```python
import torch

def _softmax(x, axis=-1):
    return torch.softmax(x, dim=axis)
def _gelu(x):
    return torch.nn.functional.gelu(x, approximate="tanh")
def _silu(x):
    return torch.nn.functional.silu(x)
def _sigmoid(x):
    return torch.sigmoid(x)
def _layernorm(x, axis=-1, eps=1e-5):
    m = x.mean(dim=axis, keepdim=True)
    v = x.var(dim=axis, keepdim=True, unbiased=False)
    return (x - m) / torch.sqrt(v + eps)
def _scatter_add(tgt, idx, src, axis=0):
    return tgt.clone().index_add_(axis, idx, src)
def _segment_sum(src, seg, n):
    out = torch.zeros((n,) + src.shape[1:], dtype=src.dtype)
    return out.index_add_(0, seg, src)
def _pad(x, pw):
    flat = tuple(v for pair in reversed(pw) for v in pair)
    return torch.nn.functional.pad(x, flat)

kernel_name = 'sequential_preLN__ssm_conv_h3__dense_activation_relu__prompt'

def setup_inputs():

    _w = (lambda a: (lambda t: t.to(torch.bfloat16) if t.is_floating_point() else t)(torch.as_tensor(a)))
    def _A_setup():
        B, S, D = 1, 2048, 512
        ks = 4
        return {
            "q": _w((lambda *s: torch.randn(*s, dtype=torch.bfloat16) * 0.05)(B, S, D)),
            "k": _w((lambda *s: torch.randn(*s, dtype=torch.bfloat16) * 0.4)(B, S, D)),
            "v": _w((lambda *s: torch.randn(*s, dtype=torch.bfloat16) * 0.4)(B, S, D)),
            "shift_k": _w((lambda *s: torch.randn(*s, dtype=torch.bfloat16) * 0.4)(D, ks) * 0.5),
            "ssm_k": _w((lambda *s: torch.randn(*s, dtype=torch.bfloat16) * 0.4)(D, S) * (1.0 / S ** 0.5)),
            "ssm_D": _w((lambda *s: torch.randn(*s, dtype=torch.bfloat16) * 0.4)(D)),
        }
    _A_in = _A_setup()

    def _B_setup():
        B, S, D, Dff = 1, 2048, 512, 1792
        return {
            "x": _w((lambda *s: torch.randn(*s, dtype=torch.bfloat16) * 0.05)(B, S, D)),
            "w1": _w((lambda *s: torch.randn(*s, dtype=torch.bfloat16) * 0.05)(D, Dff)),
            "w2": _w((lambda *s: torch.randn(*s, dtype=torch.bfloat16) * 0.05)(Dff, D)),
        }
    _B_in = _B_setup()

    return {
        "A_q": _A_in["q"],
        "A_k": _A_in["k"],
        "A_v": _A_in["v"],
        "A_shift_k": _A_in["shift_k"],
        "A_ssm_k": _A_in["ssm_k"],
        "A_ssm_D": _A_in["ssm_D"],
        "B_x": _B_in["x"],
        "B_w1": _B_in["w1"],
        "B_w2": _B_in["w2"],
    }

def reference(A_q, A_k, A_v, A_shift_k, A_ssm_k, A_ssm_D, B_x, B_w1, B_w2):
    def _A_ref(q, k, v, shift_k, ssm_k, ssm_D):
        B, S, D = q.shape
        ks = shift_k.shape[-1]
        k_pad = _pad(k, ((0, 0), (ks - 1, 0), (0, 0)))
        k_shift = torch.zeros_like(k)
        for t in range(ks):
            k_shift = k_shift + k_pad[:, t:t + S, :] * shift_k[:, ks - 1 - t][None, None, :]
        kv = k_shift * v
        L = 2 * S
        kv_pad = _pad(kv, ((0, 0), (0, S), (0, 0)))
        kf_pad = _pad(ssm_k, ((0, 0), (0, S)))
        kv_f = (lambda x, axes=(-2,-1): torch.fft.rfft2(x.float(), dim=axes))(kv_pad[:, None, :, :], axes=(1, 2))
        kf_f = (lambda x, axes=(-2,-1): torch.fft.rfft2(x.float(), dim=axes))(kf_pad[:, None, :], axes=(1, 2))
        kf_f = (lambda x, *d: x.permute(*d))(kf_f, 1, 2, 0)
        y_f = kv_f * kf_f[None, :, :, :]
        y = (lambda x, s, axes=(-2,-1): torch.fft.irfft2(x, s=s, dim=axes).to(torch.bfloat16))(y_f, (1, L), axes=(1, 2))[:, 0, :S, :]
        y = y + kv * ssm_D[None, None, :]
        return q * y

    def _B_ref(x, w1, w2):
        h = torch.einsum("bsd,df->bsf", x, w1)
        zero = torch.zeros_like(h)
        h = torch.maximum(h, zero)
        return torch.einsum("bsf,fd->bsd", h, w2)

    x = A_q
    h = x + _A_ref(_layernorm(x, axis=-1), A_k, A_v, A_shift_k, A_ssm_k, A_ssm_D)
    h2 = h + _B_ref(_layernorm(h, axis=-1), B_w1, B_w2)
    return h2
```

```asm
; @launch grid=(256,1,1) block=(256,1,1) lds=163840
.amdgcn_target "amdgcn-amd-amdhsa--gfx950"
.text
.globl sequential_preLN__ssm_conv_h3__dense_activation_relu__prompt_kernel
.p2align 8
.type sequential_preLN__ssm_conv_h3__dense_activation_relu__prompt_kernel,@function
sequential_preLN__ssm_conv_h3__dense_activation_relu__prompt_kernel:
    s_load_dwordx2 s[4:5], s[0:1], 0
    s_load_dwordx2 s[8:9], s[0:1], 8
    s_load_dwordx2 s[12:13], s[0:1], 16
    s_load_dwordx2 s[36:37], s[0:1], 88
    s_cmp_ge_u32 s2, 256
    s_cbranch_scc1 L_exit
    v_and_b32 v1, 63, v0
    v_lshrrev_b32 v2, 6, v0
    s_and_b32 s46, s2, 7
    v_readfirstlane_b32 s48, v2
    s_lshr_b32 s47, s2, 3
    s_mov_b32 s6, 0x200000
    s_mov_b32 s7, 0x20000
    s_mov_b64 s[10:11], s[6:7]
    s_mov_b64 s[14:15], s[6:7]
    s_mov_b32 s38, 0x1000000
    s_mov_b32 s39, s7
    v_lshlrev_b32 v5, 4, v1
    s_lshl_b32 s54, s46, 5
    s_add_u32 s54, s54, s47
    s_lshl_b32 s55, s54, 2
    s_add_u32 s55, s55, s48
    s_lshl_b32 s55, s55, 11
    v_lshrrev_b32 v6, 3, v1
    v_lshlrev_b32 v6, 10, v6
    v_and_b32 v7, 7, v1
    v_lshl_add_u32 v6, v7, 4, v6
    s_lshl_b32 s56, s47, 2
    s_add_u32 s56, s56, s48
    s_lshl_b32 s56, s56, 14
    s_lshl_b32 s53, s46, 7
    s_add_u32 s56, s56, s53
    s_add_u32 s57, s56, 7168
    v_add_u32 v7, s56, v6
    v_subrev_u32 v7, 3072, v7
    s_lshl_b32 s52, s48, 13
    s_mov_b32 m0, s52
    s_waitcnt lgkmcnt(0)
    buffer_load_dwordx4 v[36:39], v5, s[4:7], s55 offen nt
    buffer_load_dwordx4 v[40:43], v5, s[4:7], s55 offen offset:1024 nt
    s_load_dword s49, s[36:37], 0
    s_load_dwordx2 s[16:17], s[0:1], 24
    s_load_dwordx2 s[20:21], s[0:1], 32
    s_load_dwordx2 s[44:45], s[0:1], 40
    s_load_dwordx2 s[24:25], s[0:1], 56
    s_load_dwordx2 s[28:29], s[0:1], 64
    s_load_dwordx2 s[32:33], s[0:1], 72
    s_load_dwordx2 s[40:41], s[0:1], 80
    s_mov_b64 exec, 0xffffff
    buffer_load_dwordx4 v7, s[8:11], 0 offen nt lds
    s_mov_b64 exec, -1
    s_add_u32 m0, m0, 384
    s_getpc_b64 s[70:71]
    buffer_load_dwordx4 v6, s[8:11], s56 offen nt lds
    buffer_load_dwordx4 v6, s[8:11], s57 offen offset:1024 nt lds
    s_add_u32 m0, m0, 3712
    s_lshl_b32 s53, s47, 3
    buffer_load_dwordx4 v6, s[12:15], s56 offen nt lds
    buffer_load_dwordx4 v6, s[12:15], s57 offen offset:1024 nt lds
    v_add_u32 v2, s53, v1
    v_cmp_gt_u32 vcc, 24, v1
    s_getreg_b32 s51, hwreg(HW_REG_XCC_ID)
    s_add_u32 m0, m0, 2048
    v_cndmask_b32 v2, v2, v1, vcc
    v_lshlrev_b32 v2, 7, v2
    v_min_u32 v2, 23808, v2
    s_mov_b32 s18, 0x1000
    s_mov_b32 s19, 0x20000
    s_mov_b32 s22, 0x1000
    s_mov_b32 s23, 0x20000
    s_mov_b32 s26, 0x1c0000
    s_mov_b32 s27, 0x20000
    s_mov_b32 s30, 0x1c0000
    s_mov_b32 s31, 0x20000
    s_mov_b32 s34, 0x200000
    s_mov_b32 s35, 0x20000
    s_mov_b32 s42, 0x100
    s_mov_b32 s43, 0x20000
    s_and_b32 s51, s51, 15
    s_or_b32 s51, s51, 0x80
    v_mov_b32 v8, s51
    v_mov_b32 v9, s54
    v_and_b32 v3, 31, v1
    s_add_u32 s66, s52, 131072
    v_lshlrev_b32 v4, 4, v3
    s_lshl_b32 s53, s46, 9
    v_add_u32 v4, s53, v4
    s_lshl_b32 s53, s46, 5
    s_cmp_lg_u32 s48, 0
    s_waitcnt lgkmcnt(0)
    s_cbranch_scc1 L_nocen
    s_mov_b64 exec, 0xffffffff
    global_load_dword v10, v2, s[70:71]
    s_mov_b64 exec, 1
    buffer_store_byte v8, v9, s[40:43], 0 offen
    s_mov_b64 exec, -1
L_nocen:
    buffer_load_dwordx4 v[44:47], v4, s[16:19], 0 offen
    buffer_load_ubyte v14, v3, s[40:43], s53 offen sc1
    buffer_load_dwordx4 v6, s[4:7], s56 offen nt lds
    buffer_load_dwordx4 v6, s[4:7], s57 offen offset:1024 nt lds
    s_lshl_b32 s55, s46, 6
    s_lshl_b32 s53, s47, 1
    s_add_u32 s55, s55, s53
    s_lshr_b32 s53, s48, 1
    s_add_u32 s55, s55, s53
    s_mul_i32 s67, s53, 18432
    s_add_u32 s67, s67, 65536
    s_lshl_b32 s53, s55, 1
    v_mov_b32 v8, s53
    v_mov_b32 v9, 0
    s_lshl_b32 s55, s55, 12
    s_add_u32 s20, s20, s55
    s_addc_u32 s21, s21, 0
    s_and_b32 s72, s48, 1
    s_lshl_b32 s53, s72, 11
    s_mov_b32 s74, s53
    v_mov_b32 v113, v8
    s_lshl_b32 s55, s46, 20
    s_sub_u32 s53, 31, s47
    s_lshl_b32 s53, s53, 7
    s_add_u32 s92, s55, s53
    s_add_u32 s92, s92, 0x840000
    s_lshl_b32 s55, s46, 7
    s_lshl_b32 s53, s47, 2
    s_add_u32 s61, s55, s53
    s_mul_i32 s53, s72, 9216
    s_add_u32 s53, s53, s67
    v_mov_b32 v12, 0
    v_lshlrev_b32 v11, 2, v1
    v_add_u32 v13, s67, v11
    v_add_u32 v11, s53, v11
    s_mul_i32 s53, s72, 136
    v_add_u32 v9, s53, v11
    s_lshl_b32 s53, s72, 7
    v_add_u32 v11, s53, v11
    s_mov_b64 exec, 0xffff
    ds_write_b32 v13, v12
    s_mov_b64 exec, 0xffffffff
    ds_write_b32 v9, v12 offset:4160
    ds_write_b32 v11, v12 offset:8808
    s_mov_b64 exec, -1
    s_lshl_b32 s53, s72, 11
    s_add_u32 s53, s53, s67
    v_add_u32 v111, s53, v5
    s_lshl_b32 s94, s54, 2
    s_add_u32 s94, s94, s48
    s_lshl_b32 s94, s94, 4
    s_add_u32 s94, s94, 0x10000
    s_lshl_b32 s53, s46, 20
    s_lshl_b32 s54, s47, 13
    s_add_u32 s93, s53, s54
    s_lshl_b32 s53, s48, 11
    s_add_u32 s93, s93, s53
    s_add_u32 s93, s93, 0x800000
    v_lshrrev_b32 v8, 5, v1
    v_lshlrev_b32 v8, 10, v8
    v_lshl_add_u32 v8, v3, 2, v8
    v_add_u32 v108, s52, v8
    v_add_u32 v109, 1024, v108
    v_add_u32 v110, 4096, v108
    v_mul_u32_u24 v8, 144, v3
    v_lshrrev_b32 v9, 5, v0
    v_sub_u32 v9, 7, v9
    v_lshl_add_u32 v8, v9, 4, v8
    v_add_u32 v118, 131072, v8
    v_bfe_u32 v8, v1, 3, 1
    v_lshlrev_b32 v8, 5, v8
    v_lshrrev_b32 v9, 4, v1
    v_add_u32 v8, v8, v9
    s_lshl_b32 s53, s48, 3
    v_add_u32 v8, s53, v8
    v_mul_u32_u24 v8, 144, v8
    v_and_b32 v9, 7, v1
    v_lshl_add_u32 v8, v9, 4, v8
    v_add_u32 v119, 131072, v8
    v_lshrrev_b32 v8, 3, v1
    s_lshl_b32 s53, s48, 4
    v_add_u32 v8, s53, v8
    v_lshlrev_b32 v120, 12, v8
    v_lshl_add_u32 v120, v9, 4, v120
    v_lshlrev_b32 v7, 15, v8
    v_lshl_add_u32 v7, v9, 4, v7
    s_lshl_b32 s53, s48, 16
    v_and_b32 v9, 1, v1
    v_lshrrev_b32 v4, 1, v1
    v_lshlrev_b32 v4, 10, v4
    v_lshl_add_u32 v4, v9, 4, v4
    v_add_u32 v4, s53, v4
    v_and_b32 v9, 3, v1
    v_lshrrev_b32 v11, 3, v1
    v_lshl_add_u32 v11, v11, 2, v9
    v_bfe_u32 v15, v1, 2, 1
    v_lshlrev_b32 v116, 6, v11
    v_lshlrev_b32 v11, 5, v11
    v_lshl_add_u32 v11, v15, 4, v11
    s_mul_i32 s65, s48, 6144
    s_add_u32 s65, s65, 102400
    v_add_u32 v114, s65, v11
    v_add_u32 v116, s65, v116
    v_lshlrev_b32 v12, 3, v8
    v_lshl_add_u32 v12, v9, 1, v12
    v_and_b32 v11, 3, v8
    v_xor_b32 v12, v12, v11
    v_lshlrev_b32 v12, 4, v12
    v_lshl_add_u32 v12, v15, 14, v12
    v_add_u32 v12, 131072, v12
    v_xor_b32 v13, 16, v12
    v_and_b32 v8, 15, v1
    v_lshrrev_b32 v9, 4, v1
    v_lshl_add_u32 v11, v8, 2, v9
    v_bfe_u32 v15, v1, 1, 2
    v_xor_b32 v11, v11, v15
    v_lshlrev_b32 v127, 4, v11
    v_add_u32 v127, s66, v127
    v_lshlrev_b32 v2, 6, v9
    v_lshlrev_b32 v11, 5, v8
    v_sub_u32 v2, v2, v11
    s_lshl_b32 s53, s72, 8
    s_add_u32 s53, s53, s66
    s_add_u32 s53, s53, 512
    v_add_u32 v2, s53, v2
    v_and_b32 v15, 1, v9
    v_lshlrev_b32 v3, 4, v15
    v_sub_u32 v3, v3, v11
    s_lshl_b32 s53, s72, 11
    s_sub_u32 s53, s66, s53
    s_add_u32 s53, s53, 2528
    v_add_u32 v3, s53, v3
    v_lshl_add_u32 v15, v15, 3, v8
    v_lshlrev_b32 v126, 1, v15
    v_add_u32 v126, 34, v126
    v_cmp_lt_u32 vcc, 31, v1
    v_sub_u32 v15, 15, v15
    v_mov_b32 v11, 64
    v_cndmask_b32 v126, v126, 0, vcc
    v_cndmask_b32 v117, v11, v15, vcc
    v_add_u32 v126, s67, v126
    v_add_u32 v8, 1, v8
    v_and_b32 v15, 3, v8
    v_min_u32 v11, 1, v15
    v_lshlrev_b32 v121, 3, v11
    v_and_b32 v11, 1, v15
    v_mul_u32_u24 v11, 4640, v11
    v_add_u32 v121, v121, v11
    v_lshrrev_b32 v11, 1, v15
    v_mul_u32_u24 v11, 9344, v11
    v_add_u32 v121, v121, v11
    v_and_b32 v8, 0xfc, v8
    v_lshl_add_u32 v8, v9, 5, v8
    v_lshl_add_u32 v121, v8, 1, v121
    s_lshl_b32 s53, s72, 8
    s_add_u32 s53, s53, s67
    s_add_u32 s53, s53, 64
    v_add_u32 v121, s53, v121
    s_mul_i32 s73, s47, 37
    s_lshr_b32 s73, s73, 8
    s_sub_u32 s53, s47, 28
    s_cmp_ge_u32 s47, 28
    s_cselect_b32 s97, s53, s73
    s_mov_b32 s4, s24
    s_mov_b32 s5, s25
    s_mov_b32 s6, s26
    s_cselect_b32 s26, 0, s26
    s_mul_i32 s73, s97, 7
    s_sub_u32 s98, s47, s73
    s_min_u32 s98, s98, 6
    s_and_b32 s99, s46, 1
    s_mul_i32 s73, s99, 7
    s_add_u32 s63, s98, s73
    s_lshr_b32 s73, s46, 1
    s_lshl_b32 s73, s73, 2
    s_add_u32 s64, s73, s97
    s_lshl_b32 s73, s47, 2
    s_add_u32 s73, s73, s48
    s_mul_i32 s53, s73, 14336
    s_mul_i32 s62, s99, 1792
    s_add_u32 s95, s53, s62
    s_mul_i32 s53, s73, 7168
    s_mul_i32 s62, s99, 917504
    s_add_u32 s96, s53, s62
    v_lshrrev_b32 v8, 4, v1
    v_mul_u32_u24 v8, 3584, v8
    v_and_b32 v9, 15, v1
    v_min_u32 v9, 13, v9
    v_lshl_add_u32 v6, v9, 7, v8
    buffer_load_dwordx4 v[184:187], v5, s[20:23], s74 offen offset:0 nt
    buffer_load_dwordx2 v[188:189], v5, s[20:23], s74 offen offset:16 nt
    buffer_load_dwordx4 v[192:195], v5, s[20:23], s74 offen offset:1024 nt
    buffer_load_dwordx2 v[196:197], v5, s[20:23], s74 offen offset:1040 nt
    global_load_ushort v112, v113, s[44:45]
    v_and_b32 v75, 15, v1
    v_lshlrev_b32 v73, 7, v75
    v_add_u32 v73, s93, v73
    s_lshl_b32 s60, s48, 4
    v_add_u32 v75, s60, v75
    v_lshlrev_b32 v75, 12, v75
    v_add_u32 v75, s92, v75
    v_cmp_gt_u32 vcc, 16, v1
    s_nop 1
    v_cndmask_b32 v75, v73, v75, vcc
    buffer_load_dword v10, v75, s[36:39], 0 offen
    s_cmp_lg_u32 s48, 3
    s_cbranch_scc1 L_nofl
    v_and_b32 v11, 1, v1
    v_mul_u32_u24 v11, 5120, v11
    v_bfe_u32 v9, v1, 1, 1
    v_mul_u32_u24 v9, 8192, v9
    v_max_u32 v11, v11, v9
    v_bfe_u32 v9, v1, 2, 1
    v_mul_u32_u24 v9, 10240, v9
    v_max_u32 v11, v11, v9
    s_lshl_b32 s53, s46, 7
    s_add_u32 s53, s53, 1024
    s_lshl_b32 s60, s46, 20
    s_add_u32 s60, s60, 0x8df000
    s_sub_u32 s60, s60, s53
    v_lshlrev_b32 v9, 7, v1
    v_add_u32 v9, s60, v9
    v_cmp_lt_u32 vcc, 31, v1
    s_nop 1
    v_cndmask_b32 v11, v11, v9, vcc
    buffer_load_dword v10, v11, s[36:39], s53 offen sc1
L_nofl:
    v_bfe_u32 v9, v1, 2, 2
    v_lshlrev_b32 v9, 7, v9
    v_lshrrev_b32 v11, 4, v1
    v_lshl_add_u32 v9, v11, 5, v9
    v_and_b32 v11, 3, v1
    v_lshl_add_u32 v9, v11, 3, v9
    s_add_u32 s53, s52, 6144
    v_add_u32 v115, s53, v9
    v_lshrrev_b32 v8, 4, v1
    v_bfe_u32 v9, v1, 2, 2
    v_xor_b32 v9, v9, v8
    v_mul_u32_u24 v8, 3584, v8
    v_lshl_add_u32 v8, v9, 6, v8
    v_and_b32 v9, 3, v1
    v_lshl_add_u32 v8, v9, 4, v8
    s_lshl_b32 s55, s63, 8
    s_mul_i32 s53, s48, 14336
    s_add_u32 s55, s55, s53
    v_add_u32 v87, s55, v8
    s_lshl_b32 s56, s47, 1
    s_lshr_b32 s53, s48, 1
    s_add_u32 s53, s53, s56
    s_lshl_b32 s15, s53, 12
    s_lshl_b32 s19, s46, 20
    s_add_u32 s15, s15, s19
    s_add_u32 s15, s15, 0x840000
    s_lshl_b32 s53, s46, 6
    s_add_u32 s56, s56, s53
    s_lshl_b32 s56, s56, 6
    s_lshl_b32 s53, s47, 5
    s_add_u32 s19, s19, s53
    s_add_u32 s19, s19, 0x800000
    s_lshl_b32 s18, s48, 12
    s_add_u32 s18, s18, 0x10000
    s_mov_b32 s58, 57344
    s_mov_b32 s59, 114688
    s_mov_b32 s60, 172032
    s_waitcnt vmcnt(15)
    s_add_u32 s49, s49, 0x9e3779b9
    v_mov_b32 v64, 0
    v_mov_b32 v65, 0
    v_mov_b32 v66, 0
    v_mov_b32 v67, 0
    v_mov_b32 v72, 0x3f803f80
    v_dot2c_f32_bf16 v64, v36, v72
    v_dot2c_f32_bf16 v66, v36, v36
    v_dot2c_f32_bf16 v65, v40, v72
    v_dot2c_f32_bf16 v67, v40, v40
    v_dot2c_f32_bf16 v64, v37, v72
    v_dot2c_f32_bf16 v66, v37, v37
    v_dot2c_f32_bf16 v65, v41, v72
    v_dot2c_f32_bf16 v67, v41, v41
    v_dot2c_f32_bf16 v64, v38, v72
    v_dot2c_f32_bf16 v66, v38, v38
    v_dot2c_f32_bf16 v65, v42, v72
    v_dot2c_f32_bf16 v67, v42, v42
    v_dot2c_f32_bf16 v64, v39, v72
    v_dot2c_f32_bf16 v66, v39, v39
    v_dot2c_f32_bf16 v65, v43, v72
    v_dot2c_f32_bf16 v67, v43, v43
    s_nop 2
    v_add_f32_dpp v64, v64, v64 quad_perm:[1,0,3,2] row_mask:0xf bank_mask:0xf
    v_add_f32_dpp v65, v65, v65 quad_perm:[1,0,3,2] row_mask:0xf bank_mask:0xf
    v_add_f32_dpp v66, v66, v66 quad_perm:[1,0,3,2] row_mask:0xf bank_mask:0xf
    v_add_f32_dpp v67, v67, v67 quad_perm:[1,0,3,2] row_mask:0xf bank_mask:0xf
    v_add_f32_dpp v64, v64, v64 quad_perm:[2,3,0,1] row_mask:0xf bank_mask:0xf
    v_add_f32_dpp v65, v65, v65 quad_perm:[2,3,0,1] row_mask:0xf bank_mask:0xf
    v_add_f32_dpp v66, v66, v66 quad_perm:[2,3,0,1] row_mask:0xf bank_mask:0xf
    v_add_f32_dpp v67, v67, v67 quad_perm:[2,3,0,1] row_mask:0xf bank_mask:0xf
    v_add_f32_dpp v64, v64, v64 row_half_mirror row_mask:0xf bank_mask:0xf
    v_add_f32_dpp v65, v65, v65 row_half_mirror row_mask:0xf bank_mask:0xf
    v_add_f32_dpp v66, v66, v66 row_half_mirror row_mask:0xf bank_mask:0xf
    v_add_f32_dpp v67, v67, v67 row_half_mirror row_mask:0xf bank_mask:0xf
    v_add_f32_dpp v64, v64, v64 row_mirror row_mask:0xf bank_mask:0xf
    v_add_f32_dpp v65, v65, v65 row_mirror row_mask:0xf bank_mask:0xf
    v_add_f32_dpp v66, v66, v66 row_mirror row_mask:0xf bank_mask:0xf
    v_add_f32_dpp v67, v67, v67 row_mirror row_mask:0xf bank_mask:0xf
    v_mov_b32 v68, v64
    v_mov_b32 v69, v65
    v_mov_b32 v70, v66
    v_mov_b32 v71, v67
    s_nop 0
    v_permlane16_swap_b32 v64, v68
    v_permlane16_swap_b32 v65, v69
    v_permlane16_swap_b32 v66, v70
    v_permlane16_swap_b32 v67, v71
    v_add_f32 v64, v64, v68
    v_add_f32 v65, v65, v69
    v_add_f32 v66, v66, v70
    v_add_f32 v67, v67, v71
    v_mov_b32 v68, v64
    v_mov_b32 v69, v65
    v_mov_b32 v70, v66
    v_mov_b32 v71, v67
    s_nop 0
    v_permlane32_swap_b32 v64, v68
    v_permlane32_swap_b32 v65, v69
    v_permlane32_swap_b32 v66, v70
    v_permlane32_swap_b32 v67, v71
    v_add_f32 v64, v64, v68
    v_add_f32 v65, v65, v69
    v_add_f32 v66, v66, v70
    v_add_f32 v67, v67, v71
    v_mul_f32 v64, 0x3b000000, v64
    v_mul_f32 v65, 0x3b000000, v65
    v_mul_f32 v66, 0x3b000000, v66
    v_mul_f32 v67, 0x3b000000, v67
    v_fma_f32 v66, -v64, v64, v66
    v_fma_f32 v67, -v65, v65, v67
    v_max_f32 v66, 0, v66
    v_max_f32 v67, 0, v67
    v_cvt_pk_bf16_f32 v64, v64, v66
    v_cvt_pk_bf16_f32 v65, v65, v67
    v_and_b32 v66, 0xffff0000, v64
    v_and_b32 v67, 0xffff0000, v65
    v_add_f32 v66, 0x3727c5ac, v66
    v_add_f32 v67, 0x3727c5ac, v67
    v_cvt_pk_bf16_f32 v66, v66, v67
    v_lshlrev_b32 v64, 16, v64
    v_lshlrev_b32 v65, 16, v65
    v_and_b32 v67, 0xffff0000, v66
    v_lshlrev_b32 v66, 16, v66
    v_sqrt_f32 v67, v67
    v_sqrt_f32 v66, v66
    s_nop 0
    s_nop 0
    v_cvt_pk_bf16_f32 v66, v66, v67
    v_and_b32 v67, 0xffff0000, v66
    v_lshlrev_b32 v66, 16, v66
    v_rcp_f32 v70, v67
    v_rcp_f32 v68, v66
    v_mov_b32 v9, 0
    v_mul_f32 v71, -v65, v70
    v_mul_f32 v69, -v64, v68
    v_mov_b32 v73, 0xff
    s_lshr_b32 s53, s49, 0
    v_bfi_b32 v68, v73, s53, v68
    s_lshr_b32 s53, s49, 8
    v_bfi_b32 v69, v73, s53, v69
    s_lshr_b32 s53, s49, 16
    v_bfi_b32 v70, v73, s53, v70
    s_lshr_b32 s53, s49, 24
    v_bfi_b32 v71, v73, s53, v71
    s_mov_b64 exec, 1
    buffer_store_dwordx4 v[68:71], v9, s[36:39], s94 offen sc1
    s_mov_b64 exec, -1
    s_waitcnt vmcnt(9)
    ds_read2_b32 v[16:17], v108 offset0:0 offset1:32
    ds_read2_b32 v[18:19], v108 offset0:64 offset1:96
    ds_read2_b32 v[20:21], v108 offset0:128 offset1:160
    ds_read2_b32 v[22:23], v108 offset0:192 offset1:224
    ds_read2_b32 v[24:25], v109 offset0:0 offset1:32
    ds_read_b32 v26, v109 offset:256
    ds_read2_b32 v[28:29], v110 offset0:0 offset1:32
    ds_read2_b32 v[30:31], v110 offset0:64 offset1:96
    ds_read2_b32 v[32:33], v110 offset0:128 offset1:160
    ds_read2_b32 v[34:35], v110 offset0:192 offset1:224
    v_lshlrev_b32 v100, 16, v44
    v_lshlrev_b32 v101, 16, v46
    v_and_b32 v102, 0xffff0000, v44
    v_and_b32 v103, 0xffff0000, v46
    v_lshlrev_b32 v104, 16, v45
    v_lshlrev_b32 v105, 16, v47
    v_and_b32 v106, 0xffff0000, v45
    v_and_b32 v107, 0xffff0000, v47
    s_waitcnt lgkmcnt(4)
    v_lshlrev_b32 v128, 16, v16
    v_and_b32 v129, 0xffff0000, v16
    v_lshlrev_b32 v130, 16, v17
    v_and_b32 v131, 0xffff0000, v17
    v_lshlrev_b32 v132, 16, v18
    v_and_b32 v133, 0xffff0000, v18
    v_lshlrev_b32 v134, 16, v19
    v_and_b32 v135, 0xffff0000, v19
    v_lshlrev_b32 v136, 16, v20
    v_and_b32 v137, 0xffff0000, v20
    v_lshlrev_b32 v138, 16, v21
    v_and_b32 v139, 0xffff0000, v21
    v_lshlrev_b32 v140, 16, v22
    v_and_b32 v141, 0xffff0000, v22
    v_lshlrev_b32 v142, 16, v23
    v_and_b32 v143, 0xffff0000, v23
    v_lshlrev_b32 v144, 16, v24
    v_and_b32 v145, 0xffff0000, v24
    v_lshlrev_b32 v146, 16, v25
    v_and_b32 v147, 0xffff0000, v25
    v_lshlrev_b32 v148, 16, v26
    v_and_b32 v149, 0xffff0000, v26
    v_pk_mul_f32 v[168:169], v[128:129], v[106:107]
    v_pk_mul_f32 v[170:171], v[130:131], v[106:107]
    v_pk_mul_f32 v[172:173], v[132:133], v[106:107]
    v_pk_mul_f32 v[174:175], v[134:135], v[106:107]
    v_pk_mul_f32 v[176:177], v[136:137], v[106:107]
    v_pk_mul_f32 v[178:179], v[138:139], v[106:107]
    v_pk_mul_f32 v[180:181], v[140:141], v[106:107]
    v_pk_mul_f32 v[182:183], v[142:143], v[106:107]
    v_pk_fma_f32 v[168:169], v[130:131], v[104:105], v[168:169]
    v_pk_fma_f32 v[170:171], v[132:133], v[104:105], v[170:171]
    v_pk_fma_f32 v[172:173], v[134:135], v[104:105], v[172:173]
    v_pk_fma_f32 v[174:175], v[136:137], v[104:105], v[174:175]
    v_pk_fma_f32 v[176:177], v[138:139], v[104:105], v[176:177]
    v_pk_fma_f32 v[178:179], v[140:141], v[104:105], v[178:179]
    v_pk_fma_f32 v[180:181], v[142:143], v[104:105], v[180:181]
    v_pk_fma_f32 v[182:183], v[144:145], v[104:105], v[182:183]
    v_pk_fma_f32 v[168:169], v[132:133], v[102:103], v[168:169]
    v_pk_fma_f32 v[170:171], v[134:135], v[102:103], v[170:171]
    v_pk_fma_f32 v[172:173], v[136:137], v[102:103], v[172:173]
    v_pk_fma_f32 v[174:175], v[138:139], v[102:103], v[174:175]
    v_pk_fma_f32 v[176:177], v[140:141], v[102:103], v[176:177]
    v_pk_fma_f32 v[178:179], v[142:143], v[102:103], v[178:179]
    v_pk_fma_f32 v[180:181], v[144:145], v[102:103], v[180:181]
    v_pk_fma_f32 v[182:183], v[146:147], v[102:103], v[182:183]
    v_pk_fma_f32 v[168:169], v[134:135], v[100:101], v[168:169]
    v_pk_fma_f32 v[170:171], v[136:137], v[100:101], v[170:171]
    v_pk_fma_f32 v[172:173], v[138:139], v[100:101], v[172:173]
    v_pk_fma_f32 v[174:175], v[140:141], v[100:101], v[174:175]
    v_pk_fma_f32 v[176:177], v[142:143], v[100:101], v[176:177]
    v_pk_fma_f32 v[178:179], v[144:145], v[100:101], v[178:179]
    v_pk_fma_f32 v[180:181], v[146:147], v[100:101], v[180:181]
    v_pk_fma_f32 v[182:183], v[148:149], v[100:101], v[182:183]
    s_waitcnt lgkmcnt(0)
    v_lshlrev_b32 v152, 16, v28
    v_and_b32 v153, 0xffff0000, v28
    v_lshlrev_b32 v154, 16, v29
    v_and_b32 v155, 0xffff0000, v29
    v_lshlrev_b32 v156, 16, v30
    v_and_b32 v157, 0xffff0000, v30
    v_lshlrev_b32 v158, 16, v31
    v_and_b32 v159, 0xffff0000, v31
    v_lshlrev_b32 v160, 16, v32
    v_and_b32 v161, 0xffff0000, v32
    v_lshlrev_b32 v162, 16, v33
    v_and_b32 v163, 0xffff0000, v33
    v_lshlrev_b32 v164, 16, v34
    v_and_b32 v165, 0xffff0000, v34
    v_lshlrev_b32 v166, 16, v35
    v_and_b32 v167, 0xffff0000, v35
    v_pk_mul_f32 v[168:169], v[168:169], v[152:153]
    v_pk_mul_f32 v[170:171], v[170:171], v[154:155]
    v_pk_mul_f32 v[172:173], v[172:173], v[156:157]
    v_pk_mul_f32 v[174:175], v[174:175], v[158:159]
    v_pk_mul_f32 v[176:177], v[176:177], v[160:161]
    v_pk_mul_f32 v[178:179], v[178:179], v[162:163]
    v_pk_mul_f32 v[180:181], v[180:181], v[164:165]
    v_pk_mul_f32 v[182:183], v[182:183], v[166:167]
    v_cvt_pk_bf16_f32 v16, v182, v180
    v_cvt_pk_bf16_f32 v17, v178, v176
    v_cvt_pk_bf16_f32 v18, v174, v172
    v_cvt_pk_bf16_f32 v19, v170, v168
    v_cvt_pk_bf16_f32 v20, v183, v181
    v_cvt_pk_bf16_f32 v21, v179, v177
    v_cvt_pk_bf16_f32 v22, v175, v173
    v_cvt_pk_bf16_f32 v23, v171, v169
    ds_write_b128 v118, v[16:19]
    ds_write_b128 v118, v[20:23] offset:4608
    s_waitcnt vmcnt(7)
    ds_read_b64_tr_b16 v[76:77], v115 offset:0
    ds_read_b64_tr_b16 v[78:79], v115 offset:512
    ds_read_b64_tr_b16 v[80:81], v115 offset:1024
    ds_read_b64_tr_b16 v[82:83], v115 offset:1536
    s_waitcnt lgkmcnt(0)
    s_barrier
    ds_read_b128 v[16:19], v119
    ds_read_b128 v[20:23], v119 offset:576
    v_cmp_ne_u32 vcc, s51, v14
    s_cbranch_vccz L_loc
    s_lshl_b32 s52, s46, 5
    v_and_b32 v9, 31, v1
    s_mov_b32 s62, 0
Lc1:
    buffer_load_ubyte v10, v9, s[40:43], s52 offen sc1
    s_add_u32 s62, s62, 1
    s_waitcnt vmcnt(0)
    v_cmp_ne_u32 vcc, s51, v10
    s_cbranch_vccz L_loc
    s_cmp_lt_u32 s62, 6
    s_cbranch_scc1 Lc1
    s_branch L_glob
L_loc:
    s_add_u32 s53, s92, 0x8000
    s_waitcnt lgkmcnt(0)
    s_or_b32 s54, s47, s48
    s_cbranch_scc1 Lcia
    s_lshl_b32 s54, s46, 7
    s_add_u32 s54, s54, 9216
    v_mov_b32 v9, 0
    s_mov_b64 exec, 1
    buffer_store_dword v9, v9, s[36:39], s54 offen
    s_mov_b64 exec, -1
    Lcia:
    buffer_store_dwordx4 v[16:19], v120, s[36:39], s92 offen
    buffer_store_dwordx4 v[20:23], v120, s[36:39], s53 offen
    buffer_store_dwordx4 v[76:79], v5, s[36:39], s93 offen
    buffer_store_dwordx4 v[80:83], v5, s[36:39], s93 offen offset:1024
    s_waitcnt vmcnt(6)
    v_alignbit_b32 v200, v185, v184, 16
    v_alignbit_b32 v201, v186, v185, 16
    v_alignbit_b32 v202, v187, v186, 16
    v_alignbit_b32 v203, v188, v187, 16
    v_alignbit_b32 v204, v189, v188, 16
    ds_write_b128 v111, v[184:187] offset:64
    ds_write_b64 v111, v[200:201] offset:4712
    ds_write_b64 v111, v[202:203] offset:4720
    ds_write_b32 v111, v185 offset:9416
    ds_write_b32 v111, v186 offset:9420
    ds_write_b32 v111, v187 offset:9424
    ds_write_b32 v111, v188 offset:9428
    ds_write_b32 v111, v201 offset:14056
    ds_write_b32 v111, v202 offset:14060
    ds_write_b32 v111, v203 offset:14064
    ds_write_b32 v111, v204 offset:14068
    s_waitcnt lgkmcnt(0)
    v_alignbit_b32 v200, v193, v192, 16
    v_alignbit_b32 v201, v194, v193, 16
    v_alignbit_b32 v202, v195, v194, 16
    v_alignbit_b32 v203, v196, v195, 16
    v_alignbit_b32 v204, v197, v196, 16
    ds_write_b128 v111, v[192:195] offset:1088
    ds_write_b64 v111, v[200:201] offset:5736
    ds_write_b64 v111, v[202:203] offset:5744
    ds_write_b32 v111, v193 offset:10440
    ds_write_b32 v111, v194 offset:10444
    ds_write_b32 v111, v195 offset:10448
    ds_write_b32 v111, v196 offset:10452
    ds_write_b32 v111, v201 offset:15080
    ds_write_b32 v111, v202 offset:15084
    ds_write_b32 v111, v203 offset:15088
    ds_write_b32 v111, v204 offset:15092
    s_waitcnt lgkmcnt(0)
    s_waitcnt vmcnt(0)
    s_barrier
    s_add_u32 s54, s61, 1024
    s_cmp_lg_u32 s48, 0
    s_cbranch_scc1 Lf2
    v_mov_b32 v14, s49
    v_mov_b32 v15, 0
    s_mov_b64 exec, 1
    buffer_store_dword v14, v15, s[36:39], s54 offen
    s_mov_b64 exec, -1
Lf2:
    s_mov_b64 exec, 0xffffffff
    buffer_load_dword a255, v6, s[4:7], s95 offen
    s_mov_b64 exec, -1
    v_mov_b32 v16, 0
    v_mov_b32 v17, 0
    v_lshlrev_b32 v8, 3, v1
    v_add_u32 v8, s66, v8
    ds_write_b64 v8, v[16:17] offset:4096
    ds_read_u16 v104, v126 offset:0
    ds_read_u16 v105, v126 offset:2
    ds_read_u16 v106, v126 offset:4
    ds_read_u16 v107, v126 offset:6
    ds_read_u16 v108, v126 offset:8
    ds_read_u16 v109, v126 offset:10
    ds_read_u16 v110, v126 offset:12
    ds_read_u16 v111, v126 offset:14
    ds_read_b64 v[128:129], v121 offset:0
    ds_read_b64 v[130:131], v121 offset:8
    ds_read_b64 v[144:145], v121 offset:512
    ds_read_b64 v[146:147], v121 offset:520
    ds_read_b64 v[160:161], v121 offset:1024
    ds_read_b64 v[162:163], v121 offset:1032
    s_waitcnt lgkmcnt(6)
    ds_read_b64 v[176:177], v121 offset:1536
    v_cmp_eq_u32 vcc, 0, v117
    s_nop 1
    v_cndmask_b32 v104, v104, v112, vcc
    ds_read_b64 v[178:179], v121 offset:1544
    v_cmp_eq_u32 vcc, 1, v117
    s_nop 1
    v_cndmask_b32 v105, v105, v112, vcc
    v_lshl_or_b32 v122, v105, 16, v104
    ds_read_b64 v[192:193], v121 offset:2048
    v_cmp_eq_u32 vcc, 2, v117
    s_nop 1
    v_cndmask_b32 v106, v106, v112, vcc
    ds_read_b64 v[194:195], v121 offset:2056
    v_cmp_eq_u32 vcc, 3, v117
    s_nop 1
    v_cndmask_b32 v107, v107, v112, vcc
    v_lshl_or_b32 v123, v107, 16, v106
    ds_read_b64 v[208:209], v121 offset:2560
    v_cmp_eq_u32 vcc, 4, v117
    s_nop 1
    v_cndmask_b32 v108, v108, v112, vcc
    ds_read_b64 v[210:211], v121 offset:2568
    v_cmp_eq_u32 vcc, 5, v117
    s_nop 1
    v_cndmask_b32 v109, v109, v112, vcc
    v_lshl_or_b32 v124, v109, 16, v108
    ds_read_b64 v[224:225], v121 offset:3072
    v_cmp_eq_u32 vcc, 6, v117
    s_nop 1
    v_cndmask_b32 v110, v110, v112, vcc
    ds_read_b64 v[226:227], v121 offset:3080
    v_cmp_eq_u32 vcc, 7, v117
    s_nop 1
    v_cndmask_b32 v111, v111, v112, vcc
    v_lshl_or_b32 v125, v111, 16, v110
    s_waitcnt lgkmcnt(8)
    ds_read_b64 v[240:241], v121 offset:3584
    ds_read_b64 v[242:243], v121 offset:3592
    ds_read_b64 v[132:133], v121 offset:16
    ds_read_b64 v[134:135], v121 offset:24
    s_waitcnt lgkmcnt(10)
    ds_read_b64 v[148:149], v121 offset:528
    ds_read_b64 v[150:151], v121 offset:536
    ds_read_b64 v[164:165], v121 offset:1040
    ds_read_b64 v[166:167], v121 offset:1048
    s_waitcnt lgkmcnt(10)
    ds_read_b64 v[180:181], v121 offset:1552
    ds_read_b64 v[182:183], v121 offset:1560
    ds_read_b64 v[196:197], v121 offset:2064
    ds_read_b64 v[198:199], v121 offset:2072
    s_waitcnt lgkmcnt(10)
    ds_read_b64 v[212:213], v121 offset:2576
    ds_read_b64 v[214:215], v121 offset:2584
    ds_read_b64 v[228:229], v121 offset:3088
    ds_read_b64 v[230:231], v121 offset:3096
    s_waitcnt lgkmcnt(10)
    ds_read_b64 v[244:245], v121 offset:3600
    ds_read_b64 v[246:247], v121 offset:3608
    ds_read_b64 v[136:137], v121 offset:32
    ds_read_b64 v[138:139], v121 offset:40
    s_waitcnt lgkmcnt(10)
    ds_read_b64 v[152:153], v121 offset:544
    ds_read_b64 v[154:155], v121 offset:552
    ds_read_b64 v[168:169], v121 offset:1056
    ds_read_b64 v[170:171], v121 offset:1064
    s_waitcnt lgkmcnt(10)
    ds_read_b64 v[184:185], v121 offset:1568
    ds_read_b64 v[186:187], v121 offset:1576
    ds_read_b64 v[200:201], v121 offset:2080
    ds_read_b64 v[202:203], v121 offset:2088
    s_waitcnt lgkmcnt(10)
    ds_read_b64 v[216:217], v121 offset:2592
    ds_read_b64 v[218:219], v121 offset:2600
    ds_read_b64 v[232:233], v121 offset:3104
    ds_read_b64 v[234:235], v121 offset:3112
    s_waitcnt lgkmcnt(10)
    ds_read_b64 v[248:249], v121 offset:3616
    ds_read_b64 v[250:251], v121 offset:3624
    ds_read_b64 v[140:141], v121 offset:48
    ds_read_b64 v[142:143], v121 offset:56
    s_waitcnt lgkmcnt(10)
    ds_read_b64 v[156:157], v121 offset:560
    ds_read_b64 v[158:159], v121 offset:568
    ds_read_b64 v[172:173], v121 offset:1072
    ds_read_b64 v[174:175], v121 offset:1080
    s_waitcnt lgkmcnt(10)
    ds_read_b64 v[188:189], v121 offset:1584
    ds_read_b64 v[190:191], v121 offset:1592
    ds_read_b64 v[204:205], v121 offset:2096
    ds_read_b64 v[206:207], v121 offset:2104
    s_waitcnt lgkmcnt(10)
    ds_read_b64 v[220:221], v121 offset:2608
    ds_read_b64 v[222:223], v121 offset:2616
    ds_read_b64 v[236:237], v121 offset:3120
    ds_read_b64 v[238:239], v121 offset:3128
    s_waitcnt lgkmcnt(10)
    ds_read_b64 v[252:253], v121 offset:3632
    ds_read_b64 v[254:255], v121 offset:3640
    s_mov_b32 m0, s66
    v_mov_b32 v126, v87
    v_mov_b32 v0, v114
    s_mov_b32 s93, s19
    s_add_u32 s92, s19, 31744
    s_mov_b32 s94, s18
    s_mov_b32 s73, -1
    s_lshl_b32 s52, s46, 7
    v_and_b32 v8, 31, v1
    v_lshlrev_b32 v8, 2, v8
    v_mov_b32 v9, 1024
    v_cmp_lt_u32 vcc, 31, v1
    s_nop 1
    v_cndmask_b32 v9, 0, v9, vcc
    v_add_u32 v8, v8, v9
    s_add_u32 s52, s52, 1024
    s_mov_b32 s62, 0
Lp3:
    buffer_load_dword v9, v8, s[36:39], s52 offen sc1
    s_add_u32 s62, s62, 1
    s_cmp_gt_u32 s62, 1048576
    s_cbranch_scc1 Lpd4
    s_waitcnt vmcnt(0)
    v_cmp_eq_u32 vcc, s49, v9
    s_nop 0
    s_or_b32 s53, vcc_lo, vcc_hi
    s_and_b32 s53, s53, s73
    s_cmp_lg_u32 s53, s73
    s_cbranch_scc1 Lp3
Lpd4:
    s_waitcnt vmcnt(0)
    buffer_load_dwordx4 v5, s[36:39], s15 offen offset:0 sc1  lds
    buffer_load_dwordx4 v5, s[36:39], s15 offen offset:1024 sc1  lds
    buffer_load_dwordx4 v5, s[36:39], s15 offen offset:2048 sc1  lds
    buffer_load_dwordx4 v5, s[36:39], s15 offen offset:3072 sc1  lds
    s_waitcnt lgkmcnt(0)
    s_lshl_b32 s45, s48, 10
    s_waitcnt vmcnt(0)
    ds_read_b128 v[48:51], v2 offset:3584
    ds_read_b128 v[52:55], v2 offset:3600
    ds_read_b128 v[56:59], v2 offset:3616
    ds_read_b128 v[60:63], v2 offset:3632
    s_waitcnt lgkmcnt(3)
    v_mfma_f32_16x16x32_bf16 v[16:19], v[128:131], v[48:51], 0
    ds_read_b128 v[64:67], v2 offset:3072
    s_mov_b32 m0, s65
    s_nop 0
    buffer_load_dwordx4 v4, s[36:39], s93 offen sc1 lds
    buffer_load_dwordx4 v4, s[36:39], s92 offen offset:1024 sc1 lds
    s_add_u32 m0, m0, 2048
    s_nop 0
    v_mfma_f32_16x16x32_bf16 v[20:23], v[144:147], v[48:51], 0
    buffer_load_dwordx4 v5, s[36:39], s94 offen offset:0 sc1 lds
    buffer_load_dwordx4 v5, s[36:39], s94 offen offset:1024 sc1 lds
    v_mfma_f32_16x16x32_bf16 v[24:27], v[160:163], v[48:51], 0
    buffer_load_dwordx4 v5, s[36:39], s94 offen offset:2048 sc1 lds
    buffer_load_dwordx4 v5, s[36:39], s94 offen offset:3072 sc1 lds
    v_mfma_f32_16x16x32_bf16 v[28:31], v[176:179], v[48:51], 0
    v_mfma_f32_16x16x32_bf16 v[32:35], v[192:195], v[48:51], 0
    s_lshl_b64 exec, exec, 32
    buffer_load_dword a255, v6, s[4:7], s95 offen
    s_not_b64 exec, 0
    s_nop 3
    v_mfma_f32_16x16x32_bf16 v[36:39], v[208:211], v[48:51], 0
    v_mfma_f32_16x16x32_bf16 v[40:43], v[224:227], v[48:51], 0
    v_min_u32 v6, 55, v1
    v_lshlrev_b32 v6, 7, v6
    buffer_load_dword a255, v6, s[28:31], s96 offen
    v_mfma_f32_16x16x32_bf16 v[44:47], v[240:243], v[48:51], 0
    s_waitcnt lgkmcnt(3)
    v_mfma_f32_16x16x32_bf16 v[16:19], v[132:135], v[52:55], v[16:19]
    ds_read_b128 v[68:71], v2 offset:3088
    v_mfma_f32_16x16x32_bf16 v[20:23], v[148:151], v[52:55], v[20:23]
    v_mfma_f32_16x16x32_bf16 v[24:27], v[164:167], v[52:55], v[24:27]
    v_mfma_f32_16x16x32_bf16 v[28:31], v[180:183], v[52:55], v[28:31]
    v_mfma_f32_16x16x32_bf16 v[32:35], v[196:199], v[52:55], v[32:35]
    v_mfma_f32_16x16x32_bf16 v[36:39], v[212:215], v[52:55], v[36:39]
    v_mfma_f32_16x16x32_bf16 v[40:43], v[228:231], v[52:55], v[40:43]
    v_mfma_f32_16x16x32_bf16 v[44:47], v[244:247], v[52:55], v[44:47]
    s_waitcnt lgkmcnt(3)
    v_mfma_f32_16x16x32_bf16 v[16:19], v[136:139], v[56:59], v[16:19]
    ds_read_b128 v[72:75], v2 offset:3104
    v_mfma_f32_16x16x32_bf16 v[20:23], v[152:155], v[56:59], v[20:23]
    v_mfma_f32_16x16x32_bf16 v[24:27], v[168:171], v[56:59], v[24:27]
    v_mfma_f32_16x16x32_bf16 v[28:31], v[184:187], v[56:59], v[28:31]
    v_mfma_f32_16x16x32_bf16 v[32:35], v[200:203], v[56:59], v[32:35]
    v_mfma_f32_16x16x32_bf16 v[36:39], v[216:219], v[56:59], v[36:39]
    v_mfma_f32_16x16x32_bf16 v[40:43], v[232:235], v[56:59], v[40:43]
    v_mfma_f32_16x16x32_bf16 v[44:47], v[248:251], v[56:59], v[44:47]
    s_waitcnt lgkmcnt(3)
    v_mfma_f32_16x16x32_bf16 v[16:19], v[140:143], v[60:63], v[16:19]
    ds_read_b128 v[76:79], v2 offset:3120
    v_mfma_f32_16x16x32_bf16 v[20:23], v[156:159], v[60:63], v[20:23]
    v_mfma_f32_16x16x32_bf16 v[24:27], v[172:175], v[60:63], v[24:27]
    v_mfma_f32_16x16x32_bf16 v[28:31], v[188:191], v[60:63], v[28:31]
    v_mfma_f32_16x16x32_bf16 v[32:35], v[204:207], v[60:63], v[32:35]
    v_mfma_f32_16x16x32_bf16 v[36:39], v[220:223], v[60:63], v[36:39]
    v_mfma_f32_16x16x32_bf16 v[40:43], v[236:239], v[60:63], v[40:43]
    v_mfma_f32_16x16x32_bf16 v[44:47], v[252:255], v[60:63], v[44:47]
    s_waitcnt lgkmcnt(3)
    v_mfma_f32_16x16x32_bf16 v[20:23], v[128:131], v[64:67], v[20:23]
    ds_read_b128 v[48:51], v2 offset:2560
    v_mfma_f32_16x16x32_bf16 v[24:27], v[144:147], v[64:67], v[24:27]
    v_mfma_f32_16x16x32_bf16 v[28:31], v[160:163], v[64:67], v[28:31]
    v_mfma_f32_16x16x32_bf16 v[32:35], v[176:179], v[64:67], v[32:35]
    v_mfma_f32_16x16x32_bf16 v[36:39], v[192:195], v[64:67], v[36:39]
    v_mfma_f32_16x16x32_bf16 v[40:43], v[208:211], v[64:67], v[40:43]
    v_mfma_f32_16x16x32_bf16 v[44:47], v[224:227], v[64:67], v[44:47]
    s_waitcnt lgkmcnt(3)
    v_mfma_f32_16x16x32_bf16 v[20:23], v[132:135], v[68:71], v[20:23]
    ds_read_b128 v[52:55], v2 offset:2576
    v_mfma_f32_16x16x32_bf16 v[24:27], v[148:151], v[68:71], v[24:27]
    v_mfma_f32_16x16x32_bf16 v[28:31], v[164:167], v[68:71], v[28:31]
    v_mfma_f32_16x16x32_bf16 v[32:35], v[180:183], v[68:71], v[32:35]
    v_mfma_f32_16x16x32_bf16 v[36:39], v[196:199], v[68:71], v[36:39]
    v_mfma_f32_16x16x32_bf16 v[40:43], v[212:215], v[68:71], v[40:43]
    v_mfma_f32_16x16x32_bf16 v[44:47], v[228:231], v[68:71], v[44:47]
    s_waitcnt lgkmcnt(3)
    v_mfma_f32_16x16x32_bf16 v[20:23], v[136:139], v[72:75], v[20:23]
    ds_read_b128 v[56:59], v2 offset:2592
    v_mfma_f32_16x16x32_bf16 v[24:27], v[152:155], v[72:75], v[24:27]
    v_mfma_f32_16x16x32_bf16 v[28:31], v[168:171], v[72:75], v[28:31]
    v_mfma_f32_16x16x32_bf16 v[32:35], v[184:187], v[72:75], v[32:35]
    v_mfma_f32_16x16x32_bf16 v[36:39], v[200:203], v[72:75], v[36:39]
    v_mfma_f32_16x16x32_bf16 v[40:43], v[216:219], v[72:75], v[40:43]
    v_mfma_f32_16x16x32_bf16 v[44:47], v[232:235], v[72:75], v[44:47]
    s_waitcnt lgkmcnt(3)
    v_mfma_f32_16x16x32_bf16 v[20:23], v[140:143], v[76:79], v[20:23]
    ds_read_b128 v[60:63], v2 offset:2608
    v_mfma_f32_16x16x32_bf16 v[24:27], v[156:159], v[76:79], v[24:27]
    v_mfma_f32_16x16x32_bf16 v[28:31], v[172:175], v[76:79], v[28:31]
    v_mfma_f32_16x16x32_bf16 v[32:35], v[188:191], v[76:79], v[32:35]
    v_mfma_f32_16x16x32_bf16 v[36:39], v[204:207], v[76:79], v[36:39]
    v_mfma_f32_16x16x32_bf16 v[40:43], v[220:223], v[76:79], v[40:43]
    v_mfma_f32_16x16x32_bf16 v[44:47], v[236:239], v[76:79], v[44:47]
    s_waitcnt lgkmcnt(3)
    v_mfma_f32_16x16x32_bf16 v[24:27], v[128:131], v[48:51], v[24:27]
    ds_read_b128 v[64:67], v2 offset:2048
    v_mfma_f32_16x16x32_bf16 v[28:31], v[144:147], v[48:51], v[28:31]
    v_mfma_f32_16x16x32_bf16 v[32:35], v[160:163], v[48:51], v[32:35]
    v_mfma_f32_16x16x32_bf16 v[36:39], v[176:179], v[48:51], v[36:39]
    v_mfma_f32_16x16x32_bf16 v[40:43], v[192:195], v[48:51], v[40:43]
    v_mfma_f32_16x16x32_bf16 v[44:47], v[208:211], v[48:51], v[44:47]
    s_waitcnt lgkmcnt(3)
    v_mfma_f32_16x16x32_bf16 v[24:27], v[132:135], v[52:55], v[24:27]
    ds_read_b128 v[68:71], v2 offset:2064
    v_mfma_f32_16x16x32_bf16 v[28:31], v[148:151], v[52:55], v[28:31]
    v_mfma_f32_16x16x32_bf16 v[32:35], v[164:167], v[52:55], v[32:35]
    v_mfma_f32_16x16x32_bf16 v[36:39], v[180:183], v[52:55], v[36:39]
    v_mfma_f32_16x16x32_bf16 v[40:43], v[196:199], v[52:55], v[40:43]
    v_mfma_f32_16x16x32_bf16 v[44:47], v[212:215], v[52:55], v[44:47]
    s_waitcnt lgkmcnt(3)
    v_mfma_f32_16x16x32_bf16 v[24:27], v[136:139], v[56:59], v[24:27]
    ds_read_b128 v[72:75], v2 offset:2080
    v_mfma_f32_16x16x32_bf16 v[28:31], v[152:155], v[56:59], v[28:31]
    v_mfma_f32_16x16x32_bf16 v[32:35], v[168:171], v[56:59], v[32:35]
    v_mfma_f32_16x16x32_bf16 v[36:39], v[184:187], v[56:59], v[36:39]
    v_mfma_f32_16x16x32_bf16 v[40:43], v[200:203], v[56:59], v[40:43]
    v_mfma_f32_16x16x32_bf16 v[44:47], v[216:219], v[56:59], v[44:47]
    s_waitcnt lgkmcnt(3)
    v_mfma_f32_16x16x32_bf16 v[24:27], v[140:143], v[60:63], v[24:27]
    ds_read_b128 v[76:79], v2 offset:2096
    v_mfma_f32_16x16x32_bf16 v[28:31], v[156:159], v[60:63], v[28:31]
    v_mfma_f32_16x16x32_bf16 v[32:35], v[172:175], v[60:63], v[32:35]
    v_mfma_f32_16x16x32_bf16 v[36:39], v[188:191], v[60:63], v[36:39]
    v_mfma_f32_16x16x32_bf16 v[40:43], v[204:207], v[60:63], v[40:43]
    v_mfma_f32_16x16x32_bf16 v[44:47], v[220:223], v[60:63], v[44:47]
    s_waitcnt lgkmcnt(3)
    v_mfma_f32_16x16x32_bf16 v[28:31], v[128:131], v[64:67], v[28:31]
    ds_read_b128 v[48:51], v2 offset:1536
    s_waitcnt vmcnt(2)
    ds_read_b128 v[80:83], v0 offset:0
    ds_read_b128 v[84:87], v0 offset:1024
    v_mfma_f32_16x16x32_bf16 v[32:35], v[144:147], v[64:67], v[32:35]
    ds_read_b128 v[88:91], v116 offset:2048
    ds_read_b128 v[92:95], v116 offset:2064
    v_mfma_f32_16x16x32_bf16 v[36:39], v[160:163], v[64:67], v[36:39]
    ds_read_b128 v[96:99], v116 offset:2080
    ds_read_b128 v[100:103], v116 offset:2096
    v_mfma_f32_16x16x32_bf16 v[40:43], v[176:179], v[64:67], v[40:43]
    ds_read_b128 v[104:107], v116 offset:4096
    ds_read_b128 v[108:111], v116 offset:4112
    v_mfma_f32_16x16x32_bf16 v[44:47], v[192:195], v[64:67], v[44:47]
    ds_read_b128 v[112:115], v116 offset:4128
    ds_read_b128 v[116:119], v116 offset:4144
    s_waitcnt lgkmcnt(3)
    v_mfma_f32_16x16x32_bf16 v[28:31], v[132:135], v[68:71], v[28:31]
    ds_read_b128 v[52:55], v2 offset:1552
    v_mfma_f32_16x16x32_bf16 v[32:35], v[148:151], v[68:71], v[32:35]
    v_mfma_f32_16x16x32_bf16 v[36:39], v[164:167], v[68:71], v[36:39]
    v_mfma_f32_16x16x32_bf16 v[40:43], v[180:183], v[68:71], v[40:43]
    s_waitcnt lgkmcnt(0)
    v_mfma_f32_16x16x32_bf16 v[44:47], v[196:199], v[68:71], v[44:47]
    s_and_b32 s52, s49, 0xff
    s_bfe_u32 s53, s49, 0x80008
    s_bfe_u32 s54, s49, 0x80010
    s_lshr_b32 s55, s49, 24
    s_waitcnt lgkmcnt(3)
    v_mfma_f32_16x16x32_bf16 v[28:31], v[136:139], v[72:75], v[28:31]
    ds_read_b128 v[56:59], v2 offset:1568
    v_xor_b32 v88, s52, v88
    v_xor_b32 v89, s53, v89
    v_mfma_f32_16x16x32_bf16 v[32:35], v[152:155], v[72:75], v[32:35]
    v_xor_b32 v90, s54, v90
    v_xor_b32 v91, s55, v91
    v_mfma_f32_16x16x32_bf16 v[36:39], v[168:171], v[72:75], v[36:39]
    v_or3_b32 v8, v88, v89, 0
    v_or3_b32 v8, v90, v91, v8
    v_mfma_f32_16x16x32_bf16 v[40:43], v[184:187], v[72:75], v[40:43]
    v_xor_b32 v92, s52, v92
    v_xor_b32 v93, s53, v93
    v_mfma_f32_16x16x32_bf16 v[44:47], v[200:203], v[72:75], v[44:47]
    v_xor_b32 v94, s54, v94
    v_xor_b32 v95, s55, v95
    s_waitcnt lgkmcnt(3)
    v_mfma_f32_16x16x32_bf16 v[28:31], v[140:143], v[76:79], v[28:31]
    ds_read_b128 v[60:63], v2 offset:1584
    v_or3_b32 v8, v92, v93, v8
    v_or3_b32 v8, v94, v95, v8
    v_mfma_f32_16x16x32_bf16 v[32:35], v[156:159], v[76:79], v[32:35]
    v_xor_b32 v96, s52, v96
    v_xor_b32 v97, s53, v97
    v_mfma_f32_16x16x32_bf16 v[36:39], v[172:175], v[76:79], v[36:39]
    v_xor_b32 v98, s54, v98
    v_xor_b32 v99, s55, v99
    v_mfma_f32_16x16x32_bf16 v[40:43], v[188:191], v[76:79], v[40:43]
    v_or3_b32 v8, v96, v97, v8
    v_or3_b32 v8, v98, v99, v8
    v_mfma_f32_16x16x32_bf16 v[44:47], v[204:207], v[76:79], v[44:47]
    v_xor_b32 v100, s52, v100
    v_xor_b32 v101, s53, v101
    s_waitcnt lgkmcnt(3)
    v_mfma_f32_16x16x32_bf16 v[32:35], v[128:131], v[48:51], v[32:35]
    ds_read_b128 v[64:67], v2 offset:1024
    v_xor_b32 v102, s54, v102
    v_xor_b32 v103, s55, v103
    v_mfma_f32_16x16x32_bf16 v[36:39], v[144:147], v[48:51], v[36:39]
    v_or3_b32 v8, v100, v101, v8
    v_or3_b32 v8, v102, v103, v8
    v_mfma_f32_16x16x32_bf16 v[40:43], v[160:163], v[48:51], v[40:43]
    v_xor_b32 v104, s52, v104
    v_xor_b32 v105, s53, v105
    v_mfma_f32_16x16x32_bf16 v[44:47], v[176:179], v[48:51], v[44:47]
    v_xor_b32 v106, s54, v106
    v_xor_b32 v107, s55, v107
    s_waitcnt lgkmcnt(3)
    v_mfma_f32_16x16x32_bf16 v[32:35], v[132:135], v[52:55], v[32:35]
    ds_read_b128 v[68:71], v2 offset:1040
    v_or3_b32 v8, v104, v105, v8
    v_or3_b32 v8, v106, v107, v8
    v_mfma_f32_16x16x32_bf16 v[36:39], v[148:151], v[52:55], v[36:39]
    v_xor_b32 v108, s52, v108
    v_xor_b32 v109, s53, v109
    v_mfma_f32_16x16x32_bf16 v[40:43], v[164:167], v[52:55], v[40:43]
    v_xor_b32 v110, s54, v110
    v_xor_b32 v111, s55, v111
    v_mfma_f32_16x16x32_bf16 v[44:47], v[180:183], v[52:55], v[44:47]
    v_or3_b32 v8, v108, v109, v8
    v_or3_b32 v8, v110, v111, v8
    s_waitcnt lgkmcnt(3)
    v_mfma_f32_16x16x32_bf16 v[32:35], v[136:139], v[56:59], v[32:35]
    ds_read_b128 v[72:75], v2 offset:1056
    v_xor_b32 v112, s52, v112
    v_xor_b32 v113, s53, v113
    v_mfma_f32_16x16x32_bf16 v[36:39], v[152:155], v[56:59], v[36:39]
    v_xor_b32 v114, s54, v114
    v_xor_b32 v115, s55, v115
    v_mfma_f32_16x16x32_bf16 v[40:43], v[168:171], v[56:59], v[40:43]
    v_or3_b32 v8, v112, v113, v8
    v_or3_b32 v8, v114, v115, v8
    v_mfma_f32_16x16x32_bf16 v[44:47], v[184:187], v[56:59], v[44:47]
    v_xor_b32 v116, s52, v116
    v_xor_b32 v117, s53, v117
    s_waitcnt lgkmcnt(3)
    v_mfma_f32_16x16x32_bf16 v[32:35], v[140:143], v[60:63], v[32:35]
    ds_read_b128 v[76:79], v2 offset:1072
    v_xor_b32 v118, s54, v118
    v_xor_b32 v119, s55, v119
    v_mfma_f32_16x16x32_bf16 v[36:39], v[156:159], v[60:63], v[36:39]
    v_or3_b32 v8, v116, v117, v8
    v_or3_b32 v8, v118, v119, v8
    v_mfma_f32_16x16x32_bf16 v[40:43], v[172:175], v[60:63], v[40:43]
    v_and_b32 v8, 0xff, v8
    v_cmp_ne_u32 s[68:69], 0, v8
    v_mfma_f32_16x16x32_bf16 v[44:47], v[188:191], v[60:63], v[44:47]
    v_lshlrev_b32 v8, 16, v80
    v_fmac_f32 v89, v8, v88
    s_waitcnt lgkmcnt(3)
    v_mfma_f32_16x16x32_bf16 v[36:39], v[128:131], v[64:67], v[36:39]
    ds_read_b128 v[48:51], v2 offset:512
    v_and_b32 v9, 0xffff0000, v80
    v_fmac_f32 v91, v9, v90
    v_mfma_f32_16x16x32_bf16 v[40:43], v[144:147], v[64:67], v[40:43]
    v_lshlrev_b32 v10, 16, v81
    v_fmac_f32 v93, v10, v92
    v_mfma_f32_16x16x32_bf16 v[44:47], v[160:163], v[64:67], v[44:47]
    v_and_b32 v11, 0xffff0000, v81
    v_fmac_f32 v95, v11, v94
    s_waitcnt lgkmcnt(3)
    v_mfma_f32_16x16x32_bf16 v[36:39], v[132:135], v[68:71], v[36:39]
    ds_read_b128 v[52:55], v2 offset:528
    v_lshlrev_b32 v14, 16, v82
    v_fmac_f32 v97, v14, v96
    v_mfma_f32_16x16x32_bf16 v[40:43], v[148:151], v[68:71], v[40:43]
    v_and_b32 v15, 0xffff0000, v82
    v_fmac_f32 v99, v15, v98
    v_mfma_f32_16x16x32_bf16 v[44:47], v[164:167], v[68:71], v[44:47]
    v_lshlrev_b32 v120, 16, v83
    v_fmac_f32 v101, v120, v100
    s_waitcnt lgkmcnt(3)
    v_mfma_f32_16x16x32_bf16 v[36:39], v[136:139], v[72:75], v[36:39]
    ds_read_b128 v[56:59], v2 offset:544
    v_and_b32 v121, 0xffff0000, v83
    v_fmac_f32 v103, v121, v102
    v_mfma_f32_16x16x32_bf16 v[40:43], v[152:155], v[72:75], v[40:43]
    v_lshlrev_b32 v88, 16, v84
    v_fmac_f32 v105, v88, v104
    v_mfma_f32_16x16x32_bf16 v[44:47], v[168:171], v[72:75], v[44:47]
    v_and_b32 v90, 0xffff0000, v84
    v_fmac_f32 v107, v90, v106
    s_waitcnt lgkmcnt(3)
    v_mfma_f32_16x16x32_bf16 v[36:39], v[140:143], v[76:79], v[36:39]
    ds_read_b128 v[60:63], v2 offset:560
    v_lshlrev_b32 v92, 16, v85
    v_fmac_f32 v109, v92, v108
    v_mfma_f32_16x16x32_bf16 v[40:43], v[156:159], v[76:79], v[40:43]
    v_and_b32 v94, 0xffff0000, v85
    v_fmac_f32 v111, v94, v110
    v_mfma_f32_16x16x32_bf16 v[44:47], v[172:175], v[76:79], v[44:47]
    v_lshlrev_b32 v96, 16, v86
    v_fmac_f32 v113, v96, v112
    s_waitcnt lgkmcnt(3)
    v_mfma_f32_16x16x32_bf16 v[40:43], v[128:131], v[48:51], v[40:43]
    ds_read_b128 v[64:67], v2 offset:0
    v_and_b32 v98, 0xffff0000, v86
    v_fmac_f32 v115, v98, v114
    v_mfma_f32_16x16x32_bf16 v[44:47], v[144:147], v[48:51], v[44:47]
    v_lshlrev_b32 v100, 16, v87
    v_fmac_f32 v117, v100, v116
    s_waitcnt lgkmcnt(3)
    v_mfma_f32_16x16x32_bf16 v[40:43], v[132:135], v[52:55], v[40:43]
    ds_read_b128 v[68:71], v2 offset:16
    v_and_b32 v102, 0xffff0000, v87
    v_fmac_f32 v119, v102, v118
    v_mfma_f32_16x16x32_bf16 v[44:47], v[148:151], v[52:55], v[44:47]
    s_waitcnt lgkmcnt(3)
    v_mfma_f32_16x16x32_bf16 v[40:43], v[136:139], v[56:59], v[40:43]
    ds_read_b128 v[72:75], v2 offset:32
    v_mfma_f32_16x16x32_bf16 v[44:47], v[152:155], v[56:59], v[44:47]
    s_waitcnt lgkmcnt(3)
    v_mfma_f32_16x16x32_bf16 v[40:43], v[140:143], v[60:63], v[40:43]
    ds_read_b128 v[76:79], v2 offset:48
    v_mfma_f32_16x16x32_bf16 v[44:47], v[156:159], v[60:63], v[44:47]
    s_waitcnt lgkmcnt(3)
    v_mfma_f32_16x16x32_bf16 v[44:47], v[128:131], v[64:67], v[44:47]
    s_waitcnt lgkmcnt(2)
    v_mfma_f32_16x16x32_bf16 v[44:47], v[132:135], v[68:71], v[44:47]
    s_waitcnt lgkmcnt(1)
    v_mfma_f32_16x16x32_bf16 v[44:47], v[136:139], v[72:75], v[44:47]
    s_waitcnt lgkmcnt(0)
    v_mfma_f32_16x16x32_bf16 v[44:47], v[140:143], v[76:79], v[44:47]
    ds_read_b128 v[48:51], v3 offset:1536
    ds_read_b128 v[52:55], v3 offset:1024
    ds_read_b128 v[56:59], v3 offset:512
    ds_read_b128 v[60:63], v3 offset:0
    s_cmp_lg_u32 s72, 0
    s_cbranch_scc1 Lk1a
    s_waitcnt lgkmcnt(3)
    v_mfma_f32_16x16x32_bf16 v[16:19], v[122:125], v[48:51], v[16:19]
    s_waitcnt lgkmcnt(2)
    v_mfma_f32_16x16x32_bf16 v[20:23], v[122:125], v[52:55], v[20:23]
    s_waitcnt lgkmcnt(1)
    v_mfma_f32_16x16x32_bf16 v[24:27], v[122:125], v[56:59], v[24:27]
    s_waitcnt lgkmcnt(0)
    v_mfma_f32_16x16x32_bf16 v[28:31], v[122:125], v[60:63], v[28:31]
    s_branch Lkja
Lk1a:
    s_waitcnt lgkmcnt(3)
    v_mfma_f32_16x16x32_bf16 v[32:35], v[122:125], v[48:51], v[32:35]
    s_waitcnt lgkmcnt(2)
    v_mfma_f32_16x16x32_bf16 v[36:39], v[122:125], v[52:55], v[36:39]
    s_waitcnt lgkmcnt(1)
    v_mfma_f32_16x16x32_bf16 v[40:43], v[122:125], v[56:59], v[40:43]
    s_waitcnt lgkmcnt(0)
    v_mfma_f32_16x16x32_bf16 v[44:47], v[122:125], v[60:63], v[44:47]
Lkja:
    s_mov_b32 s62, 0
Lsta:
    s_cmp_eq_u64 s[68:69], 0
    s_cbranch_scc1 Lstoa
    s_add_u32 s62, s62, 1
    s_cmp_gt_u32 s62, 1048576
    s_cbranch_scc1 Lstoa
    s_sleep 4
    s_mov_b32 m0, s65
    s_nop 0
    buffer_load_dwordx4 v4, s[36:39], s93 offen sc1 lds
    buffer_load_dwordx4 v4, s[36:39], s92 offen offset:1024 sc1 lds
    s_add_u32 m0, m0, 2048
    s_nop 0
    buffer_load_dwordx4 v5, s[36:39], s94 offen offset:0 sc1 lds
    buffer_load_dwordx4 v5, s[36:39], s94 offen offset:1024 sc1 lds
    buffer_load_dwordx4 v5, s[36:39], s94 offen offset:2048 sc1 lds
    buffer_load_dwordx4 v5, s[36:39], s94 offen offset:3072 sc1 lds
    v_and_b32 v8, 3, v1
    v_lshrrev_b32 v9, 3, v1
    v_lshl_add_u32 v8, v9, 2, v8
    v_lshlrev_b32 v8, 6, v8
    v_add_u32 v116, s65, v8
    s_waitcnt vmcnt(0)
    ds_read_b128 v[80:83], v0 offset:0
    ds_read_b128 v[84:87], v0 offset:1024
    ds_read_b128 v[88:91], v116 offset:2048
    ds_read_b128 v[92:95], v116 offset:2064
    ds_read_b128 v[96:99], v116 offset:2080
    ds_read_b128 v[100:103], v116 offset:2096
    ds_read_b128 v[104:107], v116 offset:4096
    ds_read_b128 v[108:111], v116 offset:4112
    ds_read_b128 v[112:115], v116 offset:4128
    ds_read_b128 v[116:119], v116 offset:4144
    s_waitcnt lgkmcnt(0)
    s_and_b32 s52, s49, 0xff
    s_bfe_u32 s53, s49, 0x80008
    s_bfe_u32 s54, s49, 0x80010
    s_lshr_b32 s55, s49, 24
    v_xor_b32 v88, s52, v88
    v_xor_b32 v89, s53, v89
    v_xor_b32 v90, s54, v90
    v_xor_b32 v91, s55, v91
    v_or3_b32 v8, v88, v89, 0
    v_or3_b32 v8, v90, v91, v8
    v_xor_b32 v92, s52, v92
    v_xor_b32 v93, s53, v93
    v_xor_b32 v94, s54, v94
    v_xor_b32 v95, s55, v95
    v_or3_b32 v8, v92, v93, v8
    v_or3_b32 v8, v94, v95, v8
    v_xor_b32 v96, s52, v96
    v_xor_b32 v97, s53, v97
    v_xor_b32 v98, s54, v98
    v_xor_b32 v99, s55, v99
    v_or3_b32 v8, v96, v97, v8
    v_or3_b32 v8, v98, v99, v8
    v_xor_b32 v100, s52, v100
    v_xor_b32 v101, s53, v101
    v_xor_b32 v102, s54, v102
    v_xor_b32 v103, s55, v103
    v_or3_b32 v8, v100, v101, v8
    v_or3_b32 v8, v102, v103, v8
    v_xor_b32 v104, s52, v104
    v_xor_b32 v105, s53, v105
    v_xor_b32 v106, s54, v106
    v_xor_b32 v107, s55, v107
    v_or3_b32 v8, v104, v105, v8
    v_or3_b32 v8, v106, v107, v8
    v_xor_b32 v108, s52, v108
    v_xor_b32 v109, s53, v109
    v_xor_b32 v110, s54, v110
    v_xor_b32 v111, s55, v111
    v_or3_b32 v8, v108, v109, v8
    v_or3_b32 v8, v110, v111, v8
    v_xor_b32 v112, s52, v112
    v_xor_b32 v113, s53, v113
    v_xor_b32 v114, s54, v114
    v_xor_b32 v115, s55, v115
    v_or3_b32 v8, v112, v113, v8
    v_or3_b32 v8, v114, v115, v8
    v_xor_b32 v116, s52, v116
    v_xor_b32 v117, s53, v117
    v_xor_b32 v118, s54, v118
    v_xor_b32 v119, s55, v119
    v_or3_b32 v8, v116, v117, v8
    v_or3_b32 v8, v118, v119, v8
    v_and_b32 v8, 0xff, v8
    v_cmp_ne_u32 s[68:69], 0, v8
    v_lshlrev_b32 v8, 16, v80
    v_fmac_f32 v89, v8, v88
    v_and_b32 v9, 0xffff0000, v80
    v_fmac_f32 v91, v9, v90
    v_lshlrev_b32 v10, 16, v81
    v_fmac_f32 v93, v10, v92
    v_and_b32 v11, 0xffff0000, v81
    v_fmac_f32 v95, v11, v94
    v_lshlrev_b32 v14, 16, v82
    v_fmac_f32 v97, v14, v96
    v_and_b32 v15, 0xffff0000, v82
    v_fmac_f32 v99, v15, v98
    v_lshlrev_b32 v120, 16, v83
    v_fmac_f32 v101, v120, v100
    v_and_b32 v121, 0xffff0000, v83
    v_fmac_f32 v103, v121, v102
    v_lshlrev_b32 v88, 16, v84
    v_fmac_f32 v105, v88, v104
    v_and_b32 v90, 0xffff0000, v84
    v_fmac_f32 v107, v90, v106
    v_lshlrev_b32 v92, 16, v85
    v_fmac_f32 v109, v92, v108
    v_and_b32 v94, 0xffff0000, v85
    v_fmac_f32 v111, v94, v110
    v_lshlrev_b32 v96, 16, v86
    v_fmac_f32 v113, v96, v112
    v_and_b32 v98, 0xffff0000, v86
    v_fmac_f32 v115, v98, v114
    v_lshlrev_b32 v100, 16, v87
    v_fmac_f32 v117, v100, v116
    v_and_b32 v102, 0xffff0000, v87
    v_fmac_f32 v119, v102, v118
    s_branch Lsta
Lstoa:
    s_nop 4
    ds_write_b128 v127, v[16:19] offset:0
    ds_write_b128 v127, v[20:23] offset:1024
    ds_write_b128 v127, v[24:27] offset:2048
    ds_write_b128 v127, v[28:31] offset:3072
    ds_write_b128 v127, v[32:35] offset:4096
    ds_write_b128 v127, v[36:39] offset:5120
    ds_write_b128 v127, v[40:43] offset:6144
    ds_write_b128 v127, v[44:47] offset:7168
    s_waitcnt vmcnt(0)
    s_waitcnt lgkmcnt(0)
    s_barrier
    ds_read_b128 v[16:19], v12 offset:0
    ds_read_b128 v[20:23], v13 offset:0
    ds_read_b128 v[24:27], v12 offset:8192
    ds_read_b128 v[28:31], v13 offset:8192
    ds_read_b128 v[32:35], v12 offset:1024
    ds_read_b128 v[36:39], v13 offset:1024
    ds_read_b128 v[40:43], v12 offset:9216
    ds_read_b128 v[44:47], v13 offset:9216
    s_add_u32 s56, s56, 0x100000
    s_add_u32 s55, s56, 0x40000
    s_waitcnt lgkmcnt(4)
    v_pk_add_f32 v[16:17], v[16:17], v[24:25]
    v_pk_add_f32 v[18:19], v[18:19], v[26:27]
    v_pk_add_f32 v[20:21], v[20:21], v[28:29]
    v_pk_add_f32 v[22:23], v[22:23], v[30:31]
    v_fmac_f32 v8, v89, v16
    v_fmac_f32 v9, v91, v17
    v_fmac_f32 v10, v93, v18
    v_fmac_f32 v11, v95, v19
    v_fmac_f32 v14, v97, v20
    v_fmac_f32 v15, v99, v21
    v_fmac_f32 v120, v101, v22
    v_fmac_f32 v121, v103, v23
    v_cvt_pk_bf16_f32 v16, v8, v9
    v_cvt_pk_bf16_f32 v17, v10, v11
    v_cvt_pk_bf16_f32 v18, v14, v15
    v_cvt_pk_bf16_f32 v19, v120, v121
    buffer_store_dwordx4 v[16:19], v7, s[36:39], s56 offen sc1
    s_waitcnt lgkmcnt(0)
    v_pk_add_f32 v[32:33], v[32:33], v[40:41]
    v_pk_add_f32 v[34:35], v[34:35], v[42:43]
    v_pk_add_f32 v[36:37], v[36:37], v[44:45]
    v_pk_add_f32 v[38:39], v[38:39], v[46:47]
    v_fmac_f32 v88, v105, v32
    v_fmac_f32 v90, v107, v33
    v_fmac_f32 v92, v109, v34
    v_fmac_f32 v94, v111, v35
    v_fmac_f32 v96, v113, v36
    v_fmac_f32 v98, v115, v37
    v_fmac_f32 v100, v117, v38
    v_fmac_f32 v102, v119, v39
    v_cvt_pk_bf16_f32 v32, v88, v90
    v_cvt_pk_bf16_f32 v33, v92, v94
    v_cvt_pk_bf16_f32 v34, v96, v98
    v_cvt_pk_bf16_f32 v35, v100, v102
    buffer_store_dwordx4 v[32:35], v7, s[36:39], s55 offen sc1
    v_lshrrev_b32 v2, 5, v1
    v_lshlrev_b32 v2, 2, v2
    v_bfe_u32 v12, v1, 2, 2
    v_add_u32 v2, v2, v12
    v_lshlrev_b32 v2, 6, v2
    v_bfe_u32 v12, v1, 4, 1
    v_lshl_add_u32 v2, v12, 5, v2
    v_and_b32 v12, 3, v1
    v_lshl_add_u32 v2, v12, 3, v2
    s_lshl_b32 s75, s46, 20
    s_add_u32 s75, s75, 0x800000
    s_lshr_b32 s8, s47, 3
    s_and_b32 s9, s47, 7
    s_lshr_b32 s53, s46, 1
    s_lshl_b32 s53, s53, 2
    s_add_u32 s53, s53, s8
    s_lshl_b32 s53, s53, 2
    s_add_u32 s10, s53, s48
    s_lshl_b32 s11, s10, 15
    s_lshl_b32 s53, s9, 12
    s_add_u32 s11, s11, s53
    s_lshl_b32 s53, s99, 11
    s_add_u32 s11, s11, s53
    s_add_u32 s11, s11, 0x100000
    s_lshl_b32 s57, s48, 12
    s_add_u32 s57, s57, 81920
    v_add_u32 v170, s57, v2
    v_lshrrev_b32 v3, 5, v1
    v_lshlrev_b32 v3, 2, v3
    v_bfe_u32 v8, v1, 2, 2
    v_add_u32 v3, v3, v8
    v_lshlrev_b32 v3, 7, v3
    v_bfe_u32 v8, v1, 4, 1
    v_lshl_add_u32 v3, v8, 5, v3
    v_and_b32 v8, 3, v1
    v_lshl_add_u32 v3, v8, 3, v3
    v_bfe_u32 v8, v1, 3, 1
    v_xor_b32 v8, s99, v8
    v_lshl_add_u32 v176, v8, 6, v3
    v_xor_b32 v173, 64, v176
    v_add_u32 v172, 131072, v173
    v_add_u32 v174, 0x10000, v173
    v_add_u32 v175, 131072, v176
    v_add_u32 v177, 0x10000, v176
    v_and_b32 v8, 31, v1
    v_lshlrev_b32 v171, 3, v8
    v_mul_u32_u24 v179, 80, v8
    v_lshrrev_b32 v9, 5, v1
    v_lshl_add_u32 v179, v9, 3, v179
    v_add_u32 v179, s57, v179
    v_lshrrev_b32 v8, 2, v1
    v_and_b32 v9, 3, v1
    v_mul_u32_u24 v180, 80, v8
    v_lshl_add_u32 v180, v9, 4, v180
    v_add_u32 v180, s57, v180
    v_lshlrev_b32 v181, 10, v8
    v_lshl_add_u32 v181, v9, 4, v181
    s_lshl_b32 s53, s8, 3
    s_lshl_b32 s73, 0x7f, s53
    s_lshl_b32 s16, s97, 3
    s_add_u32 s16, s16, s98
    s_lshl_b32 s16, s16, 2
    s_lshl_b32 s53, s46, 7
    s_add_u32 s16, s16, s53
    s_lshl_b32 s12, s8, 2
    s_add_u32 s12, s12, s48
    s_mul_i32 s13, s12, 57344
    s_add_u32 s13, s13, s75
    s_lshl_b32 s12, s12, 8
    s_add_u32 s12, s12, s75
    s_add_u32 s12, s12, 0xe0000
    v_and_b32 v178, 31, v1
    v_lshlrev_b32 v178, 2, v178
    v_mov_b32 v9, 1024
    v_cmp_lt_u32 vcc, 31, v1
    s_lshl_b32 s14, s46, 7
    s_cmp_lt_u32 s48, 2
    v_cndmask_b32 v9, 0, v9, vcc
    v_add_u32 v178, v178, v9
    s_cselect_b32 s53, 5120, 0
    s_add_u32 s14, s14, s53
    s_add_u32 s14, s14, 6144
    v_lshrrev_b32 v3, 5, v1
    v_lshlrev_b32 v3, 2, v3
    v_bfe_u32 v8, v1, 2, 2
    v_add_u32 v3, v3, v8
    v_lshlrev_b32 v3, 8, v3
    v_bfe_u32 v8, v1, 4, 1
    v_lshl_add_u32 v3, v8, 5, v3
    v_and_b32 v8, 3, v1
    v_lshl_add_u32 v3, v8, 3, v3
    s_lshl_b32 s52, s72, 1
    v_bfe_u32 v8, v1, 2, 2
    v_xor_b32 v8, s52, v8
    v_lshl_add_u32 v8, v8, 6, v3
    v_xor_b32 v9, 64, v8
    v_add_u32 v10, 0x10000, v8
    v_add_u32 v11, 0x10000, v9
    s_lshr_b32 s44, s48, 1
    s_lshl_b32 s52, s44, 6
    v_xor_b32 v8, s52, v8
    v_xor_b32 v9, s52, v9
    v_xor_b32 v10, s52, v10
    v_xor_b32 v11, s52, v11
    v_mov_b32 v112, 0x3f803f80
    v_mov_b32 v113, 0x3f803f80
    v_mov_b32 v114, 0x3f803f80
    v_mov_b32 v115, 0x3f803f80
    s_add_u32 m0, s45, 0
    s_nop 0
    buffer_load_dwordx4 v126, s[24:27], 0 offen  lds
    s_add_u32 m0, s45, 4096
    s_nop 0
    buffer_load_dwordx4 v126, s[24:27], s58 offen  lds
    s_add_u32 m0, s45, 8192
    s_nop 0
    buffer_load_dwordx4 v126, s[24:27], s59 offen  lds
    s_add_u32 m0, s45, 12288
    s_nop 0
    buffer_load_dwordx4 v126, s[24:27], s60 offen  lds
    s_add_u32 m0, s45, 16384
    v_add_u32 v126, 229376, v126
    buffer_load_dwordx4 v126, s[24:27], 0 offen  lds
    s_add_u32 m0, s45, 20480
    s_nop 0
    buffer_load_dwordx4 v126, s[24:27], s58 offen  lds
    s_add_u32 m0, s45, 24576
    s_nop 0
    buffer_load_dwordx4 v126, s[24:27], s59 offen  lds
    s_add_u32 m0, s45, 28672
    s_nop 0
    buffer_load_dwordx4 v126, s[24:27], s60 offen  lds
    s_waitcnt vmcnt(8)
    s_barrier
    s_lshl_b32 s54, s46, 7
    s_lshl_b32 s53, s47, 2
    s_add_u32 s54, s54, s53
    s_add_u32 s54, s54, 4096
    s_cmp_lg_u32 s48, 0
    s_cbranch_scc1 Laga
    s_lshl_b32 s53, s46, 7
    s_add_u32 s52, s53, 9216
    v_mov_b32 v12, 1
    v_mov_b32 v14, s49
    v_mov_b32 v15, 0
    s_mov_b64 exec, 1
    buffer_atomic_add v12, v15, s[36:39], s52 offen sc0
    s_add_u32 s52, s53, 10240
    s_waitcnt vmcnt(0)
    v_cmp_eq_u32 vcc, 31, v12
    s_cbranch_vccz Lagan
    buffer_store_dword v14, v15, s[36:39], s52 offen sc1
Lagan:
    buffer_store_dword v14, v15, s[36:39], s54 offen sc1
    s_mov_b64 exec, -1
Laga:
    s_add_u32 m0, s45, 32768
    v_add_u32 v126, 229376, v126
    buffer_load_dwordx4 v126, s[24:27], 0 offen  lds
    s_add_u32 m0, s45, 36864
    s_nop 0
    buffer_load_dwordx4 v126, s[24:27], s58 offen  lds
    s_add_u32 m0, s45, 40960
    s_nop 0
    buffer_load_dwordx4 v126, s[24:27], s59 offen  lds
    s_add_u32 m0, s45, 45056
    s_nop 0
    buffer_load_dwordx4 v126, s[24:27], s60 offen  lds
    s_lshr_b32 s44, s48, 1
    s_lshl_b32 s52, s44, 15
    v_add_u32 v121, s52, v2
    v_add_u32 v122, 0x10000, v121
    s_lshl_b32 s53, s48, 13
    v_add_u32 v123, s53, v2
    s_lshl_b32 s56, s97, 2
    s_add_u32 s56, s56, s44
    s_mul_i32 s55, s56, 57344
    s_lshl_b32 s52, s98, 13
    s_add_u32 s55, s55, s52
    s_lshl_b32 s52, s72, 12
    s_add_u32 s55, s55, s52
    s_lshl_b32 s75, s46, 20
    s_add_u32 s75, s75, 0x800000
    s_add_u32 s55, s55, s75
    s_lshl_b32 s56, s56, 8
    s_add_u32 s56, s56, s75
    s_add_u32 s56, s56, 0xe0000
    v_lshrrev_b32 v12, 3, v1
    v_bfe_u32 v13, v1, 4, 1
    v_lshlrev_b32 v13, 2, v13
    v_and_b32 v14, 7, v1
    v_xor_b32 v13, v13, v14
    v_lshlrev_b32 v12, 10, v12
    v_lshl_add_u32 v12, v13, 4, v12
    s_mul_i32 s52, s99, 917504
    s_mul_i32 s53, s48, 57344
    s_add_u32 s52, s52, s53
    s_and_b32 s53, s47, 7
    s_lshl_b32 s53, s53, 7
    s_add_u32 s52, s52, s53
    v_add_u32 v127, s52, v12
    s_mul_i32 s74, s48, 7168
    s_waitcnt vmcnt(4)
    s_barrier
    s_add_u32 m0, s45, 49152
    ds_read_b64_tr_b16 a[0:1], v8 offset:0
    ds_read_b64_tr_b16 a[2:3], v8 offset:2048
    ds_read_b64_tr_b16 a[4:5], v9 offset:0
    ds_read_b64_tr_b16 a[6:7], v9 offset:2048
    v_add_u32 v126, 229376, v126
    buffer_load_dwordx4 v126, s[24:27], 0 offen  lds
    s_waitcnt lgkmcnt(8)
    s_add_u32 m0, s45, 53248
    ds_read_b64_tr_b16 a[8:9], v8 offset:4096
    ds_read_b64_tr_b16 a[10:11], v8 offset:6144
    ds_read_b64_tr_b16 a[12:13], v9 offset:4096
    ds_read_b64_tr_b16 a[14:15], v9 offset:6144
    buffer_load_dwordx4 v126, s[24:27], s58 offen  lds
    s_waitcnt lgkmcnt(8)
    s_add_u32 m0, s45, 57344
    ds_read_b64_tr_b16 a[16:17], v8 offset:8192
    ds_read_b64_tr_b16 a[18:19], v8 offset:10240
    ds_read_b64_tr_b16 a[20:21], v9 offset:8192
    ds_read_b64_tr_b16 a[22:23], v9 offset:10240
    buffer_load_dwordx4 v126, s[24:27], s59 offen  lds
    s_waitcnt lgkmcnt(8)
    v_mfma_f32_32x32x16_bf16 v[80:95], a[0:3], v[112:115], 0
    s_add_u32 m0, s45, 61440
    ds_read_b64_tr_b16 a[24:25], v8 offset:12288
    ds_read_b64_tr_b16 a[26:27], v8 offset:14336
    ds_read_b64_tr_b16 a[28:29], v9 offset:12288
    ds_read_b64_tr_b16 a[30:31], v9 offset:14336
    buffer_load_dwordx4 v126, s[24:27], s60 offen  lds
    s_waitcnt lgkmcnt(8)
    v_mfma_f32_32x32x16_bf16 v[80:95], a[8:11], v[112:115], v[80:95]
    s_add_u32 m0, s45, 65536
    ds_read_b64_tr_b16 a[32:33], v8 offset:16384
    ds_read_b64_tr_b16 a[34:35], v8 offset:18432
    ds_read_b64_tr_b16 a[36:37], v9 offset:16384
    ds_read_b64_tr_b16 a[38:39], v9 offset:18432
    v_add_u32 v126, 229376, v126
    buffer_load_dwordx4 v126, s[24:27], 0 offen  lds
    s_waitcnt lgkmcnt(8)
    v_mfma_f32_32x32x16_bf16 v[80:95], a[16:19], v[112:115], v[80:95]
    s_add_u32 m0, s45, 69632
    ds_read_b64_tr_b16 a[40:41], v8 offset:20480
    ds_read_b64_tr_b16 a[42:43], v8 offset:22528
    ds_read_b64_tr_b16 a[44:45], v9 offset:20480
    ds_read_b64_tr_b16 a[46:47], v9 offset:22528
    buffer_load_dwordx4 v126, s[24:27], s58 offen  lds
    s_waitcnt lgkmcnt(8)
    v_mfma_f32_32x32x16_bf16 v[80:95], a[24:27], v[112:115], v[80:95]
    s_add_u32 m0, s45, 73728
    ds_read_b64_tr_b16 a[48:49], v8 offset:24576
    ds_read_b64_tr_b16 a[50:51], v8 offset:26624
    ds_read_b64_tr_b16 a[52:53], v9 offset:24576
    ds_read_b64_tr_b16 a[54:55], v9 offset:26624
    buffer_load_dwordx4 v126, s[24:27], s59 offen  lds
    s_waitcnt lgkmcnt(8)
    v_mfma_f32_32x32x16_bf16 v[80:95], a[32:35], v[112:115], v[80:95]
    s_add_u32 m0, s45, 77824
    ds_read_b64_tr_b16 a[56:57], v8 offset:28672
    ds_read_b64_tr_b16 a[58:59], v8 offset:30720
    ds_read_b64_tr_b16 a[60:61], v9 offset:28672
    ds_read_b64_tr_b16 a[62:63], v9 offset:30720
    buffer_load_dwordx4 v126, s[24:27], s60 offen  lds
    s_waitcnt lgkmcnt(8)
    v_mfma_f32_32x32x16_bf16 v[80:95], a[40:43], v[112:115], v[80:95]
    s_waitcnt vmcnt(4)
    s_barrier
    s_add_u32 m0, s45, 81920
    ds_read_b64_tr_b16 a[64:65], v8 offset:32768
    ds_read_b64_tr_b16 a[66:67], v8 offset:34816
    ds_read_b64_tr_b16 a[68:69], v9 offset:32768
    ds_read_b64_tr_b16 a[70:71], v9 offset:34816
    v_add_u32 v126, 229376, v126
    buffer_load_dwordx4 v126, s[24:27], 0 offen  lds
    s_waitcnt lgkmcnt(8)
    v_mfma_f32_32x32x16_bf16 v[80:95], a[48:51], v[112:115], v[80:95]
    s_add_u32 m0, s45, 86016
    ds_read_b64_tr_b16 a[72:73], v8 offset:36864
    ds_read_b64_tr_b16 a[74:75], v8 offset:38912
    ds_read_b64_tr_b16 a[76:77], v9 offset:36864
    ds_read_b64_tr_b16 a[78:79], v9 offset:38912
    buffer_load_dwordx4 v126, s[24:27], s58 offen  lds
    s_waitcnt lgkmcnt(8)
    v_mfma_f32_32x32x16_bf16 v[80:95], a[56:59], v[112:115], v[80:95]
    s_add_u32 m0, s45, 90112
    ds_read_b64_tr_b16 a[80:81], v8 offset:40960
    ds_read_b64_tr_b16 a[82:83], v8 offset:43008
    ds_read_b64_tr_b16 a[84:85], v9 offset:40960
    ds_read_b64_tr_b16 a[86:87], v9 offset:43008
    buffer_load_dwordx4 v126, s[24:27], s59 offen  lds
    s_waitcnt lgkmcnt(8)
    v_mfma_f32_32x32x16_bf16 v[80:95], a[64:67], v[112:115], v[80:95]
    s_add_u32 m0, s45, 94208
    ds_read_b64_tr_b16 a[88:89], v8 offset:45056
    ds_read_b64_tr_b16 a[90:91], v8 offset:47104
    ds_read_b64_tr_b16 a[92:93], v9 offset:45056
    ds_read_b64_tr_b16 a[94:95], v9 offset:47104
    buffer_load_dwordx4 v126, s[24:27], s60 offen  lds
    s_waitcnt lgkmcnt(8)
    v_mfma_f32_32x32x16_bf16 v[80:95], a[72:75], v[112:115], v[80:95]
    s_add_u32 m0, s45, 98304
    ds_read_b64_tr_b16 a[96:97], v8 offset:49152
    ds_read_b64_tr_b16 a[98:99], v8 offset:51200
    ds_read_b64_tr_b16 a[100:101], v9 offset:49152
    ds_read_b64_tr_b16 a[102:103], v9 offset:51200
    v_add_u32 v126, 229376, v126
    buffer_load_dwordx4 v126, s[24:27], 0 offen  lds
    s_waitcnt lgkmcnt(8)
    v_mfma_f32_32x32x16_bf16 v[80:95], a[80:83], v[112:115], v[80:95]
    s_add_u32 m0, s45, 102400
    ds_read_b64_tr_b16 a[104:105], v8 offset:53248
    ds_read_b64_tr_b16 a[106:107], v8 offset:55296
    ds_read_b64_tr_b16 a[108:109], v9 offset:53248
    ds_read_b64_tr_b16 a[110:111], v9 offset:55296
    buffer_load_dwordx4 v126, s[24:27], s58 offen  lds
    s_waitcnt lgkmcnt(8)
    v_mfma_f32_32x32x16_bf16 v[80:95], a[88:91], v[112:115], v[80:95]
    s_add_u32 m0, s45, 106496
    ds_read_b64_tr_b16 a[112:113], v8 offset:57344
    ds_read_b64_tr_b16 a[114:115], v8 offset:59392
    ds_read_b64_tr_b16 a[116:117], v9 offset:57344
    ds_read_b64_tr_b16 a[118:119], v9 offset:59392
    buffer_load_dwordx4 v126, s[24:27], s59 offen  lds
    s_waitcnt lgkmcnt(8)
    v_mfma_f32_32x32x16_bf16 v[80:95], a[96:99], v[112:115], v[80:95]
    s_add_u32 m0, s45, 110592
    ds_read_b64_tr_b16 a[120:121], v8 offset:61440
    ds_read_b64_tr_b16 a[122:123], v8 offset:63488
    ds_read_b64_tr_b16 a[124:125], v9 offset:61440
    ds_read_b64_tr_b16 a[126:127], v9 offset:63488
    buffer_load_dwordx4 v126, s[24:27], s60 offen  lds
    s_waitcnt lgkmcnt(8)
    v_mfma_f32_32x32x16_bf16 v[80:95], a[104:107], v[112:115], v[80:95]
    s_waitcnt vmcnt(4)
    s_barrier
    s_add_u32 m0, s45, 114688
    ds_read_b64_tr_b16 a[128:129], v10 offset:0
    ds_read_b64_tr_b16 a[130:131], v10 offset:2048
    ds_read_b64_tr_b16 a[132:133], v11 offset:0
    ds_read_b64_tr_b16 a[134:135], v11 offset:2048
    v_add_u32 v126, 229376, v126
    buffer_load_dwordx4 v126, s[24:27], 0 offen  lds
    s_waitcnt lgkmcnt(8)
    v_mfma_f32_32x32x16_bf16 v[80:95], a[112:115], v[112:115], v[80:95]
    s_add_u32 m0, s45, 118784
    ds_read_b64_tr_b16 a[136:137], v10 offset:4096
    ds_read_b64_tr_b16 a[138:139], v10 offset:6144
    ds_read_b64_tr_b16 a[140:141], v11 offset:4096
    ds_read_b64_tr_b16 a[142:143], v11 offset:6144
    buffer_load_dwordx4 v126, s[24:27], s58 offen  lds
    s_waitcnt lgkmcnt(8)
    v_mfma_f32_32x32x16_bf16 v[80:95], a[120:123], v[112:115], v[80:95]
    s_add_u32 m0, s45, 122880
    ds_read_b64_tr_b16 a[144:145], v10 offset:8192
    ds_read_b64_tr_b16 a[146:147], v10 offset:10240
    ds_read_b64_tr_b16 a[148:149], v11 offset:8192
    ds_read_b64_tr_b16 a[150:151], v11 offset:10240
    buffer_load_dwordx4 v126, s[24:27], s59 offen  lds
    s_waitcnt lgkmcnt(8)
    v_mfma_f32_32x32x16_bf16 v[80:95], a[128:131], v[112:115], v[80:95]
    s_add_u32 m0, s45, 126976
    ds_read_b64_tr_b16 a[152:153], v10 offset:12288
    ds_read_b64_tr_b16 a[154:155], v10 offset:14336
    ds_read_b64_tr_b16 a[156:157], v11 offset:12288
    ds_read_b64_tr_b16 a[158:159], v11 offset:14336
    buffer_load_dwordx4 v126, s[24:27], s60 offen  lds
    s_waitcnt lgkmcnt(8)
    v_mfma_f32_32x32x16_bf16 v[80:95], a[136:139], v[112:115], v[80:95]
    ds_read_b64_tr_b16 a[160:161], v10 offset:16384
    ds_read_b64_tr_b16 a[162:163], v10 offset:18432
    ds_read_b64_tr_b16 a[164:165], v11 offset:16384
    ds_read_b64_tr_b16 a[166:167], v11 offset:18432
    s_waitcnt lgkmcnt(8)
    v_mfma_f32_32x32x16_bf16 v[80:95], a[144:147], v[112:115], v[80:95]
    ds_read_b64_tr_b16 a[168:169], v10 offset:20480
    ds_read_b64_tr_b16 a[170:171], v10 offset:22528
    ds_read_b64_tr_b16 a[172:173], v11 offset:20480
    ds_read_b64_tr_b16 a[174:175], v11 offset:22528
    s_waitcnt lgkmcnt(8)
    v_mfma_f32_32x32x16_bf16 v[80:95], a[152:155], v[112:115], v[80:95]
    ds_read_b64_tr_b16 a[176:177], v10 offset:24576
    ds_read_b64_tr_b16 a[178:179], v10 offset:26624
    ds_read_b64_tr_b16 a[180:181], v11 offset:24576
    ds_read_b64_tr_b16 a[182:183], v11 offset:26624
    s_waitcnt lgkmcnt(8)
    v_mfma_f32_32x32x16_bf16 v[80:95], a[160:163], v[112:115], v[80:95]
    ds_read_b64_tr_b16 a[184:185], v10 offset:28672
    ds_read_b64_tr_b16 a[186:187], v10 offset:30720
    ds_read_b64_tr_b16 a[188:189], v11 offset:28672
    ds_read_b64_tr_b16 a[190:191], v11 offset:30720
    s_waitcnt lgkmcnt(8)
    v_mfma_f32_32x32x16_bf16 v[80:95], a[168:171], v[112:115], v[80:95]
    s_mov_b32 s58, 7168
    s_mov_b32 s59, 14336
    s_mov_b32 s60, 21504
    s_cmp_lg_u32 s48, 0
    s_cbranch_scc1 Lf2da
    v_and_b32 v13, 7, v1
    v_lshlrev_b32 v13, 7, v13
    s_mov_b32 s52, 10240
    s_mov_b32 s62, 0
Lga:
    buffer_load_dword v12, v13, s[36:39], s52 offen sc1
    s_add_u32 s62, s62, 1
    s_waitcnt vmcnt(0)
    v_cmp_ne_u32 vcc, s49, v12
    s_cbranch_vccz Lf2da
    s_cmp_lt_u32 s62, 64
    s_cbranch_scc1 Lga
    s_mov_b32 s52, 4096
    s_mov_b32 s62, 0
Lf2a:
    buffer_load_dwordx4 v[12:15], v5, s[36:39], s52 offen sc1
    s_add_u32 s62, s62, 1
    s_cmp_gt_u32 s62, 1048576
    s_cbranch_scc1 Lf2da
Lf2ac:
    s_waitcnt vmcnt(0)
    v_xor_b32 v12, s49, v12
    v_xor_b32 v13, s49, v13
    v_xor_b32 v14, s49, v14
    v_xor_b32 v15, s49, v15
    v_or_b32 v12, v12, v13
    v_or3_b32 v12, v12, v14, v15
    v_cmp_ne_u32 vcc, 0, v12
    s_cbranch_vccnz Lf2a
Lf2da:
    s_waitcnt vmcnt(0) lgkmcnt(0)
    s_barrier
    s_cmp_ge_u32 s47, 28
    s_cbranch_scc1 Lswa
    s_lshl_b32 s53, s44, 15
    s_lshl_b32 s52, s72, 13
    s_add_u32 s53, s53, s52
    s_lshl_b32 s52, s64, 17
    s_add_u32 s52, s52, s53
    s_mov_b32 m0, s53
    s_add_u32 s52, s52, 0x100000
    buffer_load_dwordx4 v5, s[36:39], s52 offen offset:0 sc1 lds
    buffer_load_dwordx4 v5, s[36:39], s52 offen offset:1024 sc1 lds
    buffer_load_dwordx4 v5, s[36:39], s52 offen offset:2048 sc1 lds
    buffer_load_dwordx4 v5, s[36:39], s52 offen offset:3072 sc1 lds
    s_add_u32 m0, m0, 4096
    s_add_u32 s52, s52, 4096
    buffer_load_dwordx4 v5, s[36:39], s52 offen offset:0 sc1 lds
    buffer_load_dwordx4 v5, s[36:39], s52 offen offset:1024 sc1 lds
    ds_read_b64_tr_b16 a[192:193], v10 offset:32768
    ds_read_b64_tr_b16 a[194:195], v10 offset:34816
    ds_read_b64_tr_b16 a[196:197], v11 offset:32768
    ds_read_b64_tr_b16 a[198:199], v11 offset:34816
    buffer_load_dwordx4 v5, s[36:39], s52 offen offset:2048 sc1 lds
    s_waitcnt lgkmcnt(8)
    v_mfma_f32_32x32x16_bf16 v[80:95], a[176:179], v[112:115], v[80:95]
    ds_read_b64_tr_b16 a[200:201], v10 offset:36864
    ds_read_b64_tr_b16 a[202:203], v10 offset:38912
    ds_read_b64_tr_b16 a[204:205], v11 offset:36864
    ds_read_b64_tr_b16 a[206:207], v11 offset:38912
    buffer_load_dwordx4 v5, s[36:39], s52 offen offset:3072 sc1 lds
    s_waitcnt lgkmcnt(8)
    v_mfma_f32_32x32x16_bf16 v[80:95], a[184:187], v[112:115], v[80:95]
    ds_read_b64_tr_b16 a[208:209], v10 offset:40960
    ds_read_b64_tr_b16 a[210:211], v10 offset:43008
    ds_read_b64_tr_b16 a[212:213], v11 offset:40960
    ds_read_b64_tr_b16 a[214:215], v11 offset:43008
    s_add_u32 m0, m0, 12288
    s_add_u32 s52, s52, 12288
    buffer_load_dwordx4 v5, s[36:39], s52 offen offset:0 sc1 lds
    s_waitcnt lgkmcnt(8)
    v_mfma_f32_32x32x16_bf16 v[80:95], a[192:195], v[112:115], v[80:95]
    ds_read_b64_tr_b16 a[216:217], v10 offset:45056
    ds_read_b64_tr_b16 a[218:219], v10 offset:47104
    ds_read_b64_tr_b16 a[220:221], v11 offset:45056
    ds_read_b64_tr_b16 a[222:223], v11 offset:47104
    buffer_load_dwordx4 v5, s[36:39], s52 offen offset:1024 sc1 lds
    s_waitcnt lgkmcnt(8)
    v_mfma_f32_32x32x16_bf16 v[80:95], a[200:203], v[112:115], v[80:95]
    ds_read_b64_tr_b16 a[224:225], v10 offset:49152
    ds_read_b64_tr_b16 a[226:227], v10 offset:51200
    ds_read_b64_tr_b16 a[228:229], v11 offset:49152
    ds_read_b64_tr_b16 a[230:231], v11 offset:51200
    buffer_load_dwordx4 v5, s[36:39], s52 offen offset:2048 sc1 lds
    s_waitcnt lgkmcnt(8)
    v_mfma_f32_32x32x16_bf16 v[80:95], a[208:211], v[112:115], v[80:95]
    ds_read_b64_tr_b16 a[232:233], v10 offset:53248
    ds_read_b64_tr_b16 a[234:235], v10 offset:55296
    ds_read_b64_tr_b16 a[236:237], v11 offset:53248
    ds_read_b64_tr_b16 a[238:239], v11 offset:55296
    buffer_load_dwordx4 v5, s[36:39], s52 offen offset:3072 sc1 lds
    s_waitcnt lgkmcnt(8)
    v_mfma_f32_32x32x16_bf16 v[80:95], a[216:219], v[112:115], v[80:95]
    ds_read_b64_tr_b16 a[240:241], v10 offset:57344
    ds_read_b64_tr_b16 a[242:243], v10 offset:59392
    ds_read_b64_tr_b16 a[244:245], v11 offset:57344
    ds_read_b64_tr_b16 a[246:247], v11 offset:59392
    s_waitcnt lgkmcnt(8)
    v_mfma_f32_32x32x16_bf16 v[80:95], a[224:227], v[112:115], v[80:95]
    ds_read_b64_tr_b16 a[248:249], v10 offset:61440
    ds_read_b64_tr_b16 a[250:251], v10 offset:63488
    ds_read_b64_tr_b16 a[252:253], v11 offset:61440
    ds_read_b64_tr_b16 a[254:255], v11 offset:63488
    s_waitcnt lgkmcnt(8)
    v_mfma_f32_32x32x16_bf16 v[80:95], a[232:235], v[112:115], v[80:95]
    s_waitcnt lgkmcnt(0)
    v_mfma_f32_32x32x16_bf16 v[80:95], a[240:243], v[112:115], v[80:95]
    v_mfma_f32_32x32x16_bf16 v[80:95], a[248:251], v[112:115], v[80:95]
    v_lshrrev_b32 v6, 5, v1
    v_lshlrev_b32 v6, 6, v6
    s_lshl_b32 s53, s48, 7
    s_add_u32 s53, s53, 159744
    v_add_u32 v6, s53, v6
    v_xor_b32 v7, 256, v6
    s_nop 3
    s_mov_b32 exec_lo, 1
    s_mov_b32 exec_hi, 1
    ds_write_b128 v6, v[80:83] offset:0
    ds_write_b128 v6, v[84:87] offset:16
    ds_write_b128 v6, v[88:91] offset:32
    ds_write_b128 v6, v[92:95] offset:48
    s_mov_b64 exec, -1
    v_and_b32 v8, 31, v1
    v_lshlrev_b32 v4, 3, v8
    s_lshl_b32 s53, s44, 11
    v_add_u32 v182, s53, v5
    v_xor_b32 v183, 2048, v182
    s_waitcnt vmcnt(4)
    s_waitcnt lgkmcnt(0)
    s_barrier
    ds_read_b128 v[96:99], v7 offset:0
    ds_read_b128 v[100:103], v7 offset:16
    ds_read_b128 v[104:107], v7 offset:32
    ds_read_b128 v[108:111], v7 offset:48
    ds_read_b64_tr_b16 v[128:129], v121 offset:0
    ds_read_b64_tr_b16 v[130:131], v121 offset:512
    ds_read_b64_tr_b16 v[132:133], v121 offset:1024
    ds_read_b64_tr_b16 v[134:135], v121 offset:1536
    ds_read_b64_tr_b16 v[136:137], v121 offset:2048
    ds_read_b64_tr_b16 v[138:139], v121 offset:2560
    ds_read_b64_tr_b16 v[140:141], v121 offset:3072
    ds_read_b64_tr_b16 v[142:143], v121 offset:3584
    ds_read_b64_tr_b16 v[144:145], v121 offset:4096
    ds_read_b64_tr_b16 v[146:147], v121 offset:4608
    s_waitcnt lgkmcnt(8)
    v_mfma_f32_32x32x16_bf16 v[16:31], a[0:3], v[128:131], 0
    ds_read_b64_tr_b16 v[148:149], v121 offset:5120
    v_mfma_f32_32x32x16_bf16 v[32:47], a[4:7], v[128:131], 0
    ds_read_b64_tr_b16 v[150:151], v121 offset:5632
    s_add_u32 m0, m0, 4096
    s_add_u32 s52, s52, 4096
    buffer_load_dwordx4 v5, s[36:39], s52 offen offset:0 sc1 lds
    s_waitcnt lgkmcnt(8)
    v_mfma_f32_32x32x16_bf16 v[16:31], a[8:11], v[132:135], v[16:31]
    ds_read_b64_tr_b16 v[152:153], v121 offset:6144
    v_mfma_f32_32x32x16_bf16 v[32:47], a[12:15], v[132:135], v[32:47]
    ds_read_b64_tr_b16 v[154:155], v121 offset:6656
    buffer_load_dwordx4 v5, s[36:39], s52 offen offset:1024 sc1 lds
    s_waitcnt lgkmcnt(8)
    v_mfma_f32_32x32x16_bf16 v[16:31], a[16:19], v[136:139], v[16:31]
    ds_read_b64_tr_b16 v[156:157], v121 offset:7168
    v_mfma_f32_32x32x16_bf16 v[32:47], a[20:23], v[136:139], v[32:47]
    ds_read_b64_tr_b16 v[158:159], v121 offset:7680
    buffer_load_dwordx4 v5, s[36:39], s52 offen offset:2048 sc1 lds
    s_waitcnt lgkmcnt(8)
    v_mfma_f32_32x32x16_bf16 v[16:31], a[24:27], v[140:143], v[16:31]
    ds_read_b64_tr_b16 v[128:129], v121 offset:8192
    v_mfma_f32_32x32x16_bf16 v[32:47], a[28:31], v[140:143], v[32:47]
    ds_read_b64_tr_b16 v[130:131], v121 offset:8704
    buffer_load_dwordx4 v5, s[36:39], s52 offen offset:3072 sc1 lds
    s_waitcnt lgkmcnt(8)
    v_mfma_f32_32x32x16_bf16 v[16:31], a[32:35], v[144:147], v[16:31]
    ds_read_b64_tr_b16 v[132:133], v121 offset:9216
    v_mfma_f32_32x32x16_bf16 v[32:47], a[36:39], v[144:147], v[32:47]
    ds_read_b64_tr_b16 v[134:135], v121 offset:9728
    s_add_u32 m0, m0, 45056
    s_add_u32 s52, s52, 45056
    buffer_load_dwordx4 v5, s[36:39], s52 offen offset:0 sc1 lds
    s_waitcnt lgkmcnt(8)
    v_mfma_f32_32x32x16_bf16 v[16:31], a[40:43], v[148:151], v[16:31]
    ds_read_b64_tr_b16 v[136:137], v121 offset:10240
    v_mfma_f32_32x32x16_bf16 v[32:47], a[44:47], v[148:151], v[32:47]
    ds_read_b64_tr_b16 v[138:139], v121 offset:10752
    buffer_load_dwordx4 v5, s[36:39], s52 offen offset:1024 sc1 lds
    s_waitcnt lgkmcnt(8)
    v_mfma_f32_32x32x16_bf16 v[16:31], a[48:51], v[152:155], v[16:31]
    ds_read_b64_tr_b16 v[140:141], v121 offset:11264
    v_mfma_f32_32x32x16_bf16 v[32:47], a[52:55], v[152:155], v[32:47]
    ds_read_b64_tr_b16 v[142:143], v121 offset:11776
    buffer_load_dwordx4 v5, s[36:39], s52 offen offset:2048 sc1 lds
    s_waitcnt lgkmcnt(8)
    v_mfma_f32_32x32x16_bf16 v[16:31], a[56:59], v[156:159], v[16:31]
    ds_read_b64_tr_b16 v[144:145], v121 offset:12288
    v_mfma_f32_32x32x16_bf16 v[32:47], a[60:63], v[156:159], v[32:47]
    ds_read_b64_tr_b16 v[146:147], v121 offset:12800
    buffer_load_dwordx4 v5, s[36:39], s52 offen offset:3072 sc1 lds
    s_waitcnt lgkmcnt(8)
    v_mfma_f32_32x32x16_bf16 v[16:31], a[64:67], v[128:131], v[16:31]
    ds_read_b64_tr_b16 v[148:149], v121 offset:13312
    v_mfma_f32_32x32x16_bf16 v[32:47], a[68:71], v[128:131], v[32:47]
    ds_read_b64_tr_b16 v[150:151], v121 offset:13824
    s_add_u32 m0, m0, 4096
    s_add_u32 s52, s52, 4096
    buffer_load_dwordx4 v5, s[36:39], s52 offen offset:0 sc1 lds
    s_waitcnt lgkmcnt(8)
    v_mfma_f32_32x32x16_bf16 v[16:31], a[72:75], v[132:135], v[16:31]
    ds_read_b64_tr_b16 v[152:153], v121 offset:14336
    v_mfma_f32_32x32x16_bf16 v[32:47], a[76:79], v[132:135], v[32:47]
    ds_read_b64_tr_b16 v[154:155], v121 offset:14848
    buffer_load_dwordx4 v5, s[36:39], s52 offen offset:1024 sc1 lds
    s_waitcnt vmcnt(6)
    s_barrier
    s_waitcnt lgkmcnt(8)
    v_mfma_f32_32x32x16_bf16 v[16:31], a[80:83], v[136:139], v[16:31]
    ds_read_b64_tr_b16 v[156:157], v121 offset:15360
    v_mfma_f32_32x32x16_bf16 v[32:47], a[84:87], v[136:139], v[32:47]
    ds_read_b64_tr_b16 v[158:159], v121 offset:15872
    buffer_load_dwordx4 v5, s[36:39], s52 offen offset:2048 sc1 lds
    s_waitcnt lgkmcnt(8)
    v_mfma_f32_32x32x16_bf16 v[16:31], a[88:91], v[140:143], v[16:31]
    ds_read_b64_tr_b16 v[128:129], v121 offset:16384
    v_mfma_f32_32x32x16_bf16 v[32:47], a[92:95], v[140:143], v[32:47]
    ds_read_b64_tr_b16 v[130:131], v121 offset:16896
    buffer_load_dwordx4 v5, s[36:39], s52 offen offset:3072 sc1 lds
    s_waitcnt lgkmcnt(8)
    v_mfma_f32_32x32x16_bf16 v[16:31], a[96:99], v[144:147], v[16:31]
    ds_read_b64_tr_b16 v[132:133], v121 offset:17408
    v_mfma_f32_32x32x16_bf16 v[32:47], a[100:103], v[144:147], v[32:47]
    ds_read_b64_tr_b16 v[134:135], v121 offset:17920
    s_add_u32 m0, m0, 12288
    s_add_u32 s52, s52, 12288
    buffer_load_dwordx4 v5, s[36:39], s52 offen offset:0 sc1 lds
    s_waitcnt lgkmcnt(8)
    v_mfma_f32_32x32x16_bf16 v[16:31], a[104:107], v[148:151], v[16:31]
    ds_read_b64_tr_b16 v[136:137], v121 offset:18432
    v_mfma_f32_32x32x16_bf16 v[32:47], a[108:111], v[148:151], v[32:47]
    ds_read_b64_tr_b16 v[138:139], v121 offset:18944
    buffer_load_dwordx4 v5, s[36:39], s52 offen offset:1024 sc1 lds
    s_waitcnt lgkmcnt(8)
    v_mfma_f32_32x32x16_bf16 v[16:31], a[112:115], v[152:155], v[16:31]
    ds_read_b64_tr_b16 v[140:141], v121 offset:19456
    v_mfma_f32_32x32x16_bf16 v[32:47], a[116:119], v[152:155], v[32:47]
    ds_read_b64_tr_b16 v[142:143], v121 offset:19968
    buffer_load_dwordx4 v5, s[36:39], s52 offen offset:2048 sc1 lds
    s_waitcnt lgkmcnt(8)
    v_mfma_f32_32x32x16_bf16 v[16:31], a[120:123], v[156:159], v[16:31]
    ds_read_b64_tr_b16 v[144:145], v121 offset:20480
    v_mfma_f32_32x32x16_bf16 v[32:47], a[124:127], v[156:159], v[32:47]
    ds_read_b64_tr_b16 v[146:147], v121 offset:20992
    buffer_load_dwordx4 v5, s[36:39], s52 offen offset:3072 sc1 lds
    s_waitcnt lgkmcnt(8)
    v_mfma_f32_32x32x16_bf16 v[16:31], a[128:131], v[128:131], v[16:31]
    ds_read_b64_tr_b16 v[148:149], v121 offset:21504
    v_mfma_f32_32x32x16_bf16 v[32:47], a[132:135], v[128:131], v[32:47]
    ds_read_b64_tr_b16 v[150:151], v121 offset:22016
    s_add_u32 m0, m0, 4096
    s_add_u32 s52, s52, 4096
    buffer_load_dwordx4 v5, s[36:39], s52 offen offset:0 sc1 lds
    s_waitcnt lgkmcnt(8)
    v_mfma_f32_32x32x16_bf16 v[16:31], a[136:139], v[132:135], v[16:31]
    ds_read_b64_tr_b16 v[152:153], v121 offset:22528
    v_mfma_f32_32x32x16_bf16 v[32:47], a[140:143], v[132:135], v[32:47]
    ds_read_b64_tr_b16 v[154:155], v121 offset:23040
    buffer_load_dwordx4 v5, s[36:39], s52 offen offset:1024 sc1 lds
    s_waitcnt lgkmcnt(8)
    v_mfma_f32_32x32x16_bf16 v[16:31], a[144:147], v[136:139], v[16:31]
    ds_read_b64_tr_b16 v[156:157], v121 offset:23552
    v_mfma_f32_32x32x16_bf16 v[32:47], a[148:151], v[136:139], v[32:47]
    ds_read_b64_tr_b16 v[158:159], v121 offset:24064
    buffer_load_dwordx4 v5, s[36:39], s52 offen offset:2048 sc1 lds
    s_waitcnt lgkmcnt(8)
    v_mfma_f32_32x32x16_bf16 v[16:31], a[152:155], v[140:143], v[16:31]
    ds_read_b64_tr_b16 v[128:129], v121 offset:24576
    v_mfma_f32_32x32x16_bf16 v[32:47], a[156:159], v[140:143], v[32:47]
    ds_read_b64_tr_b16 v[130:131], v121 offset:25088
    buffer_load_dwordx4 v5, s[36:39], s52 offen offset:3072 sc1 lds
    s_waitcnt lgkmcnt(8)
    v_mfma_f32_32x32x16_bf16 v[16:31], a[160:163], v[144:147], v[16:31]
    ds_read_b64_tr_b16 v[132:133], v121 offset:25600
    v_mfma_f32_32x32x16_bf16 v[32:47], a[164:167], v[144:147], v[32:47]
    ds_read_b64_tr_b16 v[134:135], v121 offset:26112
    s_waitcnt lgkmcnt(8)
    v_mfma_f32_32x32x16_bf16 v[16:31], a[168:171], v[148:151], v[16:31]
    ds_read_b64_tr_b16 v[136:137], v121 offset:26624
    v_mfma_f32_32x32x16_bf16 v[32:47], a[172:175], v[148:151], v[32:47]
    ds_read_b64_tr_b16 v[138:139], v121 offset:27136
    s_waitcnt lgkmcnt(8)
    v_mfma_f32_32x32x16_bf16 v[16:31], a[176:179], v[152:155], v[16:31]
    ds_read_b64_tr_b16 v[140:141], v121 offset:27648
    v_mfma_f32_32x32x16_bf16 v[32:47], a[180:183], v[152:155], v[32:47]
    ds_read_b64_tr_b16 v[142:143], v121 offset:28160
    s_waitcnt lgkmcnt(8)
    v_mfma_f32_32x32x16_bf16 v[16:31], a[184:187], v[156:159], v[16:31]
    ds_read_b64_tr_b16 v[144:145], v121 offset:28672
    v_mfma_f32_32x32x16_bf16 v[32:47], a[188:191], v[156:159], v[32:47]
    ds_read_b64_tr_b16 v[146:147], v121 offset:29184
    s_waitcnt lgkmcnt(8)
    v_mfma_f32_32x32x16_bf16 v[16:31], a[192:195], v[128:131], v[16:31]
    ds_read_b64_tr_b16 v[148:149], v121 offset:29696
    v_mfma_f32_32x32x16_bf16 v[32:47], a[196:199], v[128:131], v[32:47]
    ds_read_b64_tr_b16 v[150:151], v121 offset:30208
    s_waitcnt lgkmcnt(8)
    v_mfma_f32_32x32x16_bf16 v[16:31], a[200:203], v[132:135], v[16:31]
    ds_read_b64_tr_b16 v[152:153], v121 offset:30720
    v_mfma_f32_32x32x16_bf16 v[32:47], a[204:207], v[132:135], v[32:47]
    ds_read_b64_tr_b16 v[154:155], v121 offset:31232
    s_waitcnt vmcnt(8)
    s_barrier
    s_waitcnt lgkmcnt(8)
    v_mfma_f32_32x32x16_bf16 v[16:31], a[208:211], v[136:139], v[16:31]
    ds_read_b64_tr_b16 v[156:157], v121 offset:31744
    v_mfma_f32_32x32x16_bf16 v[32:47], a[212:215], v[136:139], v[32:47]
    ds_read_b64_tr_b16 v[158:159], v121 offset:32256
    s_waitcnt lgkmcnt(8)
    v_mfma_f32_32x32x16_bf16 v[16:31], a[216:219], v[140:143], v[16:31]
    ds_read_b64_tr_b16 v[128:129], v122 offset:0
    v_mfma_f32_32x32x16_bf16 v[32:47], a[220:223], v[140:143], v[32:47]
    ds_read_b64_tr_b16 v[130:131], v122 offset:512
    buffer_load_dwordx2 v[124:125], v4, s[36:39], s56 offen offset:0 sc1
    s_waitcnt lgkmcnt(8)
    v_mfma_f32_32x32x16_bf16 v[16:31], a[224:227], v[144:147], v[16:31]
    ds_read_b64_tr_b16 v[132:133], v122 offset:1024
    v_mfma_f32_32x32x16_bf16 v[32:47], a[228:231], v[144:147], v[32:47]
    ds_read_b64_tr_b16 v[134:135], v122 offset:1536
    s_mul_i32 s68, s47, 12288
    s_mul_i32 s69, s48, 3072
    s_add_u32 s68, s68, s69
    s_add_u32 s68, s68, s75
    s_add_u32 s68, s68, 0x80000
    v_min_u32 v202, 23, v1
    v_lshlrev_b32 v202, 7, v202
    buffer_load_dword v200, v202, s[36:39], s68 offen
    s_waitcnt lgkmcnt(8)
    v_mfma_f32_32x32x16_bf16 v[16:31], a[232:235], v[148:151], v[16:31]
    ds_read_b64_tr_b16 v[136:137], v122 offset:2048
    v_mfma_f32_32x32x16_bf16 v[32:47], a[236:239], v[148:151], v[32:47]
    ds_read_b64_tr_b16 v[138:139], v122 offset:2560
    s_waitcnt lgkmcnt(8)
    v_mfma_f32_32x32x16_bf16 v[16:31], a[240:243], v[152:155], v[16:31]
    ds_read_b64_tr_b16 v[140:141], v122 offset:3072
    v_mfma_f32_32x32x16_bf16 v[32:47], a[244:247], v[152:155], v[32:47]
    ds_read_b64_tr_b16 v[142:143], v122 offset:3584
    s_waitcnt lgkmcnt(8)
    v_mfma_f32_32x32x16_bf16 v[16:31], a[248:251], v[156:159], v[16:31]
    ds_read_b64_tr_b16 v[144:145], v122 offset:4096
    v_mfma_f32_32x32x16_bf16 v[32:47], a[252:255], v[156:159], v[32:47]
    ds_read_b64_tr_b16 v[146:147], v122 offset:4608
    s_waitcnt lgkmcnt(8)
    v_mfma_f32_32x32x16_bf16 v[48:63], a[0:3], v[128:131], 0
    ds_read_b64_tr_b16 v[148:149], v122 offset:5120
    v_mfma_f32_32x32x16_bf16 v[64:79], a[4:7], v[128:131], 0
    ds_read_b64_tr_b16 v[150:151], v122 offset:5632
    s_waitcnt vmcnt(1)
    v_cmp_ne_u32 vcc, s49, v125
    s_cbranch_vccz Lm0ak
    s_mov_b32 s62, 0
    Lm0a:
    buffer_load_dwordx2 v[124:125], v4, s[36:39], s56 offen offset:0 sc1
    s_add_u32 s62, s62, 1
    s_cmp_gt_u32 s62, 1048576
    s_cbranch_scc1 Lm0ak
    s_waitcnt vmcnt(0)
    v_cmp_ne_u32 vcc, s49, v125
    s_cbranch_vccnz Lm0a
    Lm0ak:
    v_lshlrev_b32 v120, 16, v124
    v_xor_b32 v120, 0x80000000, v120
    s_waitcnt lgkmcnt(8)
    v_mfma_f32_32x32x16_bf16 v[48:63], a[8:11], v[132:135], v[48:63]
    ds_read_b64_tr_b16 v[152:153], v122 offset:6144
    v_mfma_f32_32x32x16_bf16 v[64:79], a[12:15], v[132:135], v[64:79]
    ds_read_b64_tr_b16 v[154:155], v122 offset:6656
    s_waitcnt lgkmcnt(8)
    v_mfma_f32_32x32x16_bf16 v[48:63], a[16:19], v[136:139], v[48:63]
    ds_read_b64_tr_b16 v[156:157], v122 offset:7168
    v_fmac_f32 v16, v120, v80
    v_fmac_f32 v17, v120, v81
    v_fmac_f32 v18, v120, v82
    v_mfma_f32_32x32x16_bf16 v[64:79], a[20:23], v[136:139], v[64:79]
    ds_read_b64_tr_b16 v[158:159], v122 offset:7680
    v_fmac_f32 v19, v120, v83
    v_fmac_f32 v20, v120, v84
    s_waitcnt lgkmcnt(8)
    v_mfma_f32_32x32x16_bf16 v[48:63], a[24:27], v[140:143], v[48:63]
    ds_read_b64_tr_b16 v[128:129], v122 offset:8192
    v_fmac_f32 v21, v120, v85
    v_fmac_f32 v22, v120, v86
    v_mfma_f32_32x32x16_bf16 v[64:79], a[28:31], v[140:143], v[64:79]
    ds_read_b64_tr_b16 v[130:131], v122 offset:8704
    v_fmac_f32 v23, v120, v87
    v_fmac_f32 v24, v120, v88
    s_waitcnt lgkmcnt(8)
    v_mfma_f32_32x32x16_bf16 v[48:63], a[32:35], v[144:147], v[48:63]
    ds_read_b64_tr_b16 v[132:133], v122 offset:9216
    v_fmac_f32 v25, v120, v89
    v_fmac_f32 v26, v120, v90
    v_mfma_f32_32x32x16_bf16 v[64:79], a[36:39], v[144:147], v[64:79]
    ds_read_b64_tr_b16 v[134:135], v122 offset:9728
    v_fmac_f32 v27, v120, v91
    v_fmac_f32 v28, v120, v92
    s_add_u32 m0, s74, 131072
    s_nop 0
    buffer_load_dwordx4 v127, s[28:31], 0 offen offset:0  lds
    s_waitcnt lgkmcnt(8)
    v_mfma_f32_32x32x16_bf16 v[48:63], a[40:43], v[148:151], v[48:63]
    ds_read_b64_tr_b16 v[136:137], v122 offset:10240
    v_fmac_f32 v29, v120, v93
    v_fmac_f32 v30, v120, v94
    v_mfma_f32_32x32x16_bf16 v[64:79], a[44:47], v[148:151], v[64:79]
    ds_read_b64_tr_b16 v[138:139], v122 offset:10752
    v_fmac_f32 v31, v120, v95
    v_cvt_pk_bf16_f32 v112, v16, v17
    buffer_load_dwordx4 v127, s[28:31], s58 offen offset:1024  lds
    s_waitcnt lgkmcnt(8)
    v_mfma_f32_32x32x16_bf16 v[48:63], a[48:51], v[152:155], v[48:63]
    ds_read_b64_tr_b16 v[140:141], v122 offset:11264
    v_cvt_pk_bf16_f32 v113, v18, v19
    v_cvt_pk_bf16_f32 v114, v20, v21
    v_cvt_pk_bf16_f32 v115, v22, v23
    v_mfma_f32_32x32x16_bf16 v[64:79], a[52:55], v[152:155], v[64:79]
    ds_read_b64_tr_b16 v[142:143], v122 offset:11776
    v_cvt_pk_bf16_f32 v116, v24, v25
    v_cvt_pk_bf16_f32 v117, v26, v27
    buffer_load_dwordx4 v127, s[28:31], s59 offen offset:2048  lds
    s_waitcnt lgkmcnt(8)
    v_mfma_f32_32x32x16_bf16 v[48:63], a[56:59], v[156:159], v[48:63]
    ds_read_b64_tr_b16 v[144:145], v122 offset:12288
    v_cvt_pk_bf16_f32 v118, v28, v29
    v_cvt_pk_bf16_f32 v119, v30, v31
    v_mfma_f32_32x32x16_bf16 v[64:79], a[60:63], v[156:159], v[64:79]
    ds_read_b64_tr_b16 v[146:147], v122 offset:12800
    v_pk_max_i16 v112, v112, 0
    v_pk_max_i16 v113, v113, 0
    buffer_load_dwordx4 v127, s[28:31], s60 offen offset:3072  lds
    s_waitcnt lgkmcnt(8)
    v_mfma_f32_32x32x16_bf16 v[48:63], a[64:67], v[128:131], v[48:63]
    ds_read_b64_tr_b16 v[148:149], v122 offset:13312
    v_pk_max_i16 v114, v114, 0
    v_pk_max_i16 v115, v115, 0
    v_mfma_f32_32x32x16_bf16 v[64:79], a[68:71], v[128:131], v[64:79]
    ds_read_b64_tr_b16 v[150:151], v122 offset:13824
    v_pk_max_i16 v116, v116, 0
    v_pk_max_i16 v117, v117, 0
    s_add_u32 m0, m0, 4096
    v_add_u32 v127, 32768, v127
    buffer_load_dwordx4 v127, s[28:31], 0 offen offset:0  lds
    s_waitcnt lgkmcnt(8)
    v_mfma_f32_32x32x16_bf16 v[48:63], a[72:75], v[132:135], v[48:63]
    ds_read_b64_tr_b16 v[152:153], v122 offset:14336
    v_pk_max_i16 v118, v118, 0
    v_pk_max_i16 v119, v119, 0
    v_mfma_f32_32x32x16_bf16 v[64:79], a[76:79], v[132:135], v[64:79]
    ds_read_b64_tr_b16 v[154:155], v122 offset:14848
    buffer_store_dwordx4 v[112:115], v182, s[36:39], s55 offen offset:0  nt
    buffer_store_dwordx4 v[116:119], v182, s[36:39], s55 offen offset:1024  nt
    buffer_load_dwordx4 v127, s[28:31], s58 offen offset:1024  lds
    s_waitcnt vmcnt(10)
    s_barrier
    s_waitcnt lgkmcnt(8)
    v_mfma_f32_32x32x16_bf16 v[48:63], a[80:83], v[136:139], v[48:63]
    ds_read_b64_tr_b16 v[156:157], v122 offset:15360
    v_fmac_f32 v32, v120, v96
    v_fmac_f32 v33, v120, v97
    v_fmac_f32 v34, v120, v98
    v_mfma_f32_32x32x16_bf16 v[64:79], a[84:87], v[136:139], v[64:79]
    ds_read_b64_tr_b16 v[158:159], v122 offset:15872
    v_fmac_f32 v35, v120, v99
    v_fmac_f32 v36, v120, v100
    buffer_load_dwordx4 v127, s[28:31], s59 offen offset:2048  lds
    s_waitcnt lgkmcnt(8)
    v_mfma_f32_32x32x16_bf16 v[48:63], a[88:91], v[140:143], v[48:63]
    ds_read_b64_tr_b16 v[128:129], v122 offset:16384
    v_fmac_f32 v37, v120, v101
    v_fmac_f32 v38, v120, v102
    v_mfma_f32_32x32x16_bf16 v[64:79], a[92:95], v[140:143], v[64:79]
    ds_read_b64_tr_b16 v[130:131], v122 offset:16896
    v_fmac_f32 v39, v120, v103
    v_fmac_f32 v40, v120, v104
    s_add_u32 m0, s74, 0
    v_add_u32 v127, 196608, v127
    buffer_load_dwordx4 v127, s[28:31], 0 offen offset:0  lds
    s_waitcnt lgkmcnt(8)
    v_mfma_f32_32x32x16_bf16 v[48:63], a[96:99], v[144:147], v[48:63]
    ds_read_b64_tr_b16 v[132:133], v122 offset:17408
    v_fmac_f32 v41, v120, v105
    v_fmac_f32 v42, v120, v106
    v_mfma_f32_32x32x16_bf16 v[64:79], a[100:103], v[144:147], v[64:79]
    ds_read_b64_tr_b16 v[134:135], v122 offset:17920
    v_fmac_f32 v43, v120, v107
    v_fmac_f32 v44, v120, v108
    buffer_load_dwordx4 v127, s[28:31], s58 offen offset:1024  lds
    s_waitcnt lgkmcnt(8)
    v_mfma_f32_32x32x16_bf16 v[48:63], a[104:107], v[148:151], v[48:63]
    ds_read_b64_tr_b16 v[136:137], v122 offset:18432
    v_fmac_f32 v45, v120, v109
    v_fmac_f32 v46, v120, v110
    v_mfma_f32_32x32x16_bf16 v[64:79], a[108:111], v[148:151], v[64:79]
    ds_read_b64_tr_b16 v[138:139], v122 offset:18944
    v_fmac_f32 v47, v120, v111
    v_cvt_pk_bf16_f32 v160, v32, v33
    buffer_load_dwordx4 v127, s[28:31], s59 offen offset:2048  lds
    s_waitcnt lgkmcnt(8)
    v_mfma_f32_32x32x16_bf16 v[48:63], a[112:115], v[152:155], v[48:63]
    ds_read_b64_tr_b16 v[140:141], v122 offset:19456
    v_cvt_pk_bf16_f32 v161, v34, v35
    v_cvt_pk_bf16_f32 v162, v36, v37
    v_cvt_pk_bf16_f32 v163, v38, v39
    v_mfma_f32_32x32x16_bf16 v[64:79], a[116:119], v[152:155], v[64:79]
    ds_read_b64_tr_b16 v[142:143], v122 offset:19968
    v_cvt_pk_bf16_f32 v164, v40, v41
    v_cvt_pk_bf16_f32 v165, v42, v43
    buffer_load_dwordx4 v127, s[28:31], s60 offen offset:3072  lds
    s_waitcnt lgkmcnt(8)
    v_mfma_f32_32x32x16_bf16 v[48:63], a[120:123], v[156:159], v[48:63]
    ds_read_b64_tr_b16 v[144:145], v122 offset:20480
    v_cvt_pk_bf16_f32 v166, v44, v45
    v_cvt_pk_bf16_f32 v167, v46, v47
    v_mfma_f32_32x32x16_bf16 v[64:79], a[124:127], v[156:159], v[64:79]
    ds_read_b64_tr_b16 v[146:147], v122 offset:20992
    v_pk_max_i16 v160, v160, 0
    v_pk_max_i16 v161, v161, 0
    s_add_u32 m0, m0, 4096
    v_add_u32 v127, 32768, v127
    buffer_load_dwordx4 v127, s[28:31], 0 offen offset:0  lds
    s_waitcnt lgkmcnt(8)
    v_mfma_f32_32x32x16_bf16 v[48:63], a[128:131], v[128:131], v[48:63]
    ds_read_b64_tr_b16 v[148:149], v122 offset:21504
    v_pk_max_i16 v162, v162, 0
    v_pk_max_i16 v163, v163, 0
    v_mfma_f32_32x32x16_bf16 v[64:79], a[132:135], v[128:131], v[64:79]
    ds_read_b64_tr_b16 v[150:151], v122 offset:22016
    v_pk_max_i16 v164, v164, 0
    v_pk_max_i16 v165, v165, 0
    buffer_load_dwordx4 v127, s[28:31], s58 offen offset:1024  lds
    buffer_load_dwordx2 v[168:169], v4, s[36:39], s56 offen offset:512 sc1
    s_waitcnt lgkmcnt(8)
    v_mfma_f32_32x32x16_bf16 v[48:63], a[136:139], v[132:135], v[48:63]
    ds_read_b64_tr_b16 v[152:153], v122 offset:22528
    v_pk_max_i16 v166, v166, 0
    v_pk_max_i16 v167, v167, 0
    v_mfma_f32_32x32x16_bf16 v[64:79], a[140:143], v[132:135], v[64:79]
    ds_read_b64_tr_b16 v[154:155], v122 offset:23040
    buffer_store_dwordx4 v[160:163], v183, s[36:39], s55 offen offset:0  nt
    buffer_store_dwordx4 v[164:167], v183, s[36:39], s55 offen offset:1024  nt
    buffer_load_dwordx4 v127, s[28:31], s59 offen offset:2048  lds
    s_waitcnt lgkmcnt(8)
    v_mfma_f32_32x32x16_bf16 v[48:63], a[144:147], v[136:139], v[48:63]
    ds_read_b64_tr_b16 v[156:157], v122 offset:23552
    v_mfma_f32_32x32x16_bf16 v[64:79], a[148:151], v[136:139], v[64:79]
    ds_read_b64_tr_b16 v[158:159], v122 offset:24064
    s_add_u32 m0, s74, 32768
    v_add_u32 v127, 196608, v127
    buffer_load_dwordx4 v127, s[28:31], 0 offen offset:0  lds
    s_waitcnt lgkmcnt(8)
    v_mfma_f32_32x32x16_bf16 v[48:63], a[152:155], v[140:143], v[48:63]
    ds_read_b64_tr_b16 v[128:129], v122 offset:24576
    v_mfma_f32_32x32x16_bf16 v[64:79], a[156:159], v[140:143], v[64:79]
    ds_read_b64_tr_b16 v[130:131], v122 offset:25088
    buffer_load_dwordx4 v127, s[28:31], s58 offen offset:1024  lds
    s_waitcnt lgkmcnt(8)
    v_mfma_f32_32x32x16_bf16 v[48:63], a[160:163], v[144:147], v[48:63]
    ds_read_b64_tr_b16 v[132:133], v122 offset:25600
    v_mfma_f32_32x32x16_bf16 v[64:79], a[164:167], v[144:147], v[64:79]
    ds_read_b64_tr_b16 v[134:135], v122 offset:26112
    buffer_load_dwordx4 v127, s[28:31], s59 offen offset:2048  lds
    s_waitcnt lgkmcnt(8)
    v_mfma_f32_32x32x16_bf16 v[48:63], a[168:171], v[148:151], v[48:63]
    ds_read_b64_tr_b16 v[136:137], v122 offset:26624
    v_mfma_f32_32x32x16_bf16 v[64:79], a[172:175], v[148:151], v[64:79]
    ds_read_b64_tr_b16 v[138:139], v122 offset:27136
    buffer_load_dwordx4 v127, s[28:31], s60 offen offset:3072  lds
    s_waitcnt lgkmcnt(8)
    v_mfma_f32_32x32x16_bf16 v[48:63], a[176:179], v[152:155], v[48:63]
    ds_read_b64_tr_b16 v[140:141], v122 offset:27648
    v_mfma_f32_32x32x16_bf16 v[64:79], a[180:183], v[152:155], v[64:79]
    ds_read_b64_tr_b16 v[142:143], v122 offset:28160
    s_add_u32 m0, m0, 4096
    v_add_u32 v127, 32768, v127
    buffer_load_dwordx4 v127, s[28:31], 0 offen offset:0  lds
    s_waitcnt lgkmcnt(8)
    v_mfma_f32_32x32x16_bf16 v[48:63], a[184:187], v[156:159], v[48:63]
    ds_read_b64_tr_b16 v[144:145], v122 offset:28672
    v_mfma_f32_32x32x16_bf16 v[64:79], a[188:191], v[156:159], v[64:79]
    ds_read_b64_tr_b16 v[146:147], v122 offset:29184
    buffer_load_dwordx4 v127, s[28:31], s58 offen offset:1024  lds
    s_waitcnt lgkmcnt(8)
    v_mfma_f32_32x32x16_bf16 v[48:63], a[192:195], v[128:131], v[48:63]
    ds_read_b64_tr_b16 v[148:149], v122 offset:29696
    v_mfma_f32_32x32x16_bf16 v[64:79], a[196:199], v[128:131], v[64:79]
    ds_read_b64_tr_b16 v[150:151], v122 offset:30208
    buffer_load_dwordx4 v127, s[28:31], s59 offen offset:2048  lds
    s_waitcnt lgkmcnt(8)
    v_mfma_f32_32x32x16_bf16 v[48:63], a[200:203], v[132:135], v[48:63]
    ds_read_b64_tr_b16 v[152:153], v122 offset:30720
    v_mfma_f32_32x32x16_bf16 v[64:79], a[204:207], v[132:135], v[64:79]
    ds_read_b64_tr_b16 v[154:155], v122 offset:31232
    s_waitcnt vmcnt(8)
    s_barrier
    s_add_u32 s54, s16, 11264
    s_cmp_lg_u32 s48, 0
    s_cbranch_scc1 Lf5
    v_mov_b32 v14, s49
    v_mov_b32 v15, 0
    s_mov_b64 exec, 1
    buffer_store_dword v14, v15, s[36:39], s54 offen
    s_mov_b64 exec, -1
Lf5:
    s_waitcnt lgkmcnt(8)
    v_mfma_f32_32x32x16_bf16 v[48:63], a[208:211], v[136:139], v[48:63]
    ds_read_b64_tr_b16 v[156:157], v122 offset:31744
    s_add_u32 m0, s74, 65536
    v_add_u32 v127, 196608, v127
    s_lshr_b32 s68, s48, 1
    s_mul_i32 s68, s68, 18432
    s_add_u32 m0, m0, s68
    s_nop 0
    buffer_load_dwordx4 v127, s[28:31], 0 offen offset:0  lds
    v_mfma_f32_32x32x16_bf16 v[64:79], a[212:215], v[136:139], v[64:79]
    ds_read_b64_tr_b16 v[158:159], v122 offset:32256
    buffer_load_dwordx4 v127, s[28:31], s58 offen offset:1024  lds
    s_waitcnt lgkmcnt(8)
    v_mfma_f32_32x32x16_bf16 v[48:63], a[216:219], v[140:143], v[48:63]
    buffer_load_dwordx4 v127, s[28:31], s59 offen offset:2048  lds
    v_mfma_f32_32x32x16_bf16 v[64:79], a[220:223], v[140:143], v[64:79]
    buffer_load_dwordx4 v127, s[28:31], s60 offen offset:3072  lds
    s_waitcnt lgkmcnt(6)
    v_mfma_f32_32x32x16_bf16 v[48:63], a[224:227], v[144:147], v[48:63]
    s_add_u32 m0, m0, 4096
    v_add_u32 v127, 32768, v127
    buffer_load_dwordx4 v127, s[28:31], 0 offen offset:0  lds
    v_mfma_f32_32x32x16_bf16 v[64:79], a[228:231], v[144:147], v[64:79]
    buffer_load_dwordx4 v127, s[28:31], s58 offen offset:1024  lds
    s_waitcnt lgkmcnt(4)
    v_mfma_f32_32x32x16_bf16 v[48:63], a[232:235], v[148:151], v[48:63]
    buffer_load_dwordx4 v127, s[28:31], s59 offen offset:2048  lds
    v_mfma_f32_32x32x16_bf16 v[64:79], a[236:239], v[148:151], v[64:79]
    s_waitcnt lgkmcnt(2)
    v_mfma_f32_32x32x16_bf16 v[48:63], a[240:243], v[152:155], v[48:63]
    v_mfma_f32_32x32x16_bf16 v[64:79], a[244:247], v[152:155], v[64:79]
    s_waitcnt lgkmcnt(0)
    v_mfma_f32_32x32x16_bf16 v[48:63], a[248:251], v[156:159], v[48:63]
    v_mfma_f32_32x32x16_bf16 v[64:79], a[252:255], v[156:159], v[64:79]
    s_waitcnt vmcnt(17)
    v_mov_b32 v124, v168
    v_mov_b32 v125, v169
    s_add_u32 s55, s55, 114688
    v_cmp_ne_u32 vcc, s49, v125
    s_cbranch_vccz Lm1ak
    s_mov_b32 s62, 0
    Lm1a:
    buffer_load_dwordx2 v[124:125], v4, s[36:39], s56 offen offset:512 sc1
    s_add_u32 s62, s62, 1
    s_cmp_gt_u32 s62, 1048576
    s_cbranch_scc1 Lm1ak
    s_waitcnt vmcnt(0)
    v_cmp_ne_u32 vcc, s49, v125
    s_cbranch_vccnz Lm1a
    Lm1ak:
    v_lshlrev_b32 v120, 16, v124
    v_xor_b32 v120, 0x80000000, v120
    buffer_load_dword v9, v178, s[36:39], s14 offen sc1
    s_nop 1
    v_fmac_f32 v48, v120, v80
    v_fmac_f32 v49, v120, v81
    v_fmac_f32 v50, v120, v82
    v_fmac_f32 v51, v120, v83
    v_fmac_f32 v52, v120, v84
    v_fmac_f32 v53, v120, v85
    v_fmac_f32 v54, v120, v86
    v_fmac_f32 v55, v120, v87
    v_fmac_f32 v56, v120, v88
    v_fmac_f32 v57, v120, v89
    v_fmac_f32 v58, v120, v90
    v_fmac_f32 v59, v120, v91
    v_fmac_f32 v60, v120, v92
    v_fmac_f32 v61, v120, v93
    v_fmac_f32 v62, v120, v94
    v_fmac_f32 v63, v120, v95
    v_cvt_pk_bf16_f32 v112, v48, v49
    v_cvt_pk_bf16_f32 v113, v50, v51
    v_cvt_pk_bf16_f32 v114, v52, v53
    v_cvt_pk_bf16_f32 v115, v54, v55
    v_cvt_pk_bf16_f32 v116, v56, v57
    v_cvt_pk_bf16_f32 v117, v58, v59
    v_cvt_pk_bf16_f32 v118, v60, v61
    v_cvt_pk_bf16_f32 v119, v62, v63
    v_pk_max_i16 v112, v112, 0
    v_pk_max_i16 v113, v113, 0
    v_pk_max_i16 v114, v114, 0
    v_pk_max_i16 v115, v115, 0
    v_pk_max_i16 v116, v116, 0
    v_pk_max_i16 v117, v117, 0
    v_pk_max_i16 v118, v118, 0
    v_pk_max_i16 v119, v119, 0
    buffer_store_dwordx4 v[112:115], v182, s[36:39], s55 offen offset:0  nt
    buffer_store_dwordx4 v[116:119], v182, s[36:39], s55 offen offset:1024  nt
    v_fmac_f32 v64, v120, v96
    v_fmac_f32 v65, v120, v97
    v_fmac_f32 v66, v120, v98
    v_fmac_f32 v67, v120, v99
    v_fmac_f32 v68, v120, v100
    v_fmac_f32 v69, v120, v101
    v_fmac_f32 v70, v120, v102
    v_fmac_f32 v71, v120, v103
    v_fmac_f32 v72, v120, v104
    v_fmac_f32 v73, v120, v105
    v_fmac_f32 v74, v120, v106
    v_fmac_f32 v75, v120, v107
    v_fmac_f32 v76, v120, v108
    v_fmac_f32 v77, v120, v109
    v_fmac_f32 v78, v120, v110
    v_fmac_f32 v79, v120, v111
    v_cvt_pk_bf16_f32 v160, v64, v65
    v_cvt_pk_bf16_f32 v161, v66, v67
    v_cvt_pk_bf16_f32 v162, v68, v69
    v_cvt_pk_bf16_f32 v163, v70, v71
    v_cvt_pk_bf16_f32 v164, v72, v73
    v_cvt_pk_bf16_f32 v165, v74, v75
    v_cvt_pk_bf16_f32 v166, v76, v77
    v_cvt_pk_bf16_f32 v167, v78, v79
    v_pk_max_i16 v160, v160, 0
    v_pk_max_i16 v161, v161, 0
    v_pk_max_i16 v162, v162, 0
    v_pk_max_i16 v163, v163, 0
    v_pk_max_i16 v164, v164, 0
    v_pk_max_i16 v165, v165, 0
    v_pk_max_i16 v166, v166, 0
    v_pk_max_i16 v167, v167, 0
    buffer_store_dwordx4 v[160:163], v183, s[36:39], s55 offen offset:0  nt
    buffer_store_dwordx4 v[164:167], v183, s[36:39], s55 offen offset:1024  nt
    s_add_u32 s54, s16, 6144
    v_mov_b32 v14, s49
    v_mov_b32 v15, 0
    s_waitcnt vmcnt(0)
    s_barrier
    s_cmp_lg_u32 s48, 3
    s_cbranch_scc1 Lnfa
    s_mov_b64 exec, 1
    buffer_store_dword v14, v15, s[36:39], s54 offen
    s_mov_b64 exec, -1
    Lnfa:
    v_cmp_eq_u32 vcc, s49, v9
    s_nop 0
    s_or_b32 s53, vcc_lo, vcc_hi
    s_and_b32 s53, s53, s73
    s_cmp_lg_u32 s53, s73
    s_cbranch_scc0 Lp3ad
    s_branch Lg2a
Lswa:
    s_lshl_b32 s52, s64, 17
    s_lshl_b32 s53, s48, 13
    s_add_u32 s52, s52, s53
    s_add_u32 s52, s52, 0x100000
    s_mov_b32 m0, s53
    s_nop 0
    buffer_load_dwordx4 v5, s[36:39], s52 offen offset:0 sc1 lds
    buffer_load_dwordx4 v5, s[36:39], s52 offen offset:1024 sc1 lds
    buffer_load_dwordx4 v5, s[36:39], s52 offen offset:2048 sc1 lds
    buffer_load_dwordx4 v5, s[36:39], s52 offen offset:3072 sc1 lds
    s_add_u32 m0, m0, 4096
    s_add_u32 s52, s52, 4096
    buffer_load_dwordx4 v5, s[36:39], s52 offen offset:0 sc1 lds
    buffer_load_dwordx4 v5, s[36:39], s52 offen offset:1024 sc1 lds
    buffer_load_dwordx4 v5, s[36:39], s52 offen offset:2048 sc1 lds
    buffer_load_dwordx4 v5, s[36:39], s52 offen offset:3072 sc1 lds
    s_add_u32 m0, m0, 28672
    s_add_u32 s52, s52, 28672
    buffer_load_dwordx4 v5, s[36:39], s52 offen offset:0 sc1 lds
    buffer_load_dwordx4 v5, s[36:39], s52 offen offset:1024 sc1 lds
    buffer_load_dwordx4 v5, s[36:39], s52 offen offset:2048 sc1 lds
    buffer_load_dwordx4 v5, s[36:39], s52 offen offset:3072 sc1 lds
    s_lshl_b32 s56, s97, 10
    s_add_u32 s56, s56, s75
    s_lshl_b32 s53, s72, 8
    s_add_u32 s56, s56, s53
    s_add_u32 s56, s56, 0xe0000
    v_and_b32 v8, 31, v1
    v_lshlrev_b32 v3, 3, v8
    v_lshlrev_b32 v7, 5, v8
    v_add_u32 v7, 159744, v7
    s_lshl_b32 s53, s48, 3
    v_add_u32 v6, s53, v7
    v_mov_b32 v4, 0x3f803f80
    s_lshl_b32 s53, s72, 10
    v_add_u32 v7, s53, v7
    v_mov_b32 v117, s49
    s_waitcnt vmcnt(4)
    ds_read_b64_tr_b16 v[48:49], v123 offset:0
    ds_read_b64_tr_b16 v[50:51], v123 offset:512
    ds_read_b64_tr_b16 v[52:53], v123 offset:1024
    ds_read_b64_tr_b16 v[54:55], v123 offset:1536
    ds_read_b64_tr_b16 v[56:57], v123 offset:2048
    ds_read_b64_tr_b16 v[58:59], v123 offset:2560
    ds_read_b64_tr_b16 v[60:61], v123 offset:3072
    ds_read_b64_tr_b16 v[62:63], v123 offset:3584
    ds_read_b64_tr_b16 v[64:65], v123 offset:4096
    ds_read_b64_tr_b16 v[66:67], v123 offset:4608
    ds_read_b64_tr_b16 v[68:69], v123 offset:5120
    ds_read_b64_tr_b16 v[70:71], v123 offset:5632
    s_waitcnt lgkmcnt(6)
    ds_read_b64_tr_b16 v[72:73], v123 offset:6144
    ds_read_b64_tr_b16 v[74:75], v123 offset:6656
    ds_read_b64_tr_b16 v[76:77], v123 offset:7168
    ds_read_b64_tr_b16 v[78:79], v123 offset:7680
    v_mov_b32 v106, 0
    v_mov_b32 v107, 0
    s_waitcnt lgkmcnt(8)
    v_dot2c_f32_bf16 v106, v48, v4
    v_dot2c_f32_bf16 v107, v48, v48
    v_dot2c_f32_bf16 v106, v49, v4
    v_dot2c_f32_bf16 v107, v49, v49
    v_dot2c_f32_bf16 v106, v50, v4
    v_dot2c_f32_bf16 v107, v50, v50
    s_add_u32 m0, m0, 4096
    s_add_u32 s52, s52, 4096
    buffer_load_dwordx4 v5, s[36:39], s52 offen offset:0 sc1 lds
    v_dot2c_f32_bf16 v106, v51, v4
    v_dot2c_f32_bf16 v107, v51, v51
    v_dot2c_f32_bf16 v106, v52, v4
    v_dot2c_f32_bf16 v107, v52, v52
    v_dot2c_f32_bf16 v106, v53, v4
    v_dot2c_f32_bf16 v107, v53, v53
    buffer_load_dwordx4 v5, s[36:39], s52 offen offset:1024 sc1 lds
    v_dot2c_f32_bf16 v106, v54, v4
    v_dot2c_f32_bf16 v107, v54, v54
    v_dot2c_f32_bf16 v106, v55, v4
    v_dot2c_f32_bf16 v107, v55, v55
    s_waitcnt lgkmcnt(4)
    v_dot2c_f32_bf16 v106, v56, v4
    v_dot2c_f32_bf16 v107, v56, v56
    buffer_load_dwordx4 v5, s[36:39], s52 offen offset:2048 sc1 lds
    v_dot2c_f32_bf16 v106, v57, v4
    v_dot2c_f32_bf16 v107, v57, v57
    v_dot2c_f32_bf16 v106, v58, v4
    v_dot2c_f32_bf16 v107, v58, v58
    v_dot2c_f32_bf16 v106, v59, v4
    v_dot2c_f32_bf16 v107, v59, v59
    buffer_load_dwordx4 v5, s[36:39], s52 offen offset:3072 sc1 lds
    v_dot2c_f32_bf16 v106, v60, v4
    v_dot2c_f32_bf16 v107, v60, v60
    v_dot2c_f32_bf16 v106, v61, v4
    v_dot2c_f32_bf16 v107, v61, v61
    v_dot2c_f32_bf16 v106, v62, v4
    v_dot2c_f32_bf16 v107, v62, v62
    s_add_u32 m0, m0, 28672
    s_add_u32 s52, s52, 28672
    buffer_load_dwordx4 v5, s[36:39], s52 offen offset:0 sc1 lds
    v_dot2c_f32_bf16 v106, v63, v4
    v_dot2c_f32_bf16 v107, v63, v63
    s_waitcnt lgkmcnt(0)
    v_dot2c_f32_bf16 v106, v64, v4
    v_dot2c_f32_bf16 v107, v64, v64
    v_dot2c_f32_bf16 v106, v65, v4
    v_dot2c_f32_bf16 v107, v65, v65
    buffer_load_dwordx4 v5, s[36:39], s52 offen offset:1024 sc1 lds
    v_dot2c_f32_bf16 v106, v66, v4
    v_dot2c_f32_bf16 v107, v66, v66
    v_dot2c_f32_bf16 v106, v67, v4
    v_dot2c_f32_bf16 v107, v67, v67
    v_dot2c_f32_bf16 v106, v68, v4
    v_dot2c_f32_bf16 v107, v68, v68
    buffer_load_dwordx4 v5, s[36:39], s52 offen offset:2048 sc1 lds
    v_dot2c_f32_bf16 v106, v69, v4
    v_dot2c_f32_bf16 v107, v69, v69
    v_dot2c_f32_bf16 v106, v70, v4
    v_dot2c_f32_bf16 v107, v70, v70
    v_dot2c_f32_bf16 v106, v71, v4
    v_dot2c_f32_bf16 v107, v71, v71
    buffer_load_dwordx4 v5, s[36:39], s52 offen offset:3072 sc1 lds
    s_waitcnt lgkmcnt(0)
    v_dot2c_f32_bf16 v106, v72, v4
    v_dot2c_f32_bf16 v107, v72, v72
    v_dot2c_f32_bf16 v106, v73, v4
    v_dot2c_f32_bf16 v107, v73, v73
    v_dot2c_f32_bf16 v106, v74, v4
    v_dot2c_f32_bf16 v107, v74, v74
    s_add_u32 m0, m0, 4096
    s_add_u32 s52, s52, 4096
    buffer_load_dwordx4 v5, s[36:39], s52 offen offset:0 sc1 lds
    v_dot2c_f32_bf16 v106, v75, v4
    v_dot2c_f32_bf16 v107, v75, v75
    v_dot2c_f32_bf16 v106, v76, v4
    v_dot2c_f32_bf16 v107, v76, v76
    v_dot2c_f32_bf16 v106, v77, v4
    v_dot2c_f32_bf16 v107, v77, v77
    buffer_load_dwordx4 v5, s[36:39], s52 offen offset:1024 sc1 lds
    v_dot2c_f32_bf16 v106, v78, v4
    v_dot2c_f32_bf16 v107, v78, v78
    v_dot2c_f32_bf16 v106, v79, v4
    v_dot2c_f32_bf16 v107, v79, v79
    s_nop 2
    v_mov_b32 v108, v106
    v_mov_b32 v109, v107
    s_nop 1
    v_permlane32_swap_b32 v106, v108
    v_permlane32_swap_b32 v107, v109
    s_nop 1
    v_add_f32 v106, v106, v108
    v_add_f32 v107, v107, v109
    ds_write_b64 v6, v[106:107] offset:0
    s_waitcnt vmcnt(6)
    ds_read_b64_tr_b16 v[48:49], v123 offset:32768
    ds_read_b64_tr_b16 v[50:51], v123 offset:33280
    ds_read_b64_tr_b16 v[52:53], v123 offset:33792
    ds_read_b64_tr_b16 v[54:55], v123 offset:34304
    ds_read_b64_tr_b16 v[56:57], v123 offset:34816
    ds_read_b64_tr_b16 v[58:59], v123 offset:35328
    ds_read_b64_tr_b16 v[60:61], v123 offset:35840
    ds_read_b64_tr_b16 v[62:63], v123 offset:36352
    ds_read_b64_tr_b16 v[64:65], v123 offset:36864
    ds_read_b64_tr_b16 v[66:67], v123 offset:37376
    ds_read_b64_tr_b16 v[68:69], v123 offset:37888
    ds_read_b64_tr_b16 v[70:71], v123 offset:38400
    s_waitcnt lgkmcnt(6)
    ds_read_b64_tr_b16 v[72:73], v123 offset:38912
    ds_read_b64_tr_b16 v[74:75], v123 offset:39424
    ds_read_b64_tr_b16 v[76:77], v123 offset:39936
    ds_read_b64_tr_b16 v[78:79], v123 offset:40448
    v_mov_b32 v106, 0
    v_mov_b32 v107, 0
    s_waitcnt lgkmcnt(8)
    v_dot2c_f32_bf16 v106, v48, v4
    v_dot2c_f32_bf16 v107, v48, v48
    v_dot2c_f32_bf16 v106, v49, v4
    v_dot2c_f32_bf16 v107, v49, v49
    v_dot2c_f32_bf16 v106, v50, v4
    v_dot2c_f32_bf16 v107, v50, v50
    buffer_load_dwordx4 v5, s[36:39], s52 offen offset:2048 sc1 lds
    v_dot2c_f32_bf16 v106, v51, v4
    v_dot2c_f32_bf16 v107, v51, v51
    v_dot2c_f32_bf16 v106, v52, v4
    v_dot2c_f32_bf16 v107, v52, v52
    v_dot2c_f32_bf16 v106, v53, v4
    v_dot2c_f32_bf16 v107, v53, v53
    buffer_load_dwordx4 v5, s[36:39], s52 offen offset:3072 sc1 lds
    v_dot2c_f32_bf16 v106, v54, v4
    v_dot2c_f32_bf16 v107, v54, v54
    v_dot2c_f32_bf16 v106, v55, v4
    v_dot2c_f32_bf16 v107, v55, v55
    s_waitcnt lgkmcnt(4)
    v_dot2c_f32_bf16 v106, v56, v4
    v_dot2c_f32_bf16 v107, v56, v56
    s_add_u32 m0, m0, 28672
    s_add_u32 s52, s52, 28672
    buffer_load_dwordx4 v5, s[36:39], s52 offen offset:0 sc1 lds
    v_dot2c_f32_bf16 v106, v57, v4
    v_dot2c_f32_bf16 v107, v57, v57
    v_dot2c_f32_bf16 v106, v58, v4
    v_dot2c_f32_bf16 v107, v58, v58
    v_dot2c_f32_bf16 v106, v59, v4
    v_dot2c_f32_bf16 v107, v59, v59
    buffer_load_dwordx4 v5, s[36:39], s52 offen offset:1024 sc1 lds
    v_dot2c_f32_bf16 v106, v60, v4
    v_dot2c_f32_bf16 v107, v60, v60
    v_dot2c_f32_bf16 v106, v61, v4
    v_dot2c_f32_bf16 v107, v61, v61
    v_dot2c_f32_bf16 v106, v62, v4
    v_dot2c_f32_bf16 v107, v62, v62
    buffer_load_dwordx4 v5, s[36:39], s52 offen offset:2048 sc1 lds
    v_dot2c_f32_bf16 v106, v63, v4
    v_dot2c_f32_bf16 v107, v63, v63
    s_waitcnt lgkmcnt(0)
    v_dot2c_f32_bf16 v106, v64, v4
    v_dot2c_f32_bf16 v107, v64, v64
    v_dot2c_f32_bf16 v106, v65, v4
    v_dot2c_f32_bf16 v107, v65, v65
    buffer_load_dwordx4 v5, s[36:39], s52 offen offset:3072 sc1 lds
    v_dot2c_f32_bf16 v106, v66, v4
    v_dot2c_f32_bf16 v107, v66, v66
    v_dot2c_f32_bf16 v106, v67, v4
    v_dot2c_f32_bf16 v107, v67, v67
    v_dot2c_f32_bf16 v106, v68, v4
    v_dot2c_f32_bf16 v107, v68, v68
    s_add_u32 m0, m0, 4096
    s_add_u32 s52, s52, 4096
    buffer_load_dwordx4 v5, s[36:39], s52 offen offset:0 sc1 lds
    v_dot2c_f32_bf16 v106, v69, v4
    v_dot2c_f32_bf16 v107, v69, v69
    v_dot2c_f32_bf16 v106, v70, v4
    v_dot2c_f32_bf16 v107, v70, v70
    v_dot2c_f32_bf16 v106, v71, v4
    v_dot2c_f32_bf16 v107, v71, v71
    buffer_load_dwordx4 v5, s[36:39], s52 offen offset:1024 sc1 lds
    s_waitcnt lgkmcnt(0)
    v_dot2c_f32_bf16 v106, v72, v4
    v_dot2c_f32_bf16 v107, v72, v72
    v_dot2c_f32_bf16 v106, v73, v4
    v_dot2c_f32_bf16 v107, v73, v73
    v_dot2c_f32_bf16 v106, v74, v4
    v_dot2c_f32_bf16 v107, v74, v74
    v_dot2c_f32_bf16 v106, v75, v4
    v_dot2c_f32_bf16 v107, v75, v75
    v_dot2c_f32_bf16 v106, v76, v4
    v_dot2c_f32_bf16 v107, v76, v76
    v_dot2c_f32_bf16 v106, v77, v4
    v_dot2c_f32_bf16 v107, v77, v77
    v_dot2c_f32_bf16 v106, v78, v4
    v_dot2c_f32_bf16 v107, v78, v78
    v_dot2c_f32_bf16 v106, v79, v4
    v_dot2c_f32_bf16 v107, v79, v79
    s_nop 2
    v_mov_b32 v108, v106
    v_mov_b32 v109, v107
    s_nop 1
    v_permlane32_swap_b32 v106, v108
    v_permlane32_swap_b32 v107, v109
    s_nop 1
    v_add_f32 v106, v106, v108
    v_add_f32 v107, v107, v109
    ds_write_b64 v6, v[106:107] offset:1024
    s_waitcnt lgkmcnt(0)
    s_barrier
    ds_read_b128 v[108:111], v7 offset:0
    ds_read_b128 v[112:115], v7 offset:16
    s_waitcnt lgkmcnt(0)
    v_pk_add_f32 v[108:109], v[108:109], v[110:111]
    v_pk_add_f32 v[112:113], v[112:113], v[114:115]
    v_pk_add_f32 v[108:109], v[108:109], v[112:113]
    v_mul_f32 v108, 0x3b000000, v108
    v_mul_f32 v109, 0x3b000000, v109
    v_fma_f32 v109, -v108, v108, v109
    v_max_f32 v109, 0, v109
    v_cvt_pk_bf16_f32 v109, v109, v109
    v_lshlrev_b32 v109, 16, v109
    v_add_f32 v109, 0x3727c5ac, v109
    v_cvt_pk_bf16_f32 v109, v109, v109
    v_lshlrev_b32 v109, 16, v109
    v_sqrt_f32 v109, v109
    s_nop 0
    v_cvt_pk_bf16_f32 v116, v108, v109
    buffer_store_dwordx2 v[116:117], v3, s[36:39], s56 offen offset:0
    s_waitcnt vmcnt(6)
    v_add_u32 v123, 0x10000, v123
    ds_read_b64_tr_b16 v[48:49], v123 offset:0
    ds_read_b64_tr_b16 v[50:51], v123 offset:512
    ds_read_b64_tr_b16 v[52:53], v123 offset:1024
    ds_read_b64_tr_b16 v[54:55], v123 offset:1536
    ds_read_b64_tr_b16 v[56:57], v123 offset:2048
    ds_read_b64_tr_b16 v[58:59], v123 offset:2560
    ds_read_b64_tr_b16 v[60:61], v123 offset:3072
    ds_read_b64_tr_b16 v[62:63], v123 offset:3584
    ds_read_b64_tr_b16 v[64:65], v123 offset:4096
    ds_read_b64_tr_b16 v[66:67], v123 offset:4608
    ds_read_b64_tr_b16 v[68:69], v123 offset:5120
    ds_read_b64_tr_b16 v[70:71], v123 offset:5632
    s_waitcnt lgkmcnt(6)
    ds_read_b64_tr_b16 v[72:73], v123 offset:6144
    ds_read_b64_tr_b16 v[74:75], v123 offset:6656
    ds_read_b64_tr_b16 v[76:77], v123 offset:7168
    ds_read_b64_tr_b16 v[78:79], v123 offset:7680
    v_mov_b32 v106, 0
    v_mov_b32 v107, 0
    s_waitcnt lgkmcnt(8)
    v_dot2c_f32_bf16 v106, v48, v4
    v_dot2c_f32_bf16 v107, v48, v48
    v_dot2c_f32_bf16 v106, v49, v4
    v_dot2c_f32_bf16 v107, v49, v49
    v_dot2c_f32_bf16 v106, v50, v4
    v_dot2c_f32_bf16 v107, v50, v50
    buffer_load_dwordx4 v5, s[36:39], s52 offen offset:2048 sc1 lds
    v_dot2c_f32_bf16 v106, v51, v4
    v_dot2c_f32_bf16 v107, v51, v51
    v_dot2c_f32_bf16 v106, v52, v4
    v_dot2c_f32_bf16 v107, v52, v52
    v_dot2c_f32_bf16 v106, v53, v4
    v_dot2c_f32_bf16 v107, v53, v53
    buffer_load_dwordx4 v5, s[36:39], s52 offen offset:3072 sc1 lds
    v_dot2c_f32_bf16 v106, v54, v4
    v_dot2c_f32_bf16 v107, v54, v54
    v_dot2c_f32_bf16 v106, v55, v4
    v_dot2c_f32_bf16 v107, v55, v55
    s_waitcnt lgkmcnt(4)
    v_dot2c_f32_bf16 v106, v56, v4
    v_dot2c_f32_bf16 v107, v56, v56
    v_dot2c_f32_bf16 v106, v57, v4
    v_dot2c_f32_bf16 v107, v57, v57
    v_dot2c_f32_bf16 v106, v58, v4
    v_dot2c_f32_bf16 v107, v58, v58
    v_dot2c_f32_bf16 v106, v59, v4
    v_dot2c_f32_bf16 v107, v59, v59
    v_dot2c_f32_bf16 v106, v60, v4
    v_dot2c_f32_bf16 v107, v60, v60
    v_dot2c_f32_bf16 v106, v61, v4
    v_dot2c_f32_bf16 v107, v61, v61
    v_dot2c_f32_bf16 v106, v62, v4
    v_dot2c_f32_bf16 v107, v62, v62
    v_dot2c_f32_bf16 v106, v63, v4
    v_dot2c_f32_bf16 v107, v63, v63
    s_waitcnt lgkmcnt(0)
    v_dot2c_f32_bf16 v106, v64, v4
    v_dot2c_f32_bf16 v107, v64, v64
    v_dot2c_f32_bf16 v106, v65, v4
    v_dot2c_f32_bf16 v107, v65, v65
    v_dot2c_f32_bf16 v106, v66, v4
    v_dot2c_f32_bf16 v107, v66, v66
    v_dot2c_f32_bf16 v106, v67, v4
    v_dot2c_f32_bf16 v107, v67, v67
    v_dot2c_f32_bf16 v106, v68, v4
    v_dot2c_f32_bf16 v107, v68, v68
    v_dot2c_f32_bf16 v106, v69, v4
    v_dot2c_f32_bf16 v107, v69, v69
    v_dot2c_f32_bf16 v106, v70, v4
    v_dot2c_f32_bf16 v107, v70, v70
    v_dot2c_f32_bf16 v106, v71, v4
    v_dot2c_f32_bf16 v107, v71, v71
    s_waitcnt lgkmcnt(0)
    v_dot2c_f32_bf16 v106, v72, v4
    v_dot2c_f32_bf16 v107, v72, v72
    v_dot2c_f32_bf16 v106, v73, v4
    v_dot2c_f32_bf16 v107, v73, v73
    v_dot2c_f32_bf16 v106, v74, v4
    v_dot2c_f32_bf16 v107, v74, v74
    v_dot2c_f32_bf16 v106, v75, v4
    v_dot2c_f32_bf16 v107, v75, v75
    v_dot2c_f32_bf16 v106, v76, v4
    v_dot2c_f32_bf16 v107, v76, v76
    v_dot2c_f32_bf16 v106, v77, v4
    v_dot2c_f32_bf16 v107, v77, v77
    v_dot2c_f32_bf16 v106, v78, v4
    v_dot2c_f32_bf16 v107, v78, v78
    v_dot2c_f32_bf16 v106, v79, v4
    v_dot2c_f32_bf16 v107, v79, v79
    s_nop 2
    v_mov_b32 v108, v106
    v_mov_b32 v109, v107
    s_nop 1
    v_permlane32_swap_b32 v106, v108
    v_permlane32_swap_b32 v107, v109
    s_nop 1
    v_add_f32 v106, v106, v108
    v_add_f32 v107, v107, v109
    ds_write_b64 v6, v[106:107] offset:2048
    s_waitcnt vmcnt(0)
    ds_read_b64_tr_b16 v[48:49], v123 offset:32768
    ds_read_b64_tr_b16 v[50:51], v123 offset:33280
    ds_read_b64_tr_b16 v[52:53], v123 offset:33792
    ds_read_b64_tr_b16 v[54:55], v123 offset:34304
    ds_read_b64_tr_b16 v[56:57], v123 offset:34816
    ds_read_b64_tr_b16 v[58:59], v123 offset:35328
    ds_read_b64_tr_b16 v[60:61], v123 offset:35840
    ds_read_b64_tr_b16 v[62:63], v123 offset:36352
    ds_read_b64_tr_b16 v[64:65], v123 offset:36864
    ds_read_b64_tr_b16 v[66:67], v123 offset:37376
    ds_read_b64_tr_b16 v[68:69], v123 offset:37888
    ds_read_b64_tr_b16 v[70:71], v123 offset:38400
    s_waitcnt lgkmcnt(6)
    ds_read_b64_tr_b16 v[72:73], v123 offset:38912
    ds_read_b64_tr_b16 v[74:75], v123 offset:39424
    ds_read_b64_tr_b16 v[76:77], v123 offset:39936
    ds_read_b64_tr_b16 v[78:79], v123 offset:40448
    v_mov_b32 v106, 0
    v_mov_b32 v107, 0
    s_waitcnt lgkmcnt(8)
    v_dot2c_f32_bf16 v106, v48, v4
    v_dot2c_f32_bf16 v107, v48, v48
    v_dot2c_f32_bf16 v106, v49, v4
    v_dot2c_f32_bf16 v107, v49, v49
    v_dot2c_f32_bf16 v106, v50, v4
    v_dot2c_f32_bf16 v107, v50, v50
    v_dot2c_f32_bf16 v106, v51, v4
    v_dot2c_f32_bf16 v107, v51, v51
    v_dot2c_f32_bf16 v106, v52, v4
    v_dot2c_f32_bf16 v107, v52, v52
    v_dot2c_f32_bf16 v106, v53, v4
    v_dot2c_f32_bf16 v107, v53, v53
    v_dot2c_f32_bf16 v106, v54, v4
    v_dot2c_f32_bf16 v107, v54, v54
    v_dot2c_f32_bf16 v106, v55, v4
    v_dot2c_f32_bf16 v107, v55, v55
    s_waitcnt lgkmcnt(4)
    v_dot2c_f32_bf16 v106, v56, v4
    v_dot2c_f32_bf16 v107, v56, v56
    v_dot2c_f32_bf16 v106, v57, v4
    v_dot2c_f32_bf16 v107, v57, v57
    v_dot2c_f32_bf16 v106, v58, v4
    v_dot2c_f32_bf16 v107, v58, v58
    v_dot2c_f32_bf16 v106, v59, v4
    v_dot2c_f32_bf16 v107, v59, v59
    v_dot2c_f32_bf16 v106, v60, v4
    v_dot2c_f32_bf16 v107, v60, v60
    v_dot2c_f32_bf16 v106, v61, v4
    v_dot2c_f32_bf16 v107, v61, v61
    v_dot2c_f32_bf16 v106, v62, v4
    v_dot2c_f32_bf16 v107, v62, v62
    v_dot2c_f32_bf16 v106, v63, v4
    v_dot2c_f32_bf16 v107, v63, v63
    s_waitcnt lgkmcnt(0)
    v_dot2c_f32_bf16 v106, v64, v4
    v_dot2c_f32_bf16 v107, v64, v64
    v_dot2c_f32_bf16 v106, v65, v4
    v_dot2c_f32_bf16 v107, v65, v65
    v_dot2c_f32_bf16 v106, v66, v4
    v_dot2c_f32_bf16 v107, v66, v66
    v_dot2c_f32_bf16 v106, v67, v4
    v_dot2c_f32_bf16 v107, v67, v67
    v_dot2c_f32_bf16 v106, v68, v4
    v_dot2c_f32_bf16 v107, v68, v68
    v_dot2c_f32_bf16 v106, v69, v4
    v_dot2c_f32_bf16 v107, v69, v69
    v_dot2c_f32_bf16 v106, v70, v4
    v_dot2c_f32_bf16 v107, v70, v70
    v_dot2c_f32_bf16 v106, v71, v4
    v_dot2c_f32_bf16 v107, v71, v71
    s_waitcnt lgkmcnt(0)
    v_dot2c_f32_bf16 v106, v72, v4
    v_dot2c_f32_bf16 v107, v72, v72
    v_dot2c_f32_bf16 v106, v73, v4
    v_dot2c_f32_bf16 v107, v73, v73
    v_dot2c_f32_bf16 v106, v74, v4
    v_dot2c_f32_bf16 v107, v74, v74
    v_dot2c_f32_bf16 v106, v75, v4
    v_dot2c_f32_bf16 v107, v75, v75
    v_dot2c_f32_bf16 v106, v76, v4
    v_dot2c_f32_bf16 v107, v76, v76
    v_dot2c_f32_bf16 v106, v77, v4
    v_dot2c_f32_bf16 v107, v77, v77
    v_dot2c_f32_bf16 v106, v78, v4
    v_dot2c_f32_bf16 v107, v78, v78
    v_dot2c_f32_bf16 v106, v79, v4
    v_dot2c_f32_bf16 v107, v79, v79
    s_nop 2
    v_mov_b32 v108, v106
    v_mov_b32 v109, v107
    s_nop 1
    v_permlane32_swap_b32 v106, v108
    v_permlane32_swap_b32 v107, v109
    s_nop 1
    v_add_f32 v106, v106, v108
    v_add_f32 v107, v107, v109
    ds_write_b64 v6, v[106:107] offset:3072
    s_waitcnt lgkmcnt(0)
    s_barrier
    ds_read_b128 v[108:111], v7 offset:2048
    ds_read_b128 v[112:115], v7 offset:2064
    s_waitcnt lgkmcnt(0)
    v_pk_add_f32 v[108:109], v[108:109], v[110:111]
    v_pk_add_f32 v[112:113], v[112:113], v[114:115]
    v_pk_add_f32 v[108:109], v[108:109], v[112:113]
    v_mul_f32 v108, 0x3b000000, v108
    v_mul_f32 v109, 0x3b000000, v109
    v_fma_f32 v109, -v108, v108, v109
    v_max_f32 v109, 0, v109
    v_cvt_pk_bf16_f32 v109, v109, v109
    v_lshlrev_b32 v109, 16, v109
    v_add_f32 v109, 0x3727c5ac, v109
    v_cvt_pk_bf16_f32 v109, v109, v109
    v_lshlrev_b32 v109, 16, v109
    v_sqrt_f32 v109, v109
    s_nop 0
    v_cvt_pk_bf16_f32 v116, v108, v109
    buffer_store_dwordx2 v[116:117], v3, s[36:39], s56 offen offset:512
    s_mul_i32 s53, s47, 12288
    s_mul_i32 s54, s48, 3072
    s_add_u32 s53, s53, s54
    s_add_u32 s53, s53, s75
    s_add_u32 s53, s53, 0x80000
    v_min_u32 v8, 23, v1
    v_lshlrev_b32 v8, 7, v8
    buffer_load_dword v200, v8, s[36:39], s53 offen
    s_barrier
    s_add_u32 m0, s74, 131072
    s_nop 0
    buffer_load_dwordx4 v127, s[28:31], 0 offen offset:0  lds
    buffer_load_dwordx4 v127, s[28:31], s58 offen offset:1024  lds
    buffer_load_dwordx4 v127, s[28:31], s59 offen offset:2048  lds
    buffer_load_dwordx4 v127, s[28:31], s60 offen offset:3072  lds
    s_add_u32 m0, m0, 4096
    v_add_u32 v127, 32768, v127
    buffer_load_dwordx4 v127, s[28:31], 0 offen offset:0  lds
    buffer_load_dwordx4 v127, s[28:31], s58 offen offset:1024  lds
    buffer_load_dwordx4 v127, s[28:31], s59 offen offset:2048  lds
    s_add_u32 m0, s74, 0
    v_add_u32 v127, 196608, v127
    buffer_load_dwordx4 v127, s[28:31], 0 offen offset:0  lds
    buffer_load_dwordx4 v127, s[28:31], s58 offen offset:1024  lds
    buffer_load_dwordx4 v127, s[28:31], s59 offen offset:2048  lds
    buffer_load_dwordx4 v127, s[28:31], s60 offen offset:3072  lds
    s_add_u32 m0, m0, 4096
    v_add_u32 v127, 32768, v127
    buffer_load_dwordx4 v127, s[28:31], 0 offen offset:0  lds
    buffer_load_dwordx4 v127, s[28:31], s58 offen offset:1024  lds
    buffer_load_dwordx4 v127, s[28:31], s59 offen offset:2048  lds
    s_add_u32 m0, s74, 32768
    v_add_u32 v127, 196608, v127
    buffer_load_dwordx4 v127, s[28:31], 0 offen offset:0  lds
    buffer_load_dwordx4 v127, s[28:31], s58 offen offset:1024  lds
    buffer_load_dwordx4 v127, s[28:31], s59 offen offset:2048  lds
    buffer_load_dwordx4 v127, s[28:31], s60 offen offset:3072  lds
    s_add_u32 m0, m0, 4096
    v_add_u32 v127, 32768, v127
    buffer_load_dwordx4 v127, s[28:31], 0 offen offset:0  lds
    buffer_load_dwordx4 v127, s[28:31], s58 offen offset:1024  lds
    buffer_load_dwordx4 v127, s[28:31], s59 offen offset:2048  lds
    s_add_u32 m0, s74, 65536
    v_add_u32 v127, 196608, v127
    s_lshr_b32 s68, s48, 1
    s_mul_i32 s68, s68, 18432
    s_add_u32 m0, m0, s68
    s_nop 0
    buffer_load_dwordx4 v127, s[28:31], 0 offen offset:0  lds
    buffer_load_dwordx4 v127, s[28:31], s58 offen offset:1024  lds
    buffer_load_dwordx4 v127, s[28:31], s59 offen offset:2048  lds
    buffer_load_dwordx4 v127, s[28:31], s60 offen offset:3072  lds
    s_add_u32 m0, m0, 4096
    v_add_u32 v127, 32768, v127
    buffer_load_dwordx4 v127, s[28:31], 0 offen offset:0  lds
    buffer_load_dwordx4 v127, s[28:31], s58 offen offset:1024  lds
    buffer_load_dwordx4 v127, s[28:31], s59 offen offset:2048  lds
    s_waitcnt vmcnt(0)
    s_barrier
Lg2a:
    s_mov_b32 s62, 0
Lp3a:
    s_add_u32 s62, s62, 1
    buffer_load_dword v9, v178, s[36:39], s14 offen sc1
    s_cmp_gt_u32 s62, 1048576
    s_cbranch_scc1 Lp3ad
    s_waitcnt vmcnt(0)
    v_cmp_eq_u32 vcc, s49, v9
    s_nop 0
    s_or_b32 s53, vcc_lo, vcc_hi
    s_and_b32 s53, s53, s73
    s_cmp_lg_u32 s53, s73
    s_cbranch_scc1 Lp3a
Lp3ad:
    buffer_load_dwordx4 a[0:3], v5, s[36:39], s13 offen offset:0 sc1
    buffer_load_dwordx4 a[4:7], v5, s[36:39], s13 offen offset:1024 sc1
    buffer_load_dwordx4 a[8:11], v5, s[36:39], s13 offen offset:2048 sc1
    buffer_load_dwordx4 a[12:15], v5, s[36:39], s13 offen offset:3072 sc1
    s_add_u32 s13, s13, 4096
    buffer_load_dwordx4 a[16:19], v5, s[36:39], s13 offen offset:0 sc1
    buffer_load_dwordx4 a[20:23], v5, s[36:39], s13 offen offset:1024 sc1
    buffer_load_dwordx4 a[24:27], v5, s[36:39], s13 offen offset:2048 sc1
    buffer_load_dwordx4 a[28:31], v5, s[36:39], s13 offen offset:3072 sc1
    s_add_u32 s13, s13, 4096
    buffer_load_dwordx4 a[32:35], v5, s[36:39], s13 offen offset:0 sc1
    buffer_load_dwordx4 a[36:39], v5, s[36:39], s13 offen offset:1024 sc1
    buffer_load_dwordx4 a[40:43], v5, s[36:39], s13 offen offset:2048 sc1
    buffer_load_dwordx4 a[44:47], v5, s[36:39], s13 offen offset:3072 sc1
    ds_read_b64_tr_b16 v[128:129], v172 offset:0
    ds_read_b64_tr_b16 v[130:131], v172 offset:1024
    ds_read_b64_tr_b16 v[132:133], v172 offset:2048
    ds_read_b64_tr_b16 v[134:135], v172 offset:3072
    ds_read_b64_tr_b16 v[136:137], v172 offset:4096
    ds_read_b64_tr_b16 v[138:139], v172 offset:5120
    ds_read_b64_tr_b16 v[140:141], v172 offset:6144
    ds_read_b64_tr_b16 v[142:143], v172 offset:7168
    ds_read_b64_tr_b16 v[144:145], v172 offset:8192
    ds_read_b64_tr_b16 v[146:147], v172 offset:9216
    s_waitcnt vmcnt(11)
    s_waitcnt lgkmcnt(8)
    v_mfma_f32_32x32x16_bf16 v[16:31], v[128:131], a[0:3], 0
    ds_read_b64_tr_b16 v[148:149], v172 offset:10240
    ds_read_b64_tr_b16 v[150:151], v172 offset:11264
    s_add_u32 s13, s13, 4096
    buffer_load_dwordx4 a[48:51], v5, s[36:39], s13 offen offset:0 sc1
    s_mov_b32 m0, s57
    s_nop 0
    buffer_load_dwordx4 v5, s[36:39], s11 offen sc1 lds
    s_waitcnt vmcnt(12)
    s_waitcnt lgkmcnt(8)
    v_mfma_f32_32x32x16_bf16 v[16:31], v[132:135], a[4:7], v[16:31]
    ds_read_b64_tr_b16 v[152:153], v172 offset:12288
    ds_read_b64_tr_b16 v[154:155], v172 offset:13312
    buffer_load_dwordx4 a[52:55], v5, s[36:39], s13 offen offset:1024 sc1
    buffer_load_dwordx4 v5, s[36:39], s11 offen offset:1024 sc1 lds
    s_waitcnt vmcnt(13)
    s_waitcnt lgkmcnt(8)
    v_mfma_f32_32x32x16_bf16 v[16:31], v[136:139], a[8:11], v[16:31]
    ds_read_b64_tr_b16 v[156:157], v172 offset:14336
    ds_read_b64_tr_b16 v[158:159], v172 offset:15360
    buffer_load_dwordx4 a[56:59], v5, s[36:39], s13 offen offset:2048 sc1
    buffer_load_dwordx2 v[96:97], v171, s[36:39], s12 offen sc1
    s_waitcnt vmcnt(14)
    s_waitcnt lgkmcnt(8)
    v_mfma_f32_32x32x16_bf16 v[16:31], v[140:143], a[12:15], v[16:31]
    ds_read_b64_tr_b16 v[128:129], v172 offset:16384
    ds_read_b64_tr_b16 v[130:131], v172 offset:17408
    buffer_load_dwordx4 a[60:63], v5, s[36:39], s13 offen offset:3072 sc1
    s_waitcnt vmcnt(14)
    s_waitcnt lgkmcnt(8)
    v_mfma_f32_32x32x16_bf16 v[16:31], v[144:147], a[16:19], v[16:31]
    ds_read_b64_tr_b16 v[132:133], v172 offset:18432
    ds_read_b64_tr_b16 v[134:135], v172 offset:19456
    s_add_u32 s13, s13, 4096
    buffer_load_dwordx4 a[64:67], v5, s[36:39], s13 offen offset:0 sc1
    s_waitcnt vmcnt(14)
    s_waitcnt lgkmcnt(8)
    v_mfma_f32_32x32x16_bf16 v[16:31], v[148:151], a[20:23], v[16:31]
    ds_read_b64_tr_b16 v[136:137], v172 offset:20480
    ds_read_b64_tr_b16 v[138:139], v172 offset:21504
    buffer_load_dwordx4 a[68:71], v5, s[36:39], s13 offen offset:1024 sc1
    s_waitcnt vmcnt(14)
    s_waitcnt lgkmcnt(8)
    v_mfma_f32_32x32x16_bf16 v[16:31], v[152:155], a[24:27], v[16:31]
    ds_read_b64_tr_b16 v[140:141], v172 offset:22528
    ds_read_b64_tr_b16 v[142:143], v172 offset:23552
    buffer_load_dwordx4 a[72:75], v5, s[36:39], s13 offen offset:2048 sc1
    s_waitcnt vmcnt(14)
    s_waitcnt lgkmcnt(8)
    v_mfma_f32_32x32x16_bf16 v[16:31], v[156:159], a[28:31], v[16:31]
    ds_read_b64_tr_b16 v[144:145], v172 offset:24576
    ds_read_b64_tr_b16 v[146:147], v172 offset:25600
    buffer_load_dwordx4 a[76:79], v5, s[36:39], s13 offen offset:3072 sc1
    s_waitcnt vmcnt(14)
    s_waitcnt lgkmcnt(8)
    v_mfma_f32_32x32x16_bf16 v[16:31], v[128:131], a[32:35], v[16:31]
    ds_read_b64_tr_b16 v[148:149], v172 offset:26624
    ds_read_b64_tr_b16 v[150:151], v172 offset:27648
    s_add_u32 s13, s13, 4096
    buffer_load_dwordx4 a[80:83], v5, s[36:39], s13 offen offset:0 sc1
    s_waitcnt vmcnt(14)
    s_waitcnt lgkmcnt(8)
    v_mfma_f32_32x32x16_bf16 v[16:31], v[132:135], a[36:39], v[16:31]
    ds_read_b64_tr_b16 v[152:153], v173 offset:0
    ds_read_b64_tr_b16 v[154:155], v173 offset:1024
    buffer_load_dwordx4 a[84:87], v5, s[36:39], s13 offen offset:1024 sc1
    s_waitcnt vmcnt(14)
    s_waitcnt lgkmcnt(8)
    v_mfma_f32_32x32x16_bf16 v[16:31], v[136:139], a[40:43], v[16:31]
    ds_read_b64_tr_b16 v[156:157], v173 offset:2048
    ds_read_b64_tr_b16 v[158:159], v173 offset:3072
    buffer_load_dwordx4 a[88:91], v5, s[36:39], s13 offen offset:2048 sc1
    s_waitcnt vmcnt(14)
    s_waitcnt lgkmcnt(8)
    v_mfma_f32_32x32x16_bf16 v[16:31], v[140:143], a[44:47], v[16:31]
    ds_read_b64_tr_b16 v[128:129], v173 offset:4096
    ds_read_b64_tr_b16 v[130:131], v173 offset:5120
    buffer_load_dwordx4 a[92:95], v5, s[36:39], s13 offen offset:3072 sc1
    s_waitcnt vmcnt(14)
    s_waitcnt lgkmcnt(8)
    v_mfma_f32_32x32x16_bf16 v[16:31], v[144:147], a[48:51], v[16:31]
    ds_read_b64_tr_b16 v[132:133], v173 offset:6144
    ds_read_b64_tr_b16 v[134:135], v173 offset:7168
    s_add_u32 s13, s13, 4096
    buffer_load_dwordx4 a[96:99], v5, s[36:39], s13 offen offset:0 sc1
    s_waitcnt vmcnt(13)
    s_waitcnt lgkmcnt(8)
    v_mfma_f32_32x32x16_bf16 v[16:31], v[148:151], a[52:55], v[16:31]
    ds_read_b64_tr_b16 v[136:137], v173 offset:8192
    ds_read_b64_tr_b16 v[138:139], v173 offset:9216
    buffer_load_dwordx4 a[100:103], v5, s[36:39], s13 offen offset:1024 sc1
    s_waitcnt vmcnt(12)
    s_waitcnt lgkmcnt(8)
    v_mfma_f32_32x32x16_bf16 v[16:31], v[152:155], a[56:59], v[16:31]
    ds_read_b64_tr_b16 v[140:141], v173 offset:10240
    ds_read_b64_tr_b16 v[142:143], v173 offset:11264
    buffer_load_dwordx4 a[104:107], v5, s[36:39], s13 offen offset:2048 sc1
    s_waitcnt vmcnt(11)
    s_waitcnt lgkmcnt(8)
    v_mfma_f32_32x32x16_bf16 v[16:31], v[156:159], a[60:63], v[16:31]
    ds_read_b64_tr_b16 v[144:145], v173 offset:12288
    ds_read_b64_tr_b16 v[146:147], v173 offset:13312
    buffer_load_dwordx4 a[108:111], v5, s[36:39], s13 offen offset:3072 sc1
    s_waitcnt vmcnt(11)
    s_waitcnt lgkmcnt(8)
    v_mfma_f32_32x32x16_bf16 v[16:31], v[128:131], a[64:67], v[16:31]
    ds_read_b64_tr_b16 v[148:149], v173 offset:14336
    ds_read_b64_tr_b16 v[150:151], v173 offset:15360
    s_add_u32 s13, s13, 4096
    buffer_load_dwordx4 a[112:115], v5, s[36:39], s13 offen offset:0 sc1
    s_waitcnt vmcnt(11)
    s_waitcnt lgkmcnt(8)
    v_mfma_f32_32x32x16_bf16 v[16:31], v[132:135], a[68:71], v[16:31]
    ds_read_b64_tr_b16 v[152:153], v173 offset:16384
    ds_read_b64_tr_b16 v[154:155], v173 offset:17408
    buffer_load_dwordx4 a[116:119], v5, s[36:39], s13 offen offset:1024 sc1
    s_waitcnt vmcnt(11)
    s_waitcnt lgkmcnt(8)
    v_mfma_f32_32x32x16_bf16 v[16:31], v[136:139], a[72:75], v[16:31]
    ds_read_b64_tr_b16 v[156:157], v173 offset:18432
    ds_read_b64_tr_b16 v[158:159], v173 offset:19456
    buffer_load_dwordx4 a[120:123], v5, s[36:39], s13 offen offset:2048 sc1
    s_waitcnt vmcnt(11)
    s_waitcnt lgkmcnt(8)
    v_mfma_f32_32x32x16_bf16 v[16:31], v[140:143], a[76:79], v[16:31]
    ds_read_b64_tr_b16 v[128:129], v173 offset:20480
    ds_read_b64_tr_b16 v[130:131], v173 offset:21504
    buffer_load_dwordx4 a[124:127], v5, s[36:39], s13 offen offset:3072 sc1
    s_waitcnt vmcnt(11)
    s_waitcnt lgkmcnt(8)
    v_mfma_f32_32x32x16_bf16 v[16:31], v[144:147], a[80:83], v[16:31]
    ds_read_b64_tr_b16 v[132:133], v173 offset:22528
    ds_read_b64_tr_b16 v[134:135], v173 offset:23552
    s_add_u32 s13, s13, 4096
    buffer_load_dwordx4 a[128:131], v5, s[36:39], s13 offen offset:0 sc1
    s_waitcnt vmcnt(11)
    s_waitcnt lgkmcnt(8)
    v_mfma_f32_32x32x16_bf16 v[16:31], v[148:151], a[84:87], v[16:31]
    ds_read_b64_tr_b16 v[136:137], v173 offset:24576
    ds_read_b64_tr_b16 v[138:139], v173 offset:25600
    buffer_load_dwordx4 a[132:135], v5, s[36:39], s13 offen offset:1024 sc1
    s_waitcnt vmcnt(11)
    s_waitcnt lgkmcnt(8)
    v_mfma_f32_32x32x16_bf16 v[16:31], v[152:155], a[88:91], v[16:31]
    ds_read_b64_tr_b16 v[140:141], v173 offset:26624
    ds_read_b64_tr_b16 v[142:143], v173 offset:27648
    buffer_load_dwordx4 a[136:139], v5, s[36:39], s13 offen offset:2048 sc1
    s_waitcnt vmcnt(11)
    s_waitcnt lgkmcnt(8)
    v_mfma_f32_32x32x16_bf16 v[16:31], v[156:159], a[92:95], v[16:31]
    ds_read_b64_tr_b16 v[144:145], v173 offset:32768
    ds_read_b64_tr_b16 v[146:147], v173 offset:33792
    buffer_load_dwordx4 a[140:143], v5, s[36:39], s13 offen offset:3072 sc1
    s_waitcnt vmcnt(11)
    s_waitcnt lgkmcnt(8)
    v_mfma_f32_32x32x16_bf16 v[16:31], v[128:131], a[96:99], v[16:31]
    ds_read_b64_tr_b16 v[148:149], v173 offset:34816
    ds_read_b64_tr_b16 v[150:151], v173 offset:35840
    s_add_u32 s13, s13, 4096
    buffer_load_dwordx4 a[144:147], v5, s[36:39], s13 offen offset:0 sc1
    s_waitcnt vmcnt(11)
    s_waitcnt lgkmcnt(8)
    v_mfma_f32_32x32x16_bf16 v[16:31], v[132:135], a[100:103], v[16:31]
    ds_read_b64_tr_b16 v[152:153], v173 offset:36864
    ds_read_b64_tr_b16 v[154:155], v173 offset:37888
    buffer_load_dwordx4 a[148:151], v5, s[36:39], s13 offen offset:1024 sc1
    s_waitcnt vmcnt(11)
    s_waitcnt lgkmcnt(8)
    v_mfma_f32_32x32x16_bf16 v[16:31], v[136:139], a[104:107], v[16:31]
    ds_read_b64_tr_b16 v[156:157], v173 offset:38912
    ds_read_b64_tr_b16 v[158:159], v173 offset:39936
    buffer_load_dwordx4 a[152:155], v5, s[36:39], s13 offen offset:2048 sc1
    s_waitcnt vmcnt(11)
    s_waitcnt lgkmcnt(8)
    v_mfma_f32_32x32x16_bf16 v[16:31], v[140:143], a[108:111], v[16:31]
    ds_read_b64_tr_b16 v[128:129], v173 offset:40960
    ds_read_b64_tr_b16 v[130:131], v173 offset:41984
    buffer_load_dwordx4 a[156:159], v5, s[36:39], s13 offen offset:3072 sc1
    s_waitcnt vmcnt(11)
    s_waitcnt lgkmcnt(8)
    v_mfma_f32_32x32x16_bf16 v[16:31], v[144:147], a[112:115], v[16:31]
    ds_read_b64_tr_b16 v[132:133], v173 offset:43008
    ds_read_b64_tr_b16 v[134:135], v173 offset:44032
    s_add_u32 s13, s13, 4096
    buffer_load_dwordx4 a[160:163], v5, s[36:39], s13 offen offset:0 sc1
    s_waitcnt vmcnt(11)
    s_waitcnt lgkmcnt(8)
    v_mfma_f32_32x32x16_bf16 v[16:31], v[148:151], a[116:119], v[16:31]
    ds_read_b64_tr_b16 v[136:137], v173 offset:45056
    ds_read_b64_tr_b16 v[138:139], v173 offset:46080
    buffer_load_dwordx4 a[164:167], v5, s[36:39], s13 offen offset:1024 sc1
    s_waitcnt vmcnt(11)
    s_waitcnt lgkmcnt(8)
    v_mfma_f32_32x32x16_bf16 v[16:31], v[152:155], a[120:123], v[16:31]
    ds_read_b64_tr_b16 v[140:141], v173 offset:47104
    ds_read_b64_tr_b16 v[142:143], v173 offset:48128
    buffer_load_dwordx4 a[168:171], v5, s[36:39], s13 offen offset:2048 sc1
    s_xor_b32 s52, s2, 1
    s_waitcnt vmcnt(11)
    s_waitcnt lgkmcnt(8)
    v_mfma_f32_32x32x16_bf16 v[16:31], v[156:159], a[124:127], v[16:31]
    ds_read_b64_tr_b16 v[144:145], v173 offset:49152
    ds_read_b64_tr_b16 v[146:147], v173 offset:50176
    buffer_load_dwordx4 a[172:175], v5, s[36:39], s13 offen offset:3072 sc1
    s_and_b32 s53, s52, 7
    s_lshl_b32 s53, s53, 5
    s_waitcnt vmcnt(11)
    s_waitcnt lgkmcnt(8)
    v_mfma_f32_32x32x16_bf16 v[16:31], v[128:131], a[128:131], v[16:31]
    ds_read_b64_tr_b16 v[148:149], v173 offset:51200
    ds_read_b64_tr_b16 v[150:151], v173 offset:52224
    s_add_u32 s13, s13, 4096
    buffer_load_dwordx4 a[176:179], v5, s[36:39], s13 offen offset:0 sc1
    s_add_u32 s53, s53, s47
    s_lshl_b32 s53, s53, 2
    s_waitcnt vmcnt(11)
    s_waitcnt lgkmcnt(8)
    v_mfma_f32_32x32x16_bf16 v[16:31], v[132:135], a[132:135], v[16:31]
    ds_read_b64_tr_b16 v[152:153], v173 offset:53248
    ds_read_b64_tr_b16 v[154:155], v173 offset:54272
    buffer_load_dwordx4 a[180:183], v5, s[36:39], s13 offen offset:1024 sc1
    s_add_u32 s53, s53, s48
    s_lshl_b32 s58, s53, 12
    s_waitcnt vmcnt(11)
    s_waitcnt lgkmcnt(8)
    v_mfma_f32_32x32x16_bf16 v[16:31], v[136:139], a[136:139], v[16:31]
    ds_read_b64_tr_b16 v[156:157], v173 offset:55296
    ds_read_b64_tr_b16 v[158:159], v173 offset:56320
    buffer_load_dwordx4 a[184:187], v5, s[36:39], s13 offen offset:2048 sc1
    s_add_u32 s58, s58, 0x400000
    s_xor_b32 s59, s58, 0x80000
    s_waitcnt vmcnt(11)
    s_waitcnt lgkmcnt(8)
    v_mfma_f32_32x32x16_bf16 v[16:31], v[140:143], a[140:143], v[16:31]
    ds_read_b64_tr_b16 v[128:129], v173 offset:57344
    ds_read_b64_tr_b16 v[130:131], v173 offset:58368
    buffer_load_dwordx4 a[188:191], v5, s[36:39], s13 offen offset:3072 sc1
    s_lshl_b32 s52, s10, 15
    s_lshl_b32 s53, s9, 7
    s_waitcnt vmcnt(11)
    s_waitcnt lgkmcnt(8)
    v_mfma_f32_32x32x16_bf16 v[16:31], v[144:147], a[144:147], v[16:31]
    ds_read_b64_tr_b16 v[132:133], v173 offset:59392
    ds_read_b64_tr_b16 v[134:135], v173 offset:60416
    s_add_u32 s13, s13, 4096
    buffer_load_dwordx4 a[192:195], v5, s[36:39], s13 offen offset:0 sc1
    s_add_u32 s52, s52, s53
    s_lshl_b32 s53, s99, 6
    s_waitcnt vmcnt(11)
    s_waitcnt lgkmcnt(8)
    v_mfma_f32_32x32x16_bf16 v[16:31], v[148:151], a[148:151], v[16:31]
    ds_read_b64_tr_b16 v[136:137], v174 offset:0
    ds_read_b64_tr_b16 v[138:139], v174 offset:1024
    buffer_load_dwordx4 a[196:199], v5, s[36:39], s13 offen offset:1024 sc1
    s_add_u32 s52, s52, s53
    s_add_u32 s53, s52, 0x4000
    s_waitcnt vmcnt(11)
    s_waitcnt lgkmcnt(8)
    v_mfma_f32_32x32x16_bf16 v[16:31], v[152:155], a[152:155], v[16:31]
    ds_read_b64_tr_b16 v[140:141], v174 offset:2048
    ds_read_b64_tr_b16 v[142:143], v174 offset:3072
    buffer_load_dwordx4 a[200:203], v5, s[36:39], s13 offen offset:2048 sc1
    v_cmp_ne_u32 vcc, s49, v97
    s_cbranch_vccz Lrak
    s_mov_b32 s62, 0
    Lra:
    buffer_load_dwordx2 v[96:97], v171, s[36:39], s12 offen sc1
    s_add_u32 s62, s62, 1
    s_cmp_gt_u32 s62, 1048576
    s_cbranch_scc1 Lrak
    s_waitcnt vmcnt(0)
    v_cmp_ne_u32 vcc, s49, v97
    s_cbranch_vccnz Lra
    Lrak:
    v_and_b32 v96, 0xffff0000, v96
    s_waitcnt vmcnt(11)
    s_waitcnt lgkmcnt(8)
    v_mfma_f32_32x32x16_bf16 v[16:31], v[156:159], a[156:159], v[16:31]
    ds_read_b64_tr_b16 v[144:145], v174 offset:4096
    ds_read_b64_tr_b16 v[146:147], v174 offset:5120
    buffer_load_dwordx4 a[204:207], v5, s[36:39], s13 offen offset:3072 sc1
    v_rcp_f32 v96, v96
    s_waitcnt vmcnt(11)
    s_waitcnt lgkmcnt(8)
    v_mfma_f32_32x32x16_bf16 v[16:31], v[128:131], a[160:163], v[16:31]
    ds_read_b64_tr_b16 v[148:149], v174 offset:6144
    ds_read_b64_tr_b16 v[150:151], v174 offset:7168
    s_add_u32 s13, s13, 4096
    buffer_load_dwordx4 a[208:211], v5, s[36:39], s13 offen offset:0 sc1
    v_mov_b32 v11, s49
    v_mov_b32 v12, 0xff
    s_waitcnt vmcnt(11)
    s_waitcnt lgkmcnt(8)
    v_mfma_f32_32x32x16_bf16 v[16:31], v[132:135], a[164:167], v[16:31]
    ds_read_b64_tr_b16 v[152:153], v174 offset:8192
    ds_read_b64_tr_b16 v[154:155], v174 offset:9216
    buffer_load_dwordx4 a[212:215], v5, s[36:39], s13 offen offset:1024 sc1
    v_and_b32 v8, 0xff, v11
    v_bfe_u32 v9, v11, 8, 8
    s_waitcnt vmcnt(11)
    s_waitcnt lgkmcnt(8)
    v_mfma_f32_32x32x16_bf16 v[16:31], v[136:139], a[168:171], v[16:31]
    ds_read_b64_tr_b16 v[156:157], v174 offset:10240
    ds_read_b64_tr_b16 v[158:159], v174 offset:11264
    buffer_load_dwordx4 a[216:219], v5, s[36:39], s13 offen offset:2048 sc1
    v_bfe_u32 v10, v11, 16, 8
    v_lshrrev_b32 v11, 24, v11
    s_waitcnt vmcnt(11)
    s_waitcnt lgkmcnt(8)
    v_mfma_f32_32x32x16_bf16 v[16:31], v[140:143], a[172:175], v[16:31]
    ds_read_b64_tr_b16 v[128:129], v174 offset:12288
    ds_read_b64_tr_b16 v[130:131], v174 offset:13312
    buffer_load_dwordx4 a[220:223], v5, s[36:39], s13 offen offset:3072 sc1
    s_waitcnt vmcnt(11)
    s_waitcnt lgkmcnt(8)
    v_mfma_f32_32x32x16_bf16 v[16:31], v[144:147], a[176:179], v[16:31]
    ds_read_b64_tr_b16 v[132:133], v174 offset:32768
    ds_read_b64_tr_b16 v[134:135], v174 offset:33792
    s_waitcnt vmcnt(10)
    s_waitcnt lgkmcnt(8)
    v_mfma_f32_32x32x16_bf16 v[16:31], v[148:151], a[180:183], v[16:31]
    ds_read_b64_tr_b16 v[136:137], v174 offset:34816
    ds_read_b64_tr_b16 v[138:139], v174 offset:35840
    s_waitcnt vmcnt(9)
    s_waitcnt lgkmcnt(8)
    v_mfma_f32_32x32x16_bf16 v[16:31], v[152:155], a[184:187], v[16:31]
    ds_read_b64_tr_b16 v[140:141], v174 offset:36864
    ds_read_b64_tr_b16 v[142:143], v174 offset:37888
    s_waitcnt vmcnt(8)
    s_waitcnt lgkmcnt(8)
    v_mfma_f32_32x32x16_bf16 v[16:31], v[156:159], a[188:191], v[16:31]
    ds_read_b64_tr_b16 v[144:145], v174 offset:38912
    ds_read_b64_tr_b16 v[146:147], v174 offset:39936
    s_waitcnt vmcnt(7)
    s_waitcnt lgkmcnt(8)
    v_mfma_f32_32x32x16_bf16 v[16:31], v[128:131], a[192:195], v[16:31]
    ds_read_b64_tr_b16 v[148:149], v174 offset:40960
    ds_read_b64_tr_b16 v[150:151], v174 offset:41984
    s_waitcnt vmcnt(6)
    s_waitcnt lgkmcnt(8)
    v_mfma_f32_32x32x16_bf16 v[16:31], v[132:135], a[196:199], v[16:31]
    ds_read_b64_tr_b16 v[152:153], v174 offset:43008
    ds_read_b64_tr_b16 v[154:155], v174 offset:44032
    s_waitcnt vmcnt(5)
    s_waitcnt lgkmcnt(8)
    v_mfma_f32_32x32x16_bf16 v[16:31], v[136:139], a[200:203], v[16:31]
    ds_read_b64_tr_b16 v[156:157], v174 offset:45056
    ds_read_b64_tr_b16 v[158:159], v174 offset:46080
    s_waitcnt vmcnt(4)
    s_waitcnt lgkmcnt(8)
    v_mfma_f32_32x32x16_bf16 v[16:31], v[140:143], a[204:207], v[16:31]
    ds_read_b64_tr_b16 v[128:129], v175 offset:0
    ds_read_b64_tr_b16 v[130:131], v175 offset:1024
    s_waitcnt vmcnt(3)
    s_waitcnt lgkmcnt(8)
    v_mfma_f32_32x32x16_bf16 v[16:31], v[144:147], a[208:211], v[16:31]
    ds_read_b64_tr_b16 v[132:133], v175 offset:2048
    ds_read_b64_tr_b16 v[134:135], v175 offset:3072
    s_waitcnt vmcnt(2)
    s_waitcnt lgkmcnt(8)
    v_mfma_f32_32x32x16_bf16 v[16:31], v[148:151], a[212:215], v[16:31]
    ds_read_b64_tr_b16 v[136:137], v175 offset:4096
    ds_read_b64_tr_b16 v[138:139], v175 offset:5120
    s_waitcnt vmcnt(1)
    s_waitcnt lgkmcnt(8)
    v_mfma_f32_32x32x16_bf16 v[16:31], v[152:155], a[216:219], v[16:31]
    ds_read_b64_tr_b16 v[140:141], v175 offset:6144
    ds_read_b64_tr_b16 v[142:143], v175 offset:7168
    s_waitcnt vmcnt(0)
    s_waitcnt lgkmcnt(8)
    v_mfma_f32_32x32x16_bf16 v[16:31], v[156:159], a[220:223], v[16:31]
    ds_read_b64_tr_b16 v[144:145], v175 offset:8192
    ds_read_b64_tr_b16 v[146:147], v175 offset:9216
    s_waitcnt lgkmcnt(8)
    v_mfma_f32_32x32x16_bf16 v[32:47], v[128:131], a[0:3], 0
    ds_read_b64_tr_b16 v[148:149], v175 offset:10240
    ds_read_b64_tr_b16 v[150:151], v175 offset:11264
    s_waitcnt lgkmcnt(8)
    v_mfma_f32_32x32x16_bf16 v[32:47], v[132:135], a[4:7], v[32:47]
    ds_read_b64_tr_b16 v[152:153], v175 offset:12288
    ds_read_b64_tr_b16 v[154:155], v175 offset:13312
    s_waitcnt lgkmcnt(8)
    v_mfma_f32_32x32x16_bf16 v[32:47], v[136:139], a[8:11], v[32:47]
    ds_read_b64_tr_b16 v[156:157], v175 offset:14336
    ds_read_b64_tr_b16 v[158:159], v175 offset:15360
    s_waitcnt lgkmcnt(8)
    v_mfma_f32_32x32x16_bf16 v[32:47], v[140:143], a[12:15], v[32:47]
    ds_read_b64_tr_b16 v[128:129], v175 offset:16384
    ds_read_b64_tr_b16 v[130:131], v175 offset:17408
    v_bfi_b32 v16, v12, v8, v16
    v_bfi_b32 v17, v12, v9, v17
    v_bfi_b32 v18, v12, v10, v18
    v_bfi_b32 v19, v12, v11, v19
    buffer_store_dwordx4 v[16:19], v5, s[36:39], s58 offen offset:0 sc1
    s_waitcnt lgkmcnt(8)
    v_mfma_f32_32x32x16_bf16 v[32:47], v[144:147], a[16:19], v[32:47]
    ds_read_b64_tr_b16 v[132:133], v175 offset:18432
    ds_read_b64_tr_b16 v[134:135], v175 offset:19456
    v_bfi_b32 v20, v12, v8, v20
    v_bfi_b32 v21, v12, v9, v21
    v_bfi_b32 v22, v12, v10, v22
    v_bfi_b32 v23, v12, v11, v23
    buffer_store_dwordx4 v[20:23], v5, s[36:39], s58 offen offset:1024 sc1
    s_waitcnt lgkmcnt(8)
    v_mfma_f32_32x32x16_bf16 v[32:47], v[148:151], a[20:23], v[32:47]
    ds_read_b64_tr_b16 v[136:137], v175 offset:20480
    ds_read_b64_tr_b16 v[138:139], v175 offset:21504
    v_bfi_b32 v24, v12, v8, v24
    v_bfi_b32 v25, v12, v9, v25
    v_bfi_b32 v26, v12, v10, v26
    v_bfi_b32 v27, v12, v11, v27
    buffer_store_dwordx4 v[24:27], v5, s[36:39], s58 offen offset:2048 sc1
    s_waitcnt lgkmcnt(8)
    v_mfma_f32_32x32x16_bf16 v[32:47], v[152:155], a[24:27], v[32:47]
    ds_read_b64_tr_b16 v[140:141], v175 offset:22528
    ds_read_b64_tr_b16 v[142:143], v175 offset:23552
    v_bfi_b32 v28, v12, v8, v28
    v_bfi_b32 v29, v12, v9, v29
    v_bfi_b32 v30, v12, v10, v30
    v_bfi_b32 v31, v12, v11, v31
    buffer_store_dwordx4 v[28:31], v5, s[36:39], s58 offen offset:3072 sc1
    s_waitcnt lgkmcnt(8)
    v_mfma_f32_32x32x16_bf16 v[32:47], v[156:159], a[28:31], v[32:47]
    ds_read_b64_tr_b16 v[144:145], v175 offset:24576
    ds_read_b64_tr_b16 v[146:147], v175 offset:25600
    s_waitcnt lgkmcnt(8)
    v_mfma_f32_32x32x16_bf16 v[32:47], v[128:131], a[32:35], v[32:47]
    ds_read_b64_tr_b16 v[148:149], v175 offset:26624
    ds_read_b64_tr_b16 v[150:151], v175 offset:27648
    ds_read_b64_tr_b16 v[98:99], v170 offset:0
    ds_read_b64_tr_b16 v[100:101], v170 offset:512
    ds_read_b64_tr_b16 v[102:103], v170 offset:1024
    ds_read_b64_tr_b16 v[104:105], v170 offset:1536
    s_waitcnt lgkmcnt(8)
    v_mfma_f32_32x32x16_bf16 v[32:47], v[132:135], a[36:39], v[32:47]
    ds_read_b64_tr_b16 v[152:153], v176 offset:0
    ds_read_b64_tr_b16 v[154:155], v176 offset:1024
    s_waitcnt lgkmcnt(8)
    v_mfma_f32_32x32x16_bf16 v[32:47], v[136:139], a[40:43], v[32:47]
    ds_read_b64_tr_b16 v[156:157], v176 offset:2048
    ds_read_b64_tr_b16 v[158:159], v176 offset:3072
    s_waitcnt lgkmcnt(8)
    v_mfma_f32_32x32x16_bf16 v[32:47], v[140:143], a[44:47], v[32:47]
    ds_read_b64_tr_b16 v[128:129], v176 offset:4096
    ds_read_b64_tr_b16 v[130:131], v176 offset:5120
    s_waitcnt lgkmcnt(8)
    v_mfma_f32_32x32x16_bf16 v[32:47], v[144:147], a[48:51], v[32:47]
    ds_read_b64_tr_b16 v[132:133], v176 offset:6144
    ds_read_b64_tr_b16 v[134:135], v176 offset:7168
    s_waitcnt lgkmcnt(8)
    v_mfma_f32_32x32x16_bf16 v[32:47], v[148:151], a[52:55], v[32:47]
    ds_read_b64_tr_b16 v[136:137], v176 offset:8192
    ds_read_b64_tr_b16 v[138:139], v176 offset:9216
    s_waitcnt lgkmcnt(8)
    v_mfma_f32_32x32x16_bf16 v[32:47], v[152:155], a[56:59], v[32:47]
    ds_read_b64_tr_b16 v[140:141], v176 offset:10240
    ds_read_b64_tr_b16 v[142:143], v176 offset:11264
    s_waitcnt lgkmcnt(8)
    v_mfma_f32_32x32x16_bf16 v[32:47], v[156:159], a[60:63], v[32:47]
    ds_read_b64_tr_b16 v[144:145], v176 offset:12288
    ds_read_b64_tr_b16 v[146:147], v176 offset:13312
    s_waitcnt lgkmcnt(8)
    v_mfma_f32_32x32x16_bf16 v[32:47], v[128:131], a[64:67], v[32:47]
    ds_read_b64_tr_b16 v[148:149], v176 offset:14336
    ds_read_b64_tr_b16 v[150:151], v176 offset:15360
    v_lshlrev_b32 v80, 16, v98
    s_waitcnt lgkmcnt(8)
    v_mfma_f32_32x32x16_bf16 v[32:47], v[132:135], a[68:71], v[32:47]
    ds_read_b64_tr_b16 v[152:153], v176 offset:16384
    ds_read_b64_tr_b16 v[154:155], v176 offset:17408
    v_and_b32 v81, 0xffff0000, v98
    s_waitcnt lgkmcnt(8)
    v_mfma_f32_32x32x16_bf16 v[32:47], v[136:139], a[72:75], v[32:47]
    ds_read_b64_tr_b16 v[156:157], v176 offset:18432
    ds_read_b64_tr_b16 v[158:159], v176 offset:19456
    v_lshlrev_b32 v82, 16, v99
    s_waitcnt lgkmcnt(8)
    v_mfma_f32_32x32x16_bf16 v[32:47], v[140:143], a[76:79], v[32:47]
    ds_read_b64_tr_b16 v[128:129], v176 offset:20480
    ds_read_b64_tr_b16 v[130:131], v176 offset:21504
    v_and_b32 v83, 0xffff0000, v99
    s_waitcnt lgkmcnt(8)
    v_mfma_f32_32x32x16_bf16 v[32:47], v[144:147], a[80:83], v[32:47]
    ds_read_b64_tr_b16 v[132:133], v176 offset:22528
    ds_read_b64_tr_b16 v[134:135], v176 offset:23552
    v_lshlrev_b32 v84, 16, v100
    s_waitcnt lgkmcnt(8)
    v_mfma_f32_32x32x16_bf16 v[32:47], v[148:151], a[84:87], v[32:47]
    ds_read_b64_tr_b16 v[136:137], v176 offset:24576
    ds_read_b64_tr_b16 v[138:139], v176 offset:25600
    v_and_b32 v85, 0xffff0000, v100
    s_waitcnt lgkmcnt(8)
    v_mfma_f32_32x32x16_bf16 v[32:47], v[152:155], a[88:91], v[32:47]
    ds_read_b64_tr_b16 v[140:141], v176 offset:26624
    ds_read_b64_tr_b16 v[142:143], v176 offset:27648
    v_lshlrev_b32 v86, 16, v101
    s_waitcnt lgkmcnt(8)
    v_mfma_f32_32x32x16_bf16 v[32:47], v[156:159], a[92:95], v[32:47]
    ds_read_b64_tr_b16 v[144:145], v176 offset:32768
    ds_read_b64_tr_b16 v[146:147], v176 offset:33792
    v_and_b32 v87, 0xffff0000, v101
    s_waitcnt lgkmcnt(8)
    v_mfma_f32_32x32x16_bf16 v[32:47], v[128:131], a[96:99], v[32:47]
    ds_read_b64_tr_b16 v[148:149], v176 offset:34816
    ds_read_b64_tr_b16 v[150:151], v176 offset:35840
    v_lshlrev_b32 v88, 16, v102
    s_waitcnt lgkmcnt(8)
    v_mfma_f32_32x32x16_bf16 v[32:47], v[132:135], a[100:103], v[32:47]
    ds_read_b64_tr_b16 v[152:153], v176 offset:36864
    ds_read_b64_tr_b16 v[154:155], v176 offset:37888
    v_and_b32 v89, 0xffff0000, v102
    s_waitcnt lgkmcnt(8)
    v_mfma_f32_32x32x16_bf16 v[32:47], v[136:139], a[104:107], v[32:47]
    ds_read_b64_tr_b16 v[156:157], v176 offset:38912
    ds_read_b64_tr_b16 v[158:159], v176 offset:39936
    v_lshlrev_b32 v90, 16, v103
    s_waitcnt lgkmcnt(8)
    v_mfma_f32_32x32x16_bf16 v[32:47], v[140:143], a[108:111], v[32:47]
    ds_read_b64_tr_b16 v[128:129], v176 offset:40960
    ds_read_b64_tr_b16 v[130:131], v176 offset:41984
    v_and_b32 v91, 0xffff0000, v103
    s_waitcnt lgkmcnt(8)
    v_mfma_f32_32x32x16_bf16 v[32:47], v[144:147], a[112:115], v[32:47]
    ds_read_b64_tr_b16 v[132:133], v176 offset:43008
    ds_read_b64_tr_b16 v[134:135], v176 offset:44032
    v_lshlrev_b32 v92, 16, v104
    s_waitcnt lgkmcnt(8)
    v_mfma_f32_32x32x16_bf16 v[32:47], v[148:151], a[116:119], v[32:47]
    ds_read_b64_tr_b16 v[136:137], v176 offset:45056
    ds_read_b64_tr_b16 v[138:139], v176 offset:46080
    v_and_b32 v93, 0xffff0000, v104
    s_waitcnt lgkmcnt(8)
    v_mfma_f32_32x32x16_bf16 v[32:47], v[152:155], a[120:123], v[32:47]
    ds_read_b64_tr_b16 v[140:141], v176 offset:47104
    ds_read_b64_tr_b16 v[142:143], v176 offset:48128
    v_lshlrev_b32 v94, 16, v105
    s_waitcnt lgkmcnt(8)
    v_mfma_f32_32x32x16_bf16 v[32:47], v[156:159], a[124:127], v[32:47]
    ds_read_b64_tr_b16 v[144:145], v176 offset:49152
    ds_read_b64_tr_b16 v[146:147], v176 offset:50176
    v_and_b32 v95, 0xffff0000, v105
    s_waitcnt lgkmcnt(8)
    v_mfma_f32_32x32x16_bf16 v[32:47], v[128:131], a[128:131], v[32:47]
    ds_read_b64_tr_b16 v[148:149], v176 offset:51200
    ds_read_b64_tr_b16 v[150:151], v176 offset:52224
    s_waitcnt lgkmcnt(8)
    v_mfma_f32_32x32x16_bf16 v[32:47], v[132:135], a[132:135], v[32:47]
    ds_read_b64_tr_b16 v[152:153], v176 offset:53248
    ds_read_b64_tr_b16 v[154:155], v176 offset:54272
    s_waitcnt lgkmcnt(8)
    v_mfma_f32_32x32x16_bf16 v[32:47], v[136:139], a[136:139], v[32:47]
    ds_read_b64_tr_b16 v[156:157], v176 offset:55296
    ds_read_b64_tr_b16 v[158:159], v176 offset:56320
    s_waitcnt lgkmcnt(8)
    v_mfma_f32_32x32x16_bf16 v[32:47], v[140:143], a[140:143], v[32:47]
    ds_read_b64_tr_b16 v[128:129], v176 offset:57344
    ds_read_b64_tr_b16 v[130:131], v176 offset:58368
    s_waitcnt lgkmcnt(8)
    v_mfma_f32_32x32x16_bf16 v[32:47], v[144:147], a[144:147], v[32:47]
    ds_read_b64_tr_b16 v[132:133], v176 offset:59392
    ds_read_b64_tr_b16 v[134:135], v176 offset:60416
    s_waitcnt lgkmcnt(8)
    v_mfma_f32_32x32x16_bf16 v[32:47], v[148:151], a[148:151], v[32:47]
    ds_read_b64_tr_b16 v[136:137], v177 offset:0
    ds_read_b64_tr_b16 v[138:139], v177 offset:1024
    s_waitcnt lgkmcnt(8)
    v_mfma_f32_32x32x16_bf16 v[32:47], v[152:155], a[152:155], v[32:47]
    ds_read_b64_tr_b16 v[140:141], v177 offset:2048
    ds_read_b64_tr_b16 v[142:143], v177 offset:3072
    s_waitcnt lgkmcnt(8)
    v_mfma_f32_32x32x16_bf16 v[32:47], v[156:159], a[156:159], v[32:47]
    ds_read_b64_tr_b16 v[144:145], v177 offset:4096
    ds_read_b64_tr_b16 v[146:147], v177 offset:5120
    s_waitcnt lgkmcnt(8)
    v_mfma_f32_32x32x16_bf16 v[32:47], v[128:131], a[160:163], v[32:47]
    ds_read_b64_tr_b16 v[148:149], v177 offset:6144
    ds_read_b64_tr_b16 v[150:151], v177 offset:7168
    s_waitcnt lgkmcnt(8)
    v_mfma_f32_32x32x16_bf16 v[32:47], v[132:135], a[164:167], v[32:47]
    ds_read_b64_tr_b16 v[152:153], v177 offset:8192
    ds_read_b64_tr_b16 v[154:155], v177 offset:9216
    s_waitcnt lgkmcnt(8)
    v_mfma_f32_32x32x16_bf16 v[32:47], v[136:139], a[168:171], v[32:47]
    ds_read_b64_tr_b16 v[156:157], v177 offset:10240
    ds_read_b64_tr_b16 v[158:159], v177 offset:11264
    s_waitcnt lgkmcnt(8)
    v_mfma_f32_32x32x16_bf16 v[32:47], v[140:143], a[172:175], v[32:47]
    ds_read_b64_tr_b16 v[128:129], v177 offset:12288
    ds_read_b64_tr_b16 v[130:131], v177 offset:13312
    s_waitcnt lgkmcnt(8)
    v_mfma_f32_32x32x16_bf16 v[32:47], v[144:147], a[176:179], v[32:47]
    ds_read_b64_tr_b16 v[132:133], v177 offset:32768
    ds_read_b64_tr_b16 v[134:135], v177 offset:33792
    buffer_load_dwordx4 v[48:51], v5, s[36:39], s59 offen offset:0 sc1
    s_waitcnt lgkmcnt(8)
    v_mfma_f32_32x32x16_bf16 v[32:47], v[148:151], a[180:183], v[32:47]
    ds_read_b64_tr_b16 v[136:137], v177 offset:34816
    ds_read_b64_tr_b16 v[138:139], v177 offset:35840
    buffer_load_dwordx4 v[52:55], v5, s[36:39], s59 offen offset:1024 sc1
    s_waitcnt lgkmcnt(8)
    v_mfma_f32_32x32x16_bf16 v[32:47], v[152:155], a[184:187], v[32:47]
    ds_read_b64_tr_b16 v[140:141], v177 offset:36864
    ds_read_b64_tr_b16 v[142:143], v177 offset:37888
    buffer_load_dwordx4 v[56:59], v5, s[36:39], s59 offen offset:2048 sc1
    s_waitcnt lgkmcnt(8)
    v_mfma_f32_32x32x16_bf16 v[32:47], v[156:159], a[188:191], v[32:47]
    ds_read_b64_tr_b16 v[144:145], v177 offset:38912
    ds_read_b64_tr_b16 v[146:147], v177 offset:39936
    buffer_load_dwordx4 v[60:63], v5, s[36:39], s59 offen offset:3072 sc1
    s_waitcnt lgkmcnt(8)
    v_mfma_f32_32x32x16_bf16 v[32:47], v[128:131], a[192:195], v[32:47]
    ds_read_b64_tr_b16 v[148:149], v177 offset:40960
    ds_read_b64_tr_b16 v[150:151], v177 offset:41984
    s_waitcnt lgkmcnt(8)
    v_mfma_f32_32x32x16_bf16 v[32:47], v[132:135], a[196:199], v[32:47]
    ds_read_b64_tr_b16 v[152:153], v177 offset:43008
    ds_read_b64_tr_b16 v[154:155], v177 offset:44032
    s_waitcnt lgkmcnt(8)
    v_mfma_f32_32x32x16_bf16 v[32:47], v[136:139], a[200:203], v[32:47]
    ds_read_b64_tr_b16 v[156:157], v177 offset:45056
    ds_read_b64_tr_b16 v[158:159], v177 offset:46080
    s_waitcnt lgkmcnt(8)
    v_mfma_f32_32x32x16_bf16 v[32:47], v[140:143], a[204:207], v[32:47]
    s_waitcnt lgkmcnt(6)
    v_mfma_f32_32x32x16_bf16 v[32:47], v[144:147], a[208:211], v[32:47]
    s_waitcnt lgkmcnt(4)
    v_mfma_f32_32x32x16_bf16 v[32:47], v[148:151], a[212:215], v[32:47]
    s_waitcnt lgkmcnt(2)
    v_mfma_f32_32x32x16_bf16 v[32:47], v[152:155], a[216:219], v[32:47]
    s_waitcnt lgkmcnt(0)
    v_mfma_f32_32x32x16_bf16 v[32:47], v[156:159], a[220:223], v[32:47]
    s_mov_b32 s62, 0
    s_branch Lxac
Lxa:
    buffer_load_dwordx4 v[48:51], v5, s[36:39], s59 offen offset:0 sc1
    buffer_load_dwordx4 v[52:55], v5, s[36:39], s59 offen offset:1024 sc1
    buffer_load_dwordx4 v[56:59], v5, s[36:39], s59 offen offset:2048 sc1
    buffer_load_dwordx4 v[60:63], v5, s[36:39], s59 offen offset:3072 sc1
    s_add_u32 s62, s62, 1
    s_cmp_gt_u32 s62, 1048576
    s_cbranch_scc1 Lxda
Lxac:
    s_waitcnt vmcnt(3)
    v_xor_b32 v48, v8, v48
    v_xor_b32 v49, v9, v49
    v_xor_b32 v50, v10, v50
    v_xor_b32 v51, v11, v51
    v_or3_b32 v13, v48, v49, 0
    v_or3_b32 v13, v50, v51, v13
    s_waitcnt vmcnt(2)
    v_xor_b32 v52, v8, v52
    v_xor_b32 v53, v9, v53
    v_xor_b32 v54, v10, v54
    v_xor_b32 v55, v11, v55
    v_or3_b32 v13, v52, v53, v13
    v_or3_b32 v13, v54, v55, v13
    s_waitcnt vmcnt(1)
    v_xor_b32 v56, v8, v56
    v_xor_b32 v57, v9, v57
    v_xor_b32 v58, v10, v58
    v_xor_b32 v59, v11, v59
    v_or3_b32 v13, v56, v57, v13
    v_or3_b32 v13, v58, v59, v13
    s_waitcnt vmcnt(0)
    v_xor_b32 v60, v8, v60
    v_xor_b32 v61, v9, v61
    v_xor_b32 v62, v10, v62
    v_xor_b32 v63, v11, v63
    v_or3_b32 v13, v60, v61, v13
    v_or3_b32 v13, v62, v63, v13
    v_and_b32 v13, 0xff, v13
    v_cmp_ne_u32 vcc, 0, v13
    s_cbranch_vccnz Lxa
Lxda:
    s_waitcnt vmcnt(0)
    s_nop 4
    v_pk_add_f32 v[48:49], v[48:49], v[32:33]
    v_pk_add_f32 v[50:51], v[50:51], v[34:35]
    v_fmac_f32 v80, v96, v48
    v_fmac_f32 v81, v96, v49
    v_fmac_f32 v82, v96, v50
    v_fmac_f32 v83, v96, v51
    v_cvt_pk_bf16_f32 v64, v80, v81
    v_cvt_pk_bf16_f32 v65, v82, v83
    ds_write_b64 v179, v[64:65] offset:0
    v_pk_add_f32 v[52:53], v[52:53], v[36:37]
    v_pk_add_f32 v[54:55], v[54:55], v[38:39]
    v_fmac_f32 v84, v96, v52
    v_fmac_f32 v85, v96, v53
    v_fmac_f32 v86, v96, v54
    v_fmac_f32 v87, v96, v55
    v_cvt_pk_bf16_f32 v66, v84, v85
    v_cvt_pk_bf16_f32 v67, v86, v87
    ds_write_b64 v179, v[66:67] offset:16
    v_pk_add_f32 v[56:57], v[56:57], v[40:41]
    v_pk_add_f32 v[58:59], v[58:59], v[42:43]
    v_fmac_f32 v88, v96, v56
    v_fmac_f32 v89, v96, v57
    v_fmac_f32 v90, v96, v58
    v_fmac_f32 v91, v96, v59
    v_cvt_pk_bf16_f32 v68, v88, v89
    v_cvt_pk_bf16_f32 v69, v90, v91
    ds_write_b64 v179, v[68:69] offset:32
    v_pk_add_f32 v[60:61], v[60:61], v[44:45]
    v_pk_add_f32 v[62:63], v[62:63], v[46:47]
    v_fmac_f32 v92, v96, v60
    v_fmac_f32 v93, v96, v61
    v_fmac_f32 v94, v96, v62
    v_fmac_f32 v95, v96, v63
    v_cvt_pk_bf16_f32 v70, v92, v93
    v_cvt_pk_bf16_f32 v71, v94, v95
    ds_write_b64 v179, v[70:71] offset:48
    s_waitcnt lgkmcnt(0)
    ds_read_b128 v[72:75], v180
    ds_read_b128 v[76:79], v180 offset:1280
    s_waitcnt lgkmcnt(1)
    buffer_store_dwordx4 v[72:75], v181, s[32:35], s52 offen nt
    s_waitcnt lgkmcnt(0)
    buffer_store_dwordx4 v[76:79], v181, s[32:35], s53 offen nt
    s_branch L_fin
L_fin:
    s_cmp_lg_u32 s2, 0
    s_cbranch_scc1 L_noep
    s_mov_b32 s54, 0
    s_cmp_lg_u32 s48, 0
    s_cbranch_scc1 Lf6
    v_mov_b32 v14, s49
    v_mov_b32 v15, 0
    s_mov_b64 exec, 1
    buffer_store_dword v14, v15, s[36:39], s54 offen sc1
    s_mov_b64 exec, -1
Lf6:
L_noep:
L_exit:
    s_endpgm
L_mainend:
L_glob:
    s_add_u32 s53, s92, 0x8000
    s_waitcnt lgkmcnt(0)
    s_or_b32 s54, s47, s48
    s_cbranch_scc1 Lcib
    s_lshl_b32 s54, s46, 7
    s_add_u32 s54, s54, 9216
    v_mov_b32 v9, 0
    s_mov_b64 exec, 1
    buffer_store_dword v9, v9, s[36:39], s54 offen
    s_mov_b64 exec, -1
    Lcib:
    buffer_store_dwordx4 v[16:19], v120, s[36:39], s92 offen sc1
    buffer_store_dwordx4 v[20:23], v120, s[36:39], s53 offen sc1
    buffer_store_dwordx4 v[76:79], v5, s[36:39], s93 offen sc1
    buffer_store_dwordx4 v[80:83], v5, s[36:39], s93 offen offset:1024 sc1
    s_waitcnt vmcnt(6)
    v_alignbit_b32 v200, v185, v184, 16
    v_alignbit_b32 v201, v186, v185, 16
    v_alignbit_b32 v202, v187, v186, 16
    v_alignbit_b32 v203, v188, v187, 16
    v_alignbit_b32 v204, v189, v188, 16
    ds_write_b128 v111, v[184:187] offset:64
    ds_write_b64 v111, v[200:201] offset:4712
    ds_write_b64 v111, v[202:203] offset:4720
    ds_write_b32 v111, v185 offset:9416
    ds_write_b32 v111, v186 offset:9420
    ds_write_b32 v111, v187 offset:9424
    ds_write_b32 v111, v188 offset:9428
    ds_write_b32 v111, v201 offset:14056
    ds_write_b32 v111, v202 offset:14060
    ds_write_b32 v111, v203 offset:14064
    ds_write_b32 v111, v204 offset:14068
    s_waitcnt lgkmcnt(0)
    v_alignbit_b32 v200, v193, v192, 16
    v_alignbit_b32 v201, v194, v193, 16
    v_alignbit_b32 v202, v195, v194, 16
    v_alignbit_b32 v203, v196, v195, 16
    v_alignbit_b32 v204, v197, v196, 16
    ds_write_b128 v111, v[192:195] offset:1088
    ds_write_b64 v111, v[200:201] offset:5736
    ds_write_b64 v111, v[202:203] offset:5744
    ds_write_b32 v111, v193 offset:10440
    ds_write_b32 v111, v194 offset:10444
    ds_write_b32 v111, v195 offset:10448
    ds_write_b32 v111, v196 offset:10452
    ds_write_b32 v111, v201 offset:15080
    ds_write_b32 v111, v202 offset:15084
    ds_write_b32 v111, v203 offset:15088
    ds_write_b32 v111, v204 offset:15092
    s_waitcnt lgkmcnt(0)
    s_waitcnt vmcnt(0)
    s_barrier
    s_add_u32 s54, s61, 2048
    s_cmp_lg_u32 s48, 0
    s_cbranch_scc1 Lf7
    v_mov_b32 v14, s49
    v_mov_b32 v15, 0
    s_mov_b64 exec, 1
    buffer_store_dword v14, v15, s[36:39], s54 offen sc1
    s_mov_b64 exec, -1
Lf7:
    s_mov_b64 exec, 0xffffffff
    buffer_load_dword a255, v6, s[4:7], s95 offen
    s_mov_b64 exec, -1
    v_mov_b32 v16, 0
    v_mov_b32 v17, 0
    v_lshlrev_b32 v8, 3, v1
    v_add_u32 v8, s66, v8
    ds_write_b64 v8, v[16:17] offset:4096
    ds_read_u16 v104, v126 offset:0
    ds_read_u16 v105, v126 offset:2
    ds_read_u16 v106, v126 offset:4
    ds_read_u16 v107, v126 offset:6
    ds_read_u16 v108, v126 offset:8
    ds_read_u16 v109, v126 offset:10
    ds_read_u16 v110, v126 offset:12
    ds_read_u16 v111, v126 offset:14
    ds_read_b64 v[128:129], v121 offset:0
    ds_read_b64 v[130:131], v121 offset:8
    ds_read_b64 v[144:145], v121 offset:512
    ds_read_b64 v[146:147], v121 offset:520
    ds_read_b64 v[160:161], v121 offset:1024
    ds_read_b64 v[162:163], v121 offset:1032
    s_waitcnt lgkmcnt(6)
    ds_read_b64 v[176:177], v121 offset:1536
    v_cmp_eq_u32 vcc, 0, v117
    s_nop 1
    v_cndmask_b32 v104, v104, v112, vcc
    ds_read_b64 v[178:179], v121 offset:1544
    v_cmp_eq_u32 vcc, 1, v117
    s_nop 1
    v_cndmask_b32 v105, v105, v112, vcc
    v_lshl_or_b32 v122, v105, 16, v104
    ds_read_b64 v[192:193], v121 offset:2048
    v_cmp_eq_u32 vcc, 2, v117
    s_nop 1
    v_cndmask_b32 v106, v106, v112, vcc
    ds_read_b64 v[194:195], v121 offset:2056
    v_cmp_eq_u32 vcc, 3, v117
    s_nop 1
    v_cndmask_b32 v107, v107, v112, vcc
    v_lshl_or_b32 v123, v107, 16, v106
    ds_read_b64 v[208:209], v121 offset:2560
    v_cmp_eq_u32 vcc, 4, v117
    s_nop 1
    v_cndmask_b32 v108, v108, v112, vcc
    ds_read_b64 v[210:211], v121 offset:2568
    v_cmp_eq_u32 vcc, 5, v117
    s_nop 1
    v_cndmask_b32 v109, v109, v112, vcc
    v_lshl_or_b32 v124, v109, 16, v108
    ds_read_b64 v[224:225], v121 offset:3072
    v_cmp_eq_u32 vcc, 6, v117
    s_nop 1
    v_cndmask_b32 v110, v110, v112, vcc
    ds_read_b64 v[226:227], v121 offset:3080
    v_cmp_eq_u32 vcc, 7, v117
    s_nop 1
    v_cndmask_b32 v111, v111, v112, vcc
    v_lshl_or_b32 v125, v111, 16, v110
    s_waitcnt lgkmcnt(8)
    ds_read_b64 v[240:241], v121 offset:3584
    ds_read_b64 v[242:243], v121 offset:3592
    ds_read_b64 v[132:133], v121 offset:16
    ds_read_b64 v[134:135], v121 offset:24
    s_waitcnt lgkmcnt(10)
    ds_read_b64 v[148:149], v121 offset:528
    ds_read_b64 v[150:151], v121 offset:536
    ds_read_b64 v[164:165], v121 offset:1040
    ds_read_b64 v[166:167], v121 offset:1048
    s_waitcnt lgkmcnt(10)
    ds_read_b64 v[180:181], v121 offset:1552
    ds_read_b64 v[182:183], v121 offset:1560
    ds_read_b64 v[196:197], v121 offset:2064
    ds_read_b64 v[198:199], v121 offset:2072
    s_waitcnt lgkmcnt(10)
    ds_read_b64 v[212:213], v121 offset:2576
    ds_read_b64 v[214:215], v121 offset:2584
    ds_read_b64 v[228:229], v121 offset:3088
    ds_read_b64 v[230:231], v121 offset:3096
    s_waitcnt lgkmcnt(10)
    ds_read_b64 v[244:245], v121 offset:3600
    ds_read_b64 v[246:247], v121 offset:3608
    ds_read_b64 v[136:137], v121 offset:32
    ds_read_b64 v[138:139], v121 offset:40
    s_waitcnt lgkmcnt(10)
    ds_read_b64 v[152:153], v121 offset:544
    ds_read_b64 v[154:155], v121 offset:552
    ds_read_b64 v[168:169], v121 offset:1056
    ds_read_b64 v[170:171], v121 offset:1064
    s_waitcnt lgkmcnt(10)
    ds_read_b64 v[184:185], v121 offset:1568
    ds_read_b64 v[186:187], v121 offset:1576
    ds_read_b64 v[200:201], v121 offset:2080
    ds_read_b64 v[202:203], v121 offset:2088
    s_waitcnt lgkmcnt(10)
    ds_read_b64 v[216:217], v121 offset:2592
    ds_read_b64 v[218:219], v121 offset:2600
    ds_read_b64 v[232:233], v121 offset:3104
    ds_read_b64 v[234:235], v121 offset:3112
    s_waitcnt lgkmcnt(10)
    ds_read_b64 v[248:249], v121 offset:3616
    ds_read_b64 v[250:251], v121 offset:3624
    ds_read_b64 v[140:141], v121 offset:48
    ds_read_b64 v[142:143], v121 offset:56
    s_waitcnt lgkmcnt(10)
    ds_read_b64 v[156:157], v121 offset:560
    ds_read_b64 v[158:159], v121 offset:568
    ds_read_b64 v[172:173], v121 offset:1072
    ds_read_b64 v[174:175], v121 offset:1080
    s_waitcnt lgkmcnt(10)
    ds_read_b64 v[188:189], v121 offset:1584
    ds_read_b64 v[190:191], v121 offset:1592
    ds_read_b64 v[204:205], v121 offset:2096
    ds_read_b64 v[206:207], v121 offset:2104
    s_waitcnt lgkmcnt(10)
    ds_read_b64 v[220:221], v121 offset:2608
    ds_read_b64 v[222:223], v121 offset:2616
    ds_read_b64 v[236:237], v121 offset:3120
    ds_read_b64 v[238:239], v121 offset:3128
    s_waitcnt lgkmcnt(10)
    ds_read_b64 v[252:253], v121 offset:3632
    ds_read_b64 v[254:255], v121 offset:3640
    s_mov_b32 m0, s66
    v_mov_b32 v126, v87
    v_mov_b32 v0, v114
    s_mov_b32 s93, s19
    s_add_u32 s92, s19, 31744
    s_mov_b32 s94, s18
    s_mov_b32 s73, -1
    s_lshl_b32 s52, s46, 7
    v_and_b32 v8, 31, v1
    v_lshlrev_b32 v8, 2, v8
    v_mov_b32 v9, 1024
    v_cmp_lt_u32 vcc, 31, v1
    s_nop 1
    v_cndmask_b32 v9, 0, v9, vcc
    v_add_u32 v8, v8, v9
    s_add_u32 s52, s52, 1024
    s_mov_b32 s62, 0
Lp8:
    buffer_load_dword v9, v8, s[36:39], s52 offen sc1
    s_add_u32 s62, s62, 1
    s_cmp_gt_u32 s62, 1048576
    s_cbranch_scc1 Lpd9
    s_waitcnt vmcnt(0)
    v_cmp_eq_u32 vcc, s49, v9
    s_nop 0
    s_or_b32 s53, vcc_lo, vcc_hi
    s_and_b32 s53, s53, s73
    s_cmp_lg_u32 s53, s73
    s_cbranch_scc1 Lp8
Lpd9:
    s_waitcnt vmcnt(0)
    buffer_load_dwordx4 v5, s[36:39], s15 offen offset:0 sc1  lds
    buffer_load_dwordx4 v5, s[36:39], s15 offen offset:1024 sc1  lds
    buffer_load_dwordx4 v5, s[36:39], s15 offen offset:2048 sc1  lds
    buffer_load_dwordx4 v5, s[36:39], s15 offen offset:3072 sc1  lds
    s_waitcnt lgkmcnt(0)
    s_lshl_b32 s45, s48, 10
    s_waitcnt vmcnt(0)
    ds_read_b128 v[48:51], v2 offset:3584
    ds_read_b128 v[52:55], v2 offset:3600
    ds_read_b128 v[56:59], v2 offset:3616
    ds_read_b128 v[60:63], v2 offset:3632
    s_waitcnt lgkmcnt(3)
    v_mfma_f32_16x16x32_bf16 v[16:19], v[128:131], v[48:51], 0
    ds_read_b128 v[64:67], v2 offset:3072
    s_mov_b32 m0, s65
    s_nop 0
    buffer_load_dwordx4 v4, s[36:39], s93 offen sc1 lds
    buffer_load_dwordx4 v4, s[36:39], s92 offen offset:1024 sc1 lds
    s_add_u32 m0, m0, 2048
    s_nop 0
    v_mfma_f32_16x16x32_bf16 v[20:23], v[144:147], v[48:51], 0
    buffer_load_dwordx4 v5, s[36:39], s94 offen offset:0 sc1 lds
    buffer_load_dwordx4 v5, s[36:39], s94 offen offset:1024 sc1 lds
    v_mfma_f32_16x16x32_bf16 v[24:27], v[160:163], v[48:51], 0
    buffer_load_dwordx4 v5, s[36:39], s94 offen offset:2048 sc1 lds
    buffer_load_dwordx4 v5, s[36:39], s94 offen offset:3072 sc1 lds
    v_mfma_f32_16x16x32_bf16 v[28:31], v[176:179], v[48:51], 0
    v_mfma_f32_16x16x32_bf16 v[32:35], v[192:195], v[48:51], 0
    s_lshl_b64 exec, exec, 32
    buffer_load_dword a255, v6, s[4:7], s95 offen
    s_not_b64 exec, 0
    s_nop 3
    v_mfma_f32_16x16x32_bf16 v[36:39], v[208:211], v[48:51], 0
    v_mfma_f32_16x16x32_bf16 v[40:43], v[224:227], v[48:51], 0
    v_min_u32 v6, 55, v1
    v_lshlrev_b32 v6, 7, v6
    buffer_load_dword a255, v6, s[28:31], s96 offen
    v_mfma_f32_16x16x32_bf16 v[44:47], v[240:243], v[48:51], 0
    s_waitcnt lgkmcnt(3)
    v_mfma_f32_16x16x32_bf16 v[16:19], v[132:135], v[52:55], v[16:19]
    ds_read_b128 v[68:71], v2 offset:3088
    v_mfma_f32_16x16x32_bf16 v[20:23], v[148:151], v[52:55], v[20:23]
    v_mfma_f32_16x16x32_bf16 v[24:27], v[164:167], v[52:55], v[24:27]
    v_mfma_f32_16x16x32_bf16 v[28:31], v[180:183], v[52:55], v[28:31]
    v_mfma_f32_16x16x32_bf16 v[32:35], v[196:199], v[52:55], v[32:35]
    v_mfma_f32_16x16x32_bf16 v[36:39], v[212:215], v[52:55], v[36:39]
    v_mfma_f32_16x16x32_bf16 v[40:43], v[228:231], v[52:55], v[40:43]
    v_mfma_f32_16x16x32_bf16 v[44:47], v[244:247], v[52:55], v[44:47]
    s_waitcnt lgkmcnt(3)
    v_mfma_f32_16x16x32_bf16 v[16:19], v[136:139], v[56:59], v[16:19]
    ds_read_b128 v[72:75], v2 offset:3104
    v_mfma_f32_16x16x32_bf16 v[20:23], v[152:155], v[56:59], v[20:23]
    v_mfma_f32_16x16x32_bf16 v[24:27], v[168:171], v[56:59], v[24:27]
    v_mfma_f32_16x16x32_bf16 v[28:31], v[184:187], v[56:59], v[28:31]
    v_mfma_f32_16x16x32_bf16 v[32:35], v[200:203], v[56:59], v[32:35]
    v_mfma_f32_16x16x32_bf16 v[36:39], v[216:219], v[56:59], v[36:39]
    v_mfma_f32_16x16x32_bf16 v[40:43], v[232:235], v[56:59], v[40:43]
    v_mfma_f32_16x16x32_bf16 v[44:47], v[248:251], v[56:59], v[44:47]
    s_waitcnt lgkmcnt(3)
    v_mfma_f32_16x16x32_bf16 v[16:19], v[140:143], v[60:63], v[16:19]
    ds_read_b128 v[76:79], v2 offset:3120
    v_mfma_f32_16x16x32_bf16 v[20:23], v[156:159], v[60:63], v[20:23]
    v_mfma_f32_16x16x32_bf16 v[24:27], v[172:175], v[60:63], v[24:27]
    v_mfma_f32_16x16x32_bf16 v[28:31], v[188:191], v[60:63], v[28:31]
    v_mfma_f32_16x16x32_bf16 v[32:35], v[204:207], v[60:63], v[32:35]
    v_mfma_f32_16x16x32_bf16 v[36:39], v[220:223], v[60:63], v[36:39]
    v_mfma_f32_16x16x32_bf16 v[40:43], v[236:239], v[60:63], v[40:43]
    v_mfma_f32_16x16x32_bf16 v[44:47], v[252:255], v[60:63], v[44:47]
    s_waitcnt lgkmcnt(3)
    v_mfma_f32_16x16x32_bf16 v[20:23], v[128:131], v[64:67], v[20:23]
    ds_read_b128 v[48:51], v2 offset:2560
    v_mfma_f32_16x16x32_bf16 v[24:27], v[144:147], v[64:67], v[24:27]
    v_mfma_f32_16x16x32_bf16 v[28:31], v[160:163], v[64:67], v[28:31]
    v_mfma_f32_16x16x32_bf16 v[32:35], v[176:179], v[64:67], v[32:35]
    v_mfma_f32_16x16x32_bf16 v[36:39], v[192:195], v[64:67], v[36:39]
    v_mfma_f32_16x16x32_bf16 v[40:43], v[208:211], v[64:67], v[40:43]
    v_mfma_f32_16x16x32_bf16 v[44:47], v[224:227], v[64:67], v[44:47]
    s_waitcnt lgkmcnt(3)
    v_mfma_f32_16x16x32_bf16 v[20:23], v[132:135], v[68:71], v[20:23]
    ds_read_b128 v[52:55], v2 offset:2576
    v_mfma_f32_16x16x32_bf16 v[24:27], v[148:151], v[68:71], v[24:27]
    v_mfma_f32_16x16x32_bf16 v[28:31], v[164:167], v[68:71], v[28:31]
    v_mfma_f32_16x16x32_bf16 v[32:35], v[180:183], v[68:71], v[32:35]
    v_mfma_f32_16x16x32_bf16 v[36:39], v[196:199], v[68:71], v[36:39]
    v_mfma_f32_16x16x32_bf16 v[40:43], v[212:215], v[68:71], v[40:43]
    v_mfma_f32_16x16x32_bf16 v[44:47], v[228:231], v[68:71], v[44:47]
    s_waitcnt lgkmcnt(3)
    v_mfma_f32_16x16x32_bf16 v[20:23], v[136:139], v[72:75], v[20:23]
    ds_read_b128 v[56:59], v2 offset:2592
    v_mfma_f32_16x16x32_bf16 v[24:27], v[152:155], v[72:75], v[24:27]
    v_mfma_f32_16x16x32_bf16 v[28:31], v[168:171], v[72:75], v[28:31]
    v_mfma_f32_16x16x32_bf16 v[32:35], v[184:187], v[72:75], v[32:35]
    v_mfma_f32_16x16x32_bf16 v[36:39], v[200:203], v[72:75], v[36:39]
    v_mfma_f32_16x16x32_bf16 v[40:43], v[216:219], v[72:75], v[40:43]
    v_mfma_f32_16x16x32_bf16 v[44:47], v[232:235], v[72:75], v[44:47]
    s_waitcnt lgkmcnt(3)
    v_mfma_f32_16x16x32_bf16 v[20:23], v[140:143], v[76:79], v[20:23]
    ds_read_b128 v[60:63], v2 offset:2608
    v_mfma_f32_16x16x32_bf16 v[24:27], v[156:159], v[76:79], v[24:27]
    v_mfma_f32_16x16x32_bf16 v[28:31], v[172:175], v[76:79], v[28:31]
    v_mfma_f32_16x16x32_bf16 v[32:35], v[188:191], v[76:79], v[32:35]
    v_mfma_f32_16x16x32_bf16 v[36:39], v[204:207], v[76:79], v[36:39]
    v_mfma_f32_16x16x32_bf16 v[40:43], v[220:223], v[76:79], v[40:43]
    v_mfma_f32_16x16x32_bf16 v[44:47], v[236:239], v[76:79], v[44:47]
    s_waitcnt lgkmcnt(3)
    v_mfma_f32_16x16x32_bf16 v[24:27], v[128:131], v[48:51], v[24:27]
    ds_read_b128 v[64:67], v2 offset:2048
    v_mfma_f32_16x16x32_bf16 v[28:31], v[144:147], v[48:51], v[28:31]
    v_mfma_f32_16x16x32_bf16 v[32:35], v[160:163], v[48:51], v[32:35]
    v_mfma_f32_16x16x32_bf16 v[36:39], v[176:179], v[48:51], v[36:39]
    v_mfma_f32_16x16x32_bf16 v[40:43], v[192:195], v[48:51], v[40:43]
    v_mfma_f32_16x16x32_bf16 v[44:47], v[208:211], v[48:51], v[44:47]
    s_waitcnt lgkmcnt(3)
    v_mfma_f32_16x16x32_bf16 v[24:27], v[132:135], v[52:55], v[24:27]
    ds_read_b128 v[68:71], v2 offset:2064
    v_mfma_f32_16x16x32_bf16 v[28:31], v[148:151], v[52:55], v[28:31]
    v_mfma_f32_16x16x32_bf16 v[32:35], v[164:167], v[52:55], v[32:35]
    v_mfma_f32_16x16x32_bf16 v[36:39], v[180:183], v[52:55], v[36:39]
    v_mfma_f32_16x16x32_bf16 v[40:43], v[196:199], v[52:55], v[40:43]
    v_mfma_f32_16x16x32_bf16 v[44:47], v[212:215], v[52:55], v[44:47]
    s_waitcnt lgkmcnt(3)
    v_mfma_f32_16x16x32_bf16 v[24:27], v[136:139], v[56:59], v[24:27]
    ds_read_b128 v[72:75], v2 offset:2080
    v_mfma_f32_16x16x32_bf16 v[28:31], v[152:155], v[56:59], v[28:31]
    v_mfma_f32_16x16x32_bf16 v[32:35], v[168:171], v[56:59], v[32:35]
    v_mfma_f32_16x16x32_bf16 v[36:39], v[184:187], v[56:59], v[36:39]
    v_mfma_f32_16x16x32_bf16 v[40:43], v[200:203], v[56:59], v[40:43]
    v_mfma_f32_16x16x32_bf16 v[44:47], v[216:219], v[56:59], v[44:47]
    s_waitcnt lgkmcnt(3)
    v_mfma_f32_16x16x32_bf16 v[24:27], v[140:143], v[60:63], v[24:27]
    ds_read_b128 v[76:79], v2 offset:2096
    v_mfma_f32_16x16x32_bf16 v[28:31], v[156:159], v[60:63], v[28:31]
    v_mfma_f32_16x16x32_bf16 v[32:35], v[172:175], v[60:63], v[32:35]
    v_mfma_f32_16x16x32_bf16 v[36:39], v[188:191], v[60:63], v[36:39]
    v_mfma_f32_16x16x32_bf16 v[40:43], v[204:207], v[60:63], v[40:43]
    v_mfma_f32_16x16x32_bf16 v[44:47], v[220:223], v[60:63], v[44:47]
    s_waitcnt lgkmcnt(3)
    v_mfma_f32_16x16x32_bf16 v[28:31], v[128:131], v[64:67], v[28:31]
    ds_read_b128 v[48:51], v2 offset:1536
    s_waitcnt vmcnt(2)
    ds_read_b128 v[80:83], v0 offset:0
    ds_read_b128 v[84:87], v0 offset:1024
    v_mfma_f32_16x16x32_bf16 v[32:35], v[144:147], v[64:67], v[32:35]
    ds_read_b128 v[88:91], v116 offset:2048
    ds_read_b128 v[92:95], v116 offset:2064
    v_mfma_f32_16x16x32_bf16 v[36:39], v[160:163], v[64:67], v[36:39]
    ds_read_b128 v[96:99], v116 offset:2080
    ds_read_b128 v[100:103], v116 offset:2096
    v_mfma_f32_16x16x32_bf16 v[40:43], v[176:179], v[64:67], v[40:43]
    ds_read_b128 v[104:107], v116 offset:4096
    ds_read_b128 v[108:111], v116 offset:4112
    v_mfma_f32_16x16x32_bf16 v[44:47], v[192:195], v[64:67], v[44:47]
    ds_read_b128 v[112:115], v116 offset:4128
    ds_read_b128 v[116:119], v116 offset:4144
    s_waitcnt lgkmcnt(3)
    v_mfma_f32_16x16x32_bf16 v[28:31], v[132:135], v[68:71], v[28:31]
    ds_read_b128 v[52:55], v2 offset:1552
    v_mfma_f32_16x16x32_bf16 v[32:35], v[148:151], v[68:71], v[32:35]
    v_mfma_f32_16x16x32_bf16 v[36:39], v[164:167], v[68:71], v[36:39]
    v_mfma_f32_16x16x32_bf16 v[40:43], v[180:183], v[68:71], v[40:43]
    s_waitcnt lgkmcnt(0)
    v_mfma_f32_16x16x32_bf16 v[44:47], v[196:199], v[68:71], v[44:47]
    s_and_b32 s52, s49, 0xff
    s_bfe_u32 s53, s49, 0x80008
    s_bfe_u32 s54, s49, 0x80010
    s_lshr_b32 s55, s49, 24
    s_waitcnt lgkmcnt(3)
    v_mfma_f32_16x16x32_bf16 v[28:31], v[136:139], v[72:75], v[28:31]
    ds_read_b128 v[56:59], v2 offset:1568
    v_xor_b32 v88, s52, v88
    v_xor_b32 v89, s53, v89
    v_mfma_f32_16x16x32_bf16 v[32:35], v[152:155], v[72:75], v[32:35]
    v_xor_b32 v90, s54, v90
    v_xor_b32 v91, s55, v91
    v_mfma_f32_16x16x32_bf16 v[36:39], v[168:171], v[72:75], v[36:39]
    v_or3_b32 v8, v88, v89, 0
    v_or3_b32 v8, v90, v91, v8
    v_mfma_f32_16x16x32_bf16 v[40:43], v[184:187], v[72:75], v[40:43]
    v_xor_b32 v92, s52, v92
    v_xor_b32 v93, s53, v93
    v_mfma_f32_16x16x32_bf16 v[44:47], v[200:203], v[72:75], v[44:47]
    v_xor_b32 v94, s54, v94
    v_xor_b32 v95, s55, v95
    s_waitcnt lgkmcnt(3)
    v_mfma_f32_16x16x32_bf16 v[28:31], v[140:143], v[76:79], v[28:31]
    ds_read_b128 v[60:63], v2 offset:1584
    v_or3_b32 v8, v92, v93, v8
    v_or3_b32 v8, v94, v95, v8
    v_mfma_f32_16x16x32_bf16 v[32:35], v[156:159], v[76:79], v[32:35]
    v_xor_b32 v96, s52, v96
    v_xor_b32 v97, s53, v97
    v_mfma_f32_16x16x32_bf16 v[36:39], v[172:175], v[76:79], v[36:39]
    v_xor_b32 v98, s54, v98
    v_xor_b32 v99, s55, v99
    v_mfma_f32_16x16x32_bf16 v[40:43], v[188:191], v[76:79], v[40:43]
    v_or3_b32 v8, v96, v97, v8
    v_or3_b32 v8, v98, v99, v8
    v_mfma_f32_16x16x32_bf16 v[44:47], v[204:207], v[76:79], v[44:47]
    v_xor_b32 v100, s52, v100
    v_xor_b32 v101, s53, v101
    s_waitcnt lgkmcnt(3)
    v_mfma_f32_16x16x32_bf16 v[32:35], v[128:131], v[48:51], v[32:35]
    ds_read_b128 v[64:67], v2 offset:1024
    v_xor_b32 v102, s54, v102
    v_xor_b32 v103, s55, v103
    v_mfma_f32_16x16x32_bf16 v[36:39], v[144:147], v[48:51], v[36:39]
    v_or3_b32 v8, v100, v101, v8
    v_or3_b32 v8, v102, v103, v8
    v_mfma_f32_16x16x32_bf16 v[40:43], v[160:163], v[48:51], v[40:43]
    v_xor_b32 v104, s52, v104
    v_xor_b32 v105, s53, v105
    v_mfma_f32_16x16x32_bf16 v[44:47], v[176:179], v[48:51], v[44:47]
    v_xor_b32 v106, s54, v106
    v_xor_b32 v107, s55, v107
    s_waitcnt lgkmcnt(3)
    v_mfma_f32_16x16x32_bf16 v[32:35], v[132:135], v[52:55], v[32:35]
    ds_read_b128 v[68:71], v2 offset:1040
    v_or3_b32 v8, v104, v105, v8
    v_or3_b32 v8, v106, v107, v8
    v_mfma_f32_16x16x32_bf16 v[36:39], v[148:151], v[52:55], v[36:39]
    v_xor_b32 v108, s52, v108
    v_xor_b32 v109, s53, v109
    v_mfma_f32_16x16x32_bf16 v[40:43], v[164:167], v[52:55], v[40:43]
    v_xor_b32 v110, s54, v110
    v_xor_b32 v111, s55, v111
    v_mfma_f32_16x16x32_bf16 v[44:47], v[180:183], v[52:55], v[44:47]
    v_or3_b32 v8, v108, v109, v8
    v_or3_b32 v8, v110, v111, v8
    s_waitcnt lgkmcnt(3)
    v_mfma_f32_16x16x32_bf16 v[32:35], v[136:139], v[56:59], v[32:35]
    ds_read_b128 v[72:75], v2 offset:1056
    v_xor_b32 v112, s52, v112
    v_xor_b32 v113, s53, v113
    v_mfma_f32_16x16x32_bf16 v[36:39], v[152:155], v[56:59], v[36:39]
    v_xor_b32 v114, s54, v114
    v_xor_b32 v115, s55, v115
    v_mfma_f32_16x16x32_bf16 v[40:43], v[168:171], v[56:59], v[40:43]
    v_or3_b32 v8, v112, v113, v8
    v_or3_b32 v8, v114, v115, v8
    v_mfma_f32_16x16x32_bf16 v[44:47], v[184:187], v[56:59], v[44:47]
    v_xor_b32 v116, s52, v116
    v_xor_b32 v117, s53, v117
    s_waitcnt lgkmcnt(3)
    v_mfma_f32_16x16x32_bf16 v[32:35], v[140:143], v[60:63], v[32:35]
    ds_read_b128 v[76:79], v2 offset:1072
    v_xor_b32 v118, s54, v118
    v_xor_b32 v119, s55, v119
    v_mfma_f32_16x16x32_bf16 v[36:39], v[156:159], v[60:63], v[36:39]
    v_or3_b32 v8, v116, v117, v8
    v_or3_b32 v8, v118, v119, v8
    v_mfma_f32_16x16x32_bf16 v[40:43], v[172:175], v[60:63], v[40:43]
    v_and_b32 v8, 0xff, v8
    v_cmp_ne_u32 s[68:69], 0, v8
    v_mfma_f32_16x16x32_bf16 v[44:47], v[188:191], v[60:63], v[44:47]
    v_lshlrev_b32 v8, 16, v80
    v_fmac_f32 v89, v8, v88
    s_waitcnt lgkmcnt(3)
    v_mfma_f32_16x16x32_bf16 v[36:39], v[128:131], v[64:67], v[36:39]
    ds_read_b128 v[48:51], v2 offset:512
    v_and_b32 v9, 0xffff0000, v80
    v_fmac_f32 v91, v9, v90
    v_mfma_f32_16x16x32_bf16 v[40:43], v[144:147], v[64:67], v[40:43]
    v_lshlrev_b32 v10, 16, v81
    v_fmac_f32 v93, v10, v92
    v_mfma_f32_16x16x32_bf16 v[44:47], v[160:163], v[64:67], v[44:47]
    v_and_b32 v11, 0xffff0000, v81
    v_fmac_f32 v95, v11, v94
    s_waitcnt lgkmcnt(3)
    v_mfma_f32_16x16x32_bf16 v[36:39], v[132:135], v[68:71], v[36:39]
    ds_read_b128 v[52:55], v2 offset:528
    v_lshlrev_b32 v14, 16, v82
    v_fmac_f32 v97, v14, v96
    v_mfma_f32_16x16x32_bf16 v[40:43], v[148:151], v[68:71], v[40:43]
    v_and_b32 v15, 0xffff0000, v82
    v_fmac_f32 v99, v15, v98
    v_mfma_f32_16x16x32_bf16 v[44:47], v[164:167], v[68:71], v[44:47]
    v_lshlrev_b32 v120, 16, v83
    v_fmac_f32 v101, v120, v100
    s_waitcnt lgkmcnt(3)
    v_mfma_f32_16x16x32_bf16 v[36:39], v[136:139], v[72:75], v[36:39]
    ds_read_b128 v[56:59], v2 offset:544
    v_and_b32 v121, 0xffff0000, v83
    v_fmac_f32 v103, v121, v102
    v_mfma_f32_16x16x32_bf16 v[40:43], v[152:155], v[72:75], v[40:43]
    v_lshlrev_b32 v88, 16, v84
    v_fmac_f32 v105, v88, v104
    v_mfma_f32_16x16x32_bf16 v[44:47], v[168:171], v[72:75], v[44:47]
    v_and_b32 v90, 0xffff0000, v84
    v_fmac_f32 v107, v90, v106
    s_waitcnt lgkmcnt(3)
    v_mfma_f32_16x16x32_bf16 v[36:39], v[140:143], v[76:79], v[36:39]
    ds_read_b128 v[60:63], v2 offset:560
    v_lshlrev_b32 v92, 16, v85
    v_fmac_f32 v109, v92, v108
    v_mfma_f32_16x16x32_bf16 v[40:43], v[156:159], v[76:79], v[40:43]
    v_and_b32 v94, 0xffff0000, v85
    v_fmac_f32 v111, v94, v110
    v_mfma_f32_16x16x32_bf16 v[44:47], v[172:175], v[76:79], v[44:47]
    v_lshlrev_b32 v96, 16, v86
    v_fmac_f32 v113, v96, v112
    s_waitcnt lgkmcnt(3)
    v_mfma_f32_16x16x32_bf16 v[40:43], v[128:131], v[48:51], v[40:43]
    ds_read_b128 v[64:67], v2 offset:0
    v_and_b32 v98, 0xffff0000, v86
    v_fmac_f32 v115, v98, v114
    v_mfma_f32_16x16x32_bf16 v[44:47], v[144:147], v[48:51], v[44:47]
    v_lshlrev_b32 v100, 16, v87
    v_fmac_f32 v117, v100, v116
    s_waitcnt lgkmcnt(3)
    v_mfma_f32_16x16x32_bf16 v[40:43], v[132:135], v[52:55], v[40:43]
    ds_read_b128 v[68:71], v2 offset:16
    v_and_b32 v102, 0xffff0000, v87
    v_fmac_f32 v119, v102, v118
    v_mfma_f32_16x16x32_bf16 v[44:47], v[148:151], v[52:55], v[44:47]
    s_waitcnt lgkmcnt(3)
    v_mfma_f32_16x16x32_bf16 v[40:43], v[136:139], v[56:59], v[40:43]
    ds_read_b128 v[72:75], v2 offset:32
    v_mfma_f32_16x16x32_bf16 v[44:47], v[152:155], v[56:59], v[44:47]
    s_waitcnt lgkmcnt(3)
    v_mfma_f32_16x16x32_bf16 v[40:43], v[140:143], v[60:63], v[40:43]
    ds_read_b128 v[76:79], v2 offset:48
    v_mfma_f32_16x16x32_bf16 v[44:47], v[156:159], v[60:63], v[44:47]
    s_waitcnt lgkmcnt(3)
    v_mfma_f32_16x16x32_bf16 v[44:47], v[128:131], v[64:67], v[44:47]
    s_waitcnt lgkmcnt(2)
    v_mfma_f32_16x16x32_bf16 v[44:47], v[132:135], v[68:71], v[44:47]
    s_waitcnt lgkmcnt(1)
    v_mfma_f32_16x16x32_bf16 v[44:47], v[136:139], v[72:75], v[44:47]
    s_waitcnt lgkmcnt(0)
    v_mfma_f32_16x16x32_bf16 v[44:47], v[140:143], v[76:79], v[44:47]
    ds_read_b128 v[48:51], v3 offset:1536
    ds_read_b128 v[52:55], v3 offset:1024
    ds_read_b128 v[56:59], v3 offset:512
    ds_read_b128 v[60:63], v3 offset:0
    s_cmp_lg_u32 s72, 0
    s_cbranch_scc1 Lk1b
    s_waitcnt lgkmcnt(3)
    v_mfma_f32_16x16x32_bf16 v[16:19], v[122:125], v[48:51], v[16:19]
    s_waitcnt lgkmcnt(2)
    v_mfma_f32_16x16x32_bf16 v[20:23], v[122:125], v[52:55], v[20:23]
    s_waitcnt lgkmcnt(1)
    v_mfma_f32_16x16x32_bf16 v[24:27], v[122:125], v[56:59], v[24:27]
    s_waitcnt lgkmcnt(0)
    v_mfma_f32_16x16x32_bf16 v[28:31], v[122:125], v[60:63], v[28:31]
    s_branch Lkjb
Lk1b:
    s_waitcnt lgkmcnt(3)
    v_mfma_f32_16x16x32_bf16 v[32:35], v[122:125], v[48:51], v[32:35]
    s_waitcnt lgkmcnt(2)
    v_mfma_f32_16x16x32_bf16 v[36:39], v[122:125], v[52:55], v[36:39]
    s_waitcnt lgkmcnt(1)
    v_mfma_f32_16x16x32_bf16 v[40:43], v[122:125], v[56:59], v[40:43]
    s_waitcnt lgkmcnt(0)
    v_mfma_f32_16x16x32_bf16 v[44:47], v[122:125], v[60:63], v[44:47]
Lkjb:
    s_mov_b32 s62, 0
Lstb:
    s_cmp_eq_u64 s[68:69], 0
    s_cbranch_scc1 Lstob
    s_add_u32 s62, s62, 1
    s_cmp_gt_u32 s62, 1048576
    s_cbranch_scc1 Lstob
    s_sleep 4
    s_mov_b32 m0, s65
    s_nop 0
    buffer_load_dwordx4 v4, s[36:39], s93 offen sc1 lds
    buffer_load_dwordx4 v4, s[36:39], s92 offen offset:1024 sc1 lds
    s_add_u32 m0, m0, 2048
    s_nop 0
    buffer_load_dwordx4 v5, s[36:39], s94 offen offset:0 sc1 lds
    buffer_load_dwordx4 v5, s[36:39], s94 offen offset:1024 sc1 lds
    buffer_load_dwordx4 v5, s[36:39], s94 offen offset:2048 sc1 lds
    buffer_load_dwordx4 v5, s[36:39], s94 offen offset:3072 sc1 lds
    v_and_b32 v8, 3, v1
    v_lshrrev_b32 v9, 3, v1
    v_lshl_add_u32 v8, v9, 2, v8
    v_lshlrev_b32 v8, 6, v8
    v_add_u32 v116, s65, v8
    s_waitcnt vmcnt(0)
    ds_read_b128 v[80:83], v0 offset:0
    ds_read_b128 v[84:87], v0 offset:1024
    ds_read_b128 v[88:91], v116 offset:2048
    ds_read_b128 v[92:95], v116 offset:2064
    ds_read_b128 v[96:99], v116 offset:2080
    ds_read_b128 v[100:103], v116 offset:2096
    ds_read_b128 v[104:107], v116 offset:4096
    ds_read_b128 v[108:111], v116 offset:4112
    ds_read_b128 v[112:115], v116 offset:4128
    ds_read_b128 v[116:119], v116 offset:4144
    s_waitcnt lgkmcnt(0)
    s_and_b32 s52, s49, 0xff
    s_bfe_u32 s53, s49, 0x80008
    s_bfe_u32 s54, s49, 0x80010
    s_lshr_b32 s55, s49, 24
    v_xor_b32 v88, s52, v88
    v_xor_b32 v89, s53, v89
    v_xor_b32 v90, s54, v90
    v_xor_b32 v91, s55, v91
    v_or3_b32 v8, v88, v89, 0
    v_or3_b32 v8, v90, v91, v8
    v_xor_b32 v92, s52, v92
    v_xor_b32 v93, s53, v93
    v_xor_b32 v94, s54, v94
    v_xor_b32 v95, s55, v95
    v_or3_b32 v8, v92, v93, v8
    v_or3_b32 v8, v94, v95, v8
    v_xor_b32 v96, s52, v96
    v_xor_b32 v97, s53, v97
    v_xor_b32 v98, s54, v98
    v_xor_b32 v99, s55, v99
    v_or3_b32 v8, v96, v97, v8
    v_or3_b32 v8, v98, v99, v8
    v_xor_b32 v100, s52, v100
    v_xor_b32 v101, s53, v101
    v_xor_b32 v102, s54, v102
    v_xor_b32 v103, s55, v103
    v_or3_b32 v8, v100, v101, v8
    v_or3_b32 v8, v102, v103, v8
    v_xor_b32 v104, s52, v104
    v_xor_b32 v105, s53, v105
    v_xor_b32 v106, s54, v106
    v_xor_b32 v107, s55, v107
    v_or3_b32 v8, v104, v105, v8
    v_or3_b32 v8, v106, v107, v8
    v_xor_b32 v108, s52, v108
    v_xor_b32 v109, s53, v109
    v_xor_b32 v110, s54, v110
    v_xor_b32 v111, s55, v111
    v_or3_b32 v8, v108, v109, v8
    v_or3_b32 v8, v110, v111, v8
    v_xor_b32 v112, s52, v112
    v_xor_b32 v113, s53, v113
    v_xor_b32 v114, s54, v114
    v_xor_b32 v115, s55, v115
    v_or3_b32 v8, v112, v113, v8
    v_or3_b32 v8, v114, v115, v8
    v_xor_b32 v116, s52, v116
    v_xor_b32 v117, s53, v117
    v_xor_b32 v118, s54, v118
    v_xor_b32 v119, s55, v119
    v_or3_b32 v8, v116, v117, v8
    v_or3_b32 v8, v118, v119, v8
    v_and_b32 v8, 0xff, v8
    v_cmp_ne_u32 s[68:69], 0, v8
    v_lshlrev_b32 v8, 16, v80
    v_fmac_f32 v89, v8, v88
    v_and_b32 v9, 0xffff0000, v80
    v_fmac_f32 v91, v9, v90
    v_lshlrev_b32 v10, 16, v81
    v_fmac_f32 v93, v10, v92
    v_and_b32 v11, 0xffff0000, v81
    v_fmac_f32 v95, v11, v94
    v_lshlrev_b32 v14, 16, v82
    v_fmac_f32 v97, v14, v96
    v_and_b32 v15, 0xffff0000, v82
    v_fmac_f32 v99, v15, v98
    v_lshlrev_b32 v120, 16, v83
    v_fmac_f32 v101, v120, v100
    v_and_b32 v121, 0xffff0000, v83
    v_fmac_f32 v103, v121, v102
    v_lshlrev_b32 v88, 16, v84
    v_fmac_f32 v105, v88, v104
    v_and_b32 v90, 0xffff0000, v84
    v_fmac_f32 v107, v90, v106
    v_lshlrev_b32 v92, 16, v85
    v_fmac_f32 v109, v92, v108
    v_and_b32 v94, 0xffff0000, v85
    v_fmac_f32 v111, v94, v110
    v_lshlrev_b32 v96, 16, v86
    v_fmac_f32 v113, v96, v112
    v_and_b32 v98, 0xffff0000, v86
    v_fmac_f32 v115, v98, v114
    v_lshlrev_b32 v100, 16, v87
    v_fmac_f32 v117, v100, v116
    v_and_b32 v102, 0xffff0000, v87
    v_fmac_f32 v119, v102, v118
    s_branch Lstb
Lstob:
    s_nop 4
    ds_write_b128 v127, v[16:19] offset:0
    ds_write_b128 v127, v[20:23] offset:1024
    ds_write_b128 v127, v[24:27] offset:2048
    ds_write_b128 v127, v[28:31] offset:3072
    ds_write_b128 v127, v[32:35] offset:4096
    ds_write_b128 v127, v[36:39] offset:5120
    ds_write_b128 v127, v[40:43] offset:6144
    ds_write_b128 v127, v[44:47] offset:7168
    s_waitcnt vmcnt(0)
    s_waitcnt lgkmcnt(0)
    s_barrier
    ds_read_b128 v[16:19], v12 offset:0
    ds_read_b128 v[20:23], v13 offset:0
    ds_read_b128 v[24:27], v12 offset:8192
    ds_read_b128 v[28:31], v13 offset:8192
    ds_read_b128 v[32:35], v12 offset:1024
    ds_read_b128 v[36:39], v13 offset:1024
    ds_read_b128 v[40:43], v12 offset:9216
    ds_read_b128 v[44:47], v13 offset:9216
    s_add_u32 s56, s56, 0x100000
    s_add_u32 s55, s56, 0x40000
    s_waitcnt lgkmcnt(4)
    v_pk_add_f32 v[16:17], v[16:17], v[24:25]
    v_pk_add_f32 v[18:19], v[18:19], v[26:27]
    v_pk_add_f32 v[20:21], v[20:21], v[28:29]
    v_pk_add_f32 v[22:23], v[22:23], v[30:31]
    v_fmac_f32 v8, v89, v16
    v_fmac_f32 v9, v91, v17
    v_fmac_f32 v10, v93, v18
    v_fmac_f32 v11, v95, v19
    v_fmac_f32 v14, v97, v20
    v_fmac_f32 v15, v99, v21
    v_fmac_f32 v120, v101, v22
    v_fmac_f32 v121, v103, v23
    v_cvt_pk_bf16_f32 v16, v8, v9
    v_cvt_pk_bf16_f32 v17, v10, v11
    v_cvt_pk_bf16_f32 v18, v14, v15
    v_cvt_pk_bf16_f32 v19, v120, v121
    buffer_store_dwordx4 v[16:19], v7, s[36:39], s56 offen sc1
    s_waitcnt lgkmcnt(0)
    v_pk_add_f32 v[32:33], v[32:33], v[40:41]
    v_pk_add_f32 v[34:35], v[34:35], v[42:43]
    v_pk_add_f32 v[36:37], v[36:37], v[44:45]
    v_pk_add_f32 v[38:39], v[38:39], v[46:47]
    v_fmac_f32 v88, v105, v32
    v_fmac_f32 v90, v107, v33
    v_fmac_f32 v92, v109, v34
    v_fmac_f32 v94, v111, v35
    v_fmac_f32 v96, v113, v36
    v_fmac_f32 v98, v115, v37
    v_fmac_f32 v100, v117, v38
    v_fmac_f32 v102, v119, v39
    v_cvt_pk_bf16_f32 v32, v88, v90
    v_cvt_pk_bf16_f32 v33, v92, v94
    v_cvt_pk_bf16_f32 v34, v96, v98
    v_cvt_pk_bf16_f32 v35, v100, v102
    buffer_store_dwordx4 v[32:35], v7, s[36:39], s55 offen sc1
    v_lshrrev_b32 v2, 5, v1
    v_lshlrev_b32 v2, 2, v2
    v_bfe_u32 v12, v1, 2, 2
    v_add_u32 v2, v2, v12
    v_lshlrev_b32 v2, 6, v2
    v_bfe_u32 v12, v1, 4, 1
    v_lshl_add_u32 v2, v12, 5, v2
    v_and_b32 v12, 3, v1
    v_lshl_add_u32 v2, v12, 3, v2
    s_lshl_b32 s75, s46, 20
    s_add_u32 s75, s75, 0x800000
    s_lshr_b32 s8, s47, 3
    s_and_b32 s9, s47, 7
    s_lshr_b32 s53, s46, 1
    s_lshl_b32 s53, s53, 2
    s_add_u32 s53, s53, s8
    s_lshl_b32 s53, s53, 2
    s_add_u32 s10, s53, s48
    s_lshl_b32 s11, s10, 15
    s_lshl_b32 s53, s9, 12
    s_add_u32 s11, s11, s53
    s_lshl_b32 s53, s99, 11
    s_add_u32 s11, s11, s53
    s_add_u32 s11, s11, 0x100000
    s_lshl_b32 s57, s48, 12
    s_add_u32 s57, s57, 81920
    v_add_u32 v170, s57, v2
    v_lshrrev_b32 v3, 5, v1
    v_lshlrev_b32 v3, 2, v3
    v_bfe_u32 v8, v1, 2, 2
    v_add_u32 v3, v3, v8
    v_lshlrev_b32 v3, 7, v3
    v_bfe_u32 v8, v1, 4, 1
    v_lshl_add_u32 v3, v8, 5, v3
    v_and_b32 v8, 3, v1
    v_lshl_add_u32 v3, v8, 3, v3
    v_bfe_u32 v8, v1, 3, 1
    v_xor_b32 v8, s99, v8
    v_lshl_add_u32 v176, v8, 6, v3
    v_xor_b32 v173, 64, v176
    v_add_u32 v172, 131072, v173
    v_add_u32 v174, 0x10000, v173
    v_add_u32 v175, 131072, v176
    v_add_u32 v177, 0x10000, v176
    v_and_b32 v8, 31, v1
    v_lshlrev_b32 v171, 3, v8
    v_mul_u32_u24 v179, 80, v8
    v_lshrrev_b32 v9, 5, v1
    v_lshl_add_u32 v179, v9, 3, v179
    v_add_u32 v179, s57, v179
    v_lshrrev_b32 v8, 2, v1
    v_and_b32 v9, 3, v1
    v_mul_u32_u24 v180, 80, v8
    v_lshl_add_u32 v180, v9, 4, v180
    v_add_u32 v180, s57, v180
    v_lshlrev_b32 v181, 10, v8
    v_lshl_add_u32 v181, v9, 4, v181
    s_lshl_b32 s53, s8, 3
    s_lshl_b32 s73, 0x7f, s53
    s_lshl_b32 s16, s97, 3
    s_add_u32 s16, s16, s98
    s_lshl_b32 s16, s16, 2
    s_lshl_b32 s53, s46, 7
    s_add_u32 s16, s16, s53
    s_lshl_b32 s12, s8, 2
    s_add_u32 s12, s12, s48
    s_mul_i32 s13, s12, 57344
    s_add_u32 s13, s13, s75
    s_lshl_b32 s12, s12, 8
    s_add_u32 s12, s12, s75
    s_add_u32 s12, s12, 0xe0000
    v_and_b32 v178, 31, v1
    v_lshlrev_b32 v178, 2, v178
    v_mov_b32 v9, 1024
    v_cmp_lt_u32 vcc, 31, v1
    s_lshl_b32 s14, s46, 7
    s_cmp_lt_u32 s48, 2
    v_cndmask_b32 v9, 0, v9, vcc
    v_add_u32 v178, v178, v9
    s_cselect_b32 s53, 5120, 0
    s_add_u32 s14, s14, s53
    s_add_u32 s14, s14, 6144
    v_lshrrev_b32 v3, 5, v1
    v_lshlrev_b32 v3, 2, v3
    v_bfe_u32 v8, v1, 2, 2
    v_add_u32 v3, v3, v8
    v_lshlrev_b32 v3, 8, v3
    v_bfe_u32 v8, v1, 4, 1
    v_lshl_add_u32 v3, v8, 5, v3
    v_and_b32 v8, 3, v1
    v_lshl_add_u32 v3, v8, 3, v3
    s_lshl_b32 s52, s72, 1
    v_bfe_u32 v8, v1, 2, 2
    v_xor_b32 v8, s52, v8
    v_lshl_add_u32 v8, v8, 6, v3
    v_xor_b32 v9, 64, v8
    v_add_u32 v10, 0x10000, v8
    v_add_u32 v11, 0x10000, v9
    s_lshr_b32 s44, s48, 1
    s_lshl_b32 s52, s44, 6
    v_xor_b32 v8, s52, v8
    v_xor_b32 v9, s52, v9
    v_xor_b32 v10, s52, v10
    v_xor_b32 v11, s52, v11
    v_mov_b32 v112, 0x3f803f80
    v_mov_b32 v113, 0x3f803f80
    v_mov_b32 v114, 0x3f803f80
    v_mov_b32 v115, 0x3f803f80
    s_add_u32 m0, s45, 0
    s_nop 0
    buffer_load_dwordx4 v126, s[24:27], 0 offen  lds
    s_add_u32 m0, s45, 4096
    s_nop 0
    buffer_load_dwordx4 v126, s[24:27], s58 offen  lds
    s_add_u32 m0, s45, 8192
    s_nop 0
    buffer_load_dwordx4 v126, s[24:27], s59 offen  lds
    s_add_u32 m0, s45, 12288
    s_nop 0
    buffer_load_dwordx4 v126, s[24:27], s60 offen  lds
    s_add_u32 m0, s45, 16384
    v_add_u32 v126, 229376, v126
    buffer_load_dwordx4 v126, s[24:27], 0 offen  lds
    s_add_u32 m0, s45, 20480
    s_nop 0
    buffer_load_dwordx4 v126, s[24:27], s58 offen  lds
    s_add_u32 m0, s45, 24576
    s_nop 0
    buffer_load_dwordx4 v126, s[24:27], s59 offen  lds
    s_add_u32 m0, s45, 28672
    s_nop 0
    buffer_load_dwordx4 v126, s[24:27], s60 offen  lds
    s_waitcnt vmcnt(8)
    s_barrier
    s_lshl_b32 s54, s46, 7
    s_lshl_b32 s53, s47, 2
    s_add_u32 s54, s54, s53
    s_add_u32 s54, s54, 4096
    s_cmp_lg_u32 s48, 0
    s_cbranch_scc1 Lf10
    v_mov_b32 v14, s49
    v_mov_b32 v15, 0
    s_mov_b64 exec, 1
    buffer_store_dword v14, v15, s[36:39], s54 offen sc1
    s_mov_b64 exec, -1
Lf10:
    s_add_u32 m0, s45, 32768
    v_add_u32 v126, 229376, v126
    buffer_load_dwordx4 v126, s[24:27], 0 offen  lds
    s_add_u32 m0, s45, 36864
    s_nop 0
    buffer_load_dwordx4 v126, s[24:27], s58 offen  lds
    s_add_u32 m0, s45, 40960
    s_nop 0
    buffer_load_dwordx4 v126, s[24:27], s59 offen  lds
    s_add_u32 m0, s45, 45056
    s_nop 0
    buffer_load_dwordx4 v126, s[24:27], s60 offen  lds
    s_lshr_b32 s44, s48, 1
    s_lshl_b32 s52, s44, 15
    v_add_u32 v121, s52, v2
    v_add_u32 v122, 0x10000, v121
    s_lshl_b32 s53, s48, 13
    v_add_u32 v123, s53, v2
    s_lshl_b32 s56, s97, 2
    s_add_u32 s56, s56, s44
    s_mul_i32 s55, s56, 57344
    s_lshl_b32 s52, s98, 13
    s_add_u32 s55, s55, s52
    s_lshl_b32 s52, s72, 12
    s_add_u32 s55, s55, s52
    s_lshl_b32 s75, s46, 20
    s_add_u32 s75, s75, 0x800000
    s_add_u32 s55, s55, s75
    s_lshl_b32 s56, s56, 8
    s_add_u32 s56, s56, s75
    s_add_u32 s56, s56, 0xe0000
    v_lshrrev_b32 v12, 3, v1
    v_bfe_u32 v13, v1, 4, 1
    v_lshlrev_b32 v13, 2, v13
    v_and_b32 v14, 7, v1
    v_xor_b32 v13, v13, v14
    v_lshlrev_b32 v12, 10, v12
    v_lshl_add_u32 v12, v13, 4, v12
    s_mul_i32 s52, s99, 917504
    s_mul_i32 s53, s48, 57344
    s_add_u32 s52, s52, s53
    s_and_b32 s53, s47, 7
    s_lshl_b32 s53, s53, 7
    s_add_u32 s52, s52, s53
    v_add_u32 v127, s52, v12
    s_mul_i32 s74, s48, 7168
    s_waitcnt vmcnt(4)
    s_barrier
    s_add_u32 m0, s45, 49152
    ds_read_b64_tr_b16 a[0:1], v8 offset:0
    ds_read_b64_tr_b16 a[2:3], v8 offset:2048
    ds_read_b64_tr_b16 a[4:5], v9 offset:0
    ds_read_b64_tr_b16 a[6:7], v9 offset:2048
    v_add_u32 v126, 229376, v126
    buffer_load_dwordx4 v126, s[24:27], 0 offen  lds
    s_waitcnt lgkmcnt(8)
    s_add_u32 m0, s45, 53248
    ds_read_b64_tr_b16 a[8:9], v8 offset:4096
    ds_read_b64_tr_b16 a[10:11], v8 offset:6144
    ds_read_b64_tr_b16 a[12:13], v9 offset:4096
    ds_read_b64_tr_b16 a[14:15], v9 offset:6144
    buffer_load_dwordx4 v126, s[24:27], s58 offen  lds
    s_waitcnt lgkmcnt(8)
    s_add_u32 m0, s45, 57344
    ds_read_b64_tr_b16 a[16:17], v8 offset:8192
    ds_read_b64_tr_b16 a[18:19], v8 offset:10240
    ds_read_b64_tr_b16 a[20:21], v9 offset:8192
    ds_read_b64_tr_b16 a[22:23], v9 offset:10240
    buffer_load_dwordx4 v126, s[24:27], s59 offen  lds
    s_waitcnt lgkmcnt(8)
    v_mfma_f32_32x32x16_bf16 v[80:95], a[0:3], v[112:115], 0
    s_add_u32 m0, s45, 61440
    ds_read_b64_tr_b16 a[24:25], v8 offset:12288
    ds_read_b64_tr_b16 a[26:27], v8 offset:14336
    ds_read_b64_tr_b16 a[28:29], v9 offset:12288
    ds_read_b64_tr_b16 a[30:31], v9 offset:14336
    buffer_load_dwordx4 v126, s[24:27], s60 offen  lds
    s_waitcnt lgkmcnt(8)
    v_mfma_f32_32x32x16_bf16 v[80:95], a[8:11], v[112:115], v[80:95]
    s_add_u32 m0, s45, 65536
    ds_read_b64_tr_b16 a[32:33], v8 offset:16384
    ds_read_b64_tr_b16 a[34:35], v8 offset:18432
    ds_read_b64_tr_b16 a[36:37], v9 offset:16384
    ds_read_b64_tr_b16 a[38:39], v9 offset:18432
    v_add_u32 v126, 229376, v126
    buffer_load_dwordx4 v126, s[24:27], 0 offen  lds
    s_waitcnt lgkmcnt(8)
    v_mfma_f32_32x32x16_bf16 v[80:95], a[16:19], v[112:115], v[80:95]
    s_add_u32 m0, s45, 69632
    ds_read_b64_tr_b16 a[40:41], v8 offset:20480
    ds_read_b64_tr_b16 a[42:43], v8 offset:22528
    ds_read_b64_tr_b16 a[44:45], v9 offset:20480
    ds_read_b64_tr_b16 a[46:47], v9 offset:22528
    buffer_load_dwordx4 v126, s[24:27], s58 offen  lds
    s_waitcnt lgkmcnt(8)
    v_mfma_f32_32x32x16_bf16 v[80:95], a[24:27], v[112:115], v[80:95]
    s_add_u32 m0, s45, 73728
    ds_read_b64_tr_b16 a[48:49], v8 offset:24576
    ds_read_b64_tr_b16 a[50:51], v8 offset:26624
    ds_read_b64_tr_b16 a[52:53], v9 offset:24576
    ds_read_b64_tr_b16 a[54:55], v9 offset:26624
    buffer_load_dwordx4 v126, s[24:27], s59 offen  lds
    s_waitcnt lgkmcnt(8)
    v_mfma_f32_32x32x16_bf16 v[80:95], a[32:35], v[112:115], v[80:95]
    s_add_u32 m0, s45, 77824
    ds_read_b64_tr_b16 a[56:57], v8 offset:28672
    ds_read_b64_tr_b16 a[58:59], v8 offset:30720
    ds_read_b64_tr_b16 a[60:61], v9 offset:28672
    ds_read_b64_tr_b16 a[62:63], v9 offset:30720
    buffer_load_dwordx4 v126, s[24:27], s60 offen  lds
    s_waitcnt lgkmcnt(8)
    v_mfma_f32_32x32x16_bf16 v[80:95], a[40:43], v[112:115], v[80:95]
    s_waitcnt vmcnt(4)
    s_barrier
    s_add_u32 m0, s45, 81920
    ds_read_b64_tr_b16 a[64:65], v8 offset:32768
    ds_read_b64_tr_b16 a[66:67], v8 offset:34816
    ds_read_b64_tr_b16 a[68:69], v9 offset:32768
    ds_read_b64_tr_b16 a[70:71], v9 offset:34816
    v_add_u32 v126, 229376, v126
    buffer_load_dwordx4 v126, s[24:27], 0 offen  lds
    s_waitcnt lgkmcnt(8)
    v_mfma_f32_32x32x16_bf16 v[80:95], a[48:51], v[112:115], v[80:95]
    s_add_u32 m0, s45, 86016
    ds_read_b64_tr_b16 a[72:73], v8 offset:36864
    ds_read_b64_tr_b16 a[74:75], v8 offset:38912
    ds_read_b64_tr_b16 a[76:77], v9 offset:36864
    ds_read_b64_tr_b16 a[78:79], v9 offset:38912
    buffer_load_dwordx4 v126, s[24:27], s58 offen  lds
    s_waitcnt lgkmcnt(8)
    v_mfma_f32_32x32x16_bf16 v[80:95], a[56:59], v[112:115], v[80:95]
    s_add_u32 m0, s45, 90112
    ds_read_b64_tr_b16 a[80:81], v8 offset:40960
    ds_read_b64_tr_b16 a[82:83], v8 offset:43008
    ds_read_b64_tr_b16 a[84:85], v9 offset:40960
    ds_read_b64_tr_b16 a[86:87], v9 offset:43008
    buffer_load_dwordx4 v126, s[24:27], s59 offen  lds
    s_waitcnt lgkmcnt(8)
    v_mfma_f32_32x32x16_bf16 v[80:95], a[64:67], v[112:115], v[80:95]
    s_add_u32 m0, s45, 94208
    ds_read_b64_tr_b16 a[88:89], v8 offset:45056
    ds_read_b64_tr_b16 a[90:91], v8 offset:47104
    ds_read_b64_tr_b16 a[92:93], v9 offset:45056
    ds_read_b64_tr_b16 a[94:95], v9 offset:47104
    buffer_load_dwordx4 v126, s[24:27], s60 offen  lds
    s_waitcnt lgkmcnt(8)
    v_mfma_f32_32x32x16_bf16 v[80:95], a[72:75], v[112:115], v[80:95]
    s_add_u32 m0, s45, 98304
    ds_read_b64_tr_b16 a[96:97], v8 offset:49152
    ds_read_b64_tr_b16 a[98:99], v8 offset:51200
    ds_read_b64_tr_b16 a[100:101], v9 offset:49152
    ds_read_b64_tr_b16 a[102:103], v9 offset:51200
    v_add_u32 v126, 229376, v126
    buffer_load_dwordx4 v126, s[24:27], 0 offen  lds
    s_waitcnt lgkmcnt(8)
    v_mfma_f32_32x32x16_bf16 v[80:95], a[80:83], v[112:115], v[80:95]
    s_add_u32 m0, s45, 102400
    ds_read_b64_tr_b16 a[104:105], v8 offset:53248
    ds_read_b64_tr_b16 a[106:107], v8 offset:55296
    ds_read_b64_tr_b16 a[108:109], v9 offset:53248
    ds_read_b64_tr_b16 a[110:111], v9 offset:55296
    buffer_load_dwordx4 v126, s[24:27], s58 offen  lds
    s_waitcnt lgkmcnt(8)
    v_mfma_f32_32x32x16_bf16 v[80:95], a[88:91], v[112:115], v[80:95]
    s_add_u32 m0, s45, 106496
    ds_read_b64_tr_b16 a[112:113], v8 offset:57344
    ds_read_b64_tr_b16 a[114:115], v8 offset:59392
    ds_read_b64_tr_b16 a[116:117], v9 offset:57344
    ds_read_b64_tr_b16 a[118:119], v9 offset:59392
    buffer_load_dwordx4 v126, s[24:27], s59 offen  lds
    s_waitcnt lgkmcnt(8)
    v_mfma_f32_32x32x16_bf16 v[80:95], a[96:99], v[112:115], v[80:95]
    s_add_u32 m0, s45, 110592
    ds_read_b64_tr_b16 a[120:121], v8 offset:61440
    ds_read_b64_tr_b16 a[122:123], v8 offset:63488
    ds_read_b64_tr_b16 a[124:125], v9 offset:61440
    ds_read_b64_tr_b16 a[126:127], v9 offset:63488
    buffer_load_dwordx4 v126, s[24:27], s60 offen  lds
    s_waitcnt lgkmcnt(8)
    v_mfma_f32_32x32x16_bf16 v[80:95], a[104:107], v[112:115], v[80:95]
    s_waitcnt vmcnt(4)
    s_barrier
    s_add_u32 m0, s45, 114688
    ds_read_b64_tr_b16 a[128:129], v10 offset:0
    ds_read_b64_tr_b16 a[130:131], v10 offset:2048
    ds_read_b64_tr_b16 a[132:133], v11 offset:0
    ds_read_b64_tr_b16 a[134:135], v11 offset:2048
    v_add_u32 v126, 229376, v126
    buffer_load_dwordx4 v126, s[24:27], 0 offen  lds
    s_waitcnt lgkmcnt(8)
    v_mfma_f32_32x32x16_bf16 v[80:95], a[112:115], v[112:115], v[80:95]
    s_add_u32 m0, s45, 118784
    ds_read_b64_tr_b16 a[136:137], v10 offset:4096
    ds_read_b64_tr_b16 a[138:139], v10 offset:6144
    ds_read_b64_tr_b16 a[140:141], v11 offset:4096
    ds_read_b64_tr_b16 a[142:143], v11 offset:6144
    buffer_load_dwordx4 v126, s[24:27], s58 offen  lds
    s_waitcnt lgkmcnt(8)
    v_mfma_f32_32x32x16_bf16 v[80:95], a[120:123], v[112:115], v[80:95]
    s_add_u32 m0, s45, 122880
    ds_read_b64_tr_b16 a[144:145], v10 offset:8192
    ds_read_b64_tr_b16 a[146:147], v10 offset:10240
    ds_read_b64_tr_b16 a[148:149], v11 offset:8192
    ds_read_b64_tr_b16 a[150:151], v11 offset:10240
    buffer_load_dwordx4 v126, s[24:27], s59 offen  lds
    s_waitcnt lgkmcnt(8)
    v_mfma_f32_32x32x16_bf16 v[80:95], a[128:131], v[112:115], v[80:95]
    s_add_u32 m0, s45, 126976
    ds_read_b64_tr_b16 a[152:153], v10 offset:12288
    ds_read_b64_tr_b16 a[154:155], v10 offset:14336
    ds_read_b64_tr_b16 a[156:157], v11 offset:12288
    ds_read_b64_tr_b16 a[158:159], v11 offset:14336
    buffer_load_dwordx4 v126, s[24:27], s60 offen  lds
    s_waitcnt lgkmcnt(8)
    v_mfma_f32_32x32x16_bf16 v[80:95], a[136:139], v[112:115], v[80:95]
    ds_read_b64_tr_b16 a[160:161], v10 offset:16384
    ds_read_b64_tr_b16 a[162:163], v10 offset:18432
    ds_read_b64_tr_b16 a[164:165], v11 offset:16384
    ds_read_b64_tr_b16 a[166:167], v11 offset:18432
    s_waitcnt lgkmcnt(8)
    v_mfma_f32_32x32x16_bf16 v[80:95], a[144:147], v[112:115], v[80:95]
    ds_read_b64_tr_b16 a[168:169], v10 offset:20480
    ds_read_b64_tr_b16 a[170:171], v10 offset:22528
    ds_read_b64_tr_b16 a[172:173], v11 offset:20480
    ds_read_b64_tr_b16 a[174:175], v11 offset:22528
    s_waitcnt lgkmcnt(8)
    v_mfma_f32_32x32x16_bf16 v[80:95], a[152:155], v[112:115], v[80:95]
    ds_read_b64_tr_b16 a[176:177], v10 offset:24576
    ds_read_b64_tr_b16 a[178:179], v10 offset:26624
    ds_read_b64_tr_b16 a[180:181], v11 offset:24576
    ds_read_b64_tr_b16 a[182:183], v11 offset:26624
    s_waitcnt lgkmcnt(8)
    v_mfma_f32_32x32x16_bf16 v[80:95], a[160:163], v[112:115], v[80:95]
    ds_read_b64_tr_b16 a[184:185], v10 offset:28672
    ds_read_b64_tr_b16 a[186:187], v10 offset:30720
    ds_read_b64_tr_b16 a[188:189], v11 offset:28672
    ds_read_b64_tr_b16 a[190:191], v11 offset:30720
    s_waitcnt lgkmcnt(8)
    v_mfma_f32_32x32x16_bf16 v[80:95], a[168:171], v[112:115], v[80:95]
    s_mov_b32 s58, 7168
    s_mov_b32 s59, 14336
    s_mov_b32 s60, 21504
    s_cmp_lg_u32 s48, 0
    s_cbranch_scc1 Lf2db
    v_and_b32 v13, 7, v1
    v_lshlrev_b32 v13, 7, v13
    s_mov_b32 s52, 10240
    s_mov_b32 s62, 0
Lgb:
    buffer_load_dword v12, v13, s[36:39], s52 offen sc1
    s_add_u32 s62, s62, 1
    s_waitcnt vmcnt(0)
    v_cmp_ne_u32 vcc, s49, v12
    s_cbranch_vccz Lf2db
    s_cmp_lt_u32 s62, 1
    s_cbranch_scc1 Lgb
    s_mov_b32 s52, 4096
    s_mov_b32 s62, 0
Lf2b:
    buffer_load_dwordx4 v[12:15], v5, s[36:39], s52 offen sc1
    s_add_u32 s62, s62, 1
    s_cmp_gt_u32 s62, 1048576
    s_cbranch_scc1 Lf2db
Lf2bc:
    s_waitcnt vmcnt(0)
    v_xor_b32 v12, s49, v12
    v_xor_b32 v13, s49, v13
    v_xor_b32 v14, s49, v14
    v_xor_b32 v15, s49, v15
    v_or_b32 v12, v12, v13
    v_or3_b32 v12, v12, v14, v15
    v_cmp_ne_u32 vcc, 0, v12
    s_cbranch_vccnz Lf2b
Lf2db:
    s_waitcnt vmcnt(0) lgkmcnt(0)
    s_barrier
    s_cmp_ge_u32 s47, 28
    s_cbranch_scc1 Lswb
    s_lshl_b32 s53, s44, 15
    s_lshl_b32 s52, s72, 13
    s_add_u32 s53, s53, s52
    s_lshl_b32 s52, s64, 17
    s_add_u32 s52, s52, s53
    s_mov_b32 m0, s53
    s_add_u32 s52, s52, 0x100000
    buffer_load_dwordx4 v5, s[36:39], s52 offen offset:0 sc1 lds
    buffer_load_dwordx4 v5, s[36:39], s52 offen offset:1024 sc1 lds
    buffer_load_dwordx4 v5, s[36:39], s52 offen offset:2048 sc1 lds
    buffer_load_dwordx4 v5, s[36:39], s52 offen offset:3072 sc1 lds
    s_add_u32 m0, m0, 4096
    s_add_u32 s52, s52, 4096
    buffer_load_dwordx4 v5, s[36:39], s52 offen offset:0 sc1 lds
    buffer_load_dwordx4 v5, s[36:39], s52 offen offset:1024 sc1 lds
    ds_read_b64_tr_b16 a[192:193], v10 offset:32768
    ds_read_b64_tr_b16 a[194:195], v10 offset:34816
    ds_read_b64_tr_b16 a[196:197], v11 offset:32768
    ds_read_b64_tr_b16 a[198:199], v11 offset:34816
    buffer_load_dwordx4 v5, s[36:39], s52 offen offset:2048 sc1 lds
    s_waitcnt lgkmcnt(8)
    v_mfma_f32_32x32x16_bf16 v[80:95], a[176:179], v[112:115], v[80:95]
    ds_read_b64_tr_b16 a[200:201], v10 offset:36864
    ds_read_b64_tr_b16 a[202:203], v10 offset:38912
    ds_read_b64_tr_b16 a[204:205], v11 offset:36864
    ds_read_b64_tr_b16 a[206:207], v11 offset:38912
    buffer_load_dwordx4 v5, s[36:39], s52 offen offset:3072 sc1 lds
    s_waitcnt lgkmcnt(8)
    v_mfma_f32_32x32x16_bf16 v[80:95], a[184:187], v[112:115], v[80:95]
    ds_read_b64_tr_b16 a[208:209], v10 offset:40960
    ds_read_b64_tr_b16 a[210:211], v10 offset:43008
    ds_read_b64_tr_b16 a[212:213], v11 offset:40960
    ds_read_b64_tr_b16 a[214:215], v11 offset:43008
    s_add_u32 m0, m0, 12288
    s_add_u32 s52, s52, 12288
    buffer_load_dwordx4 v5, s[36:39], s52 offen offset:0 sc1 lds
    s_waitcnt lgkmcnt(8)
    v_mfma_f32_32x32x16_bf16 v[80:95], a[192:195], v[112:115], v[80:95]
    ds_read_b64_tr_b16 a[216:217], v10 offset:45056
    ds_read_b64_tr_b16 a[218:219], v10 offset:47104
    ds_read_b64_tr_b16 a[220:221], v11 offset:45056
    ds_read_b64_tr_b16 a[222:223], v11 offset:47104
    buffer_load_dwordx4 v5, s[36:39], s52 offen offset:1024 sc1 lds
    s_waitcnt lgkmcnt(8)
    v_mfma_f32_32x32x16_bf16 v[80:95], a[200:203], v[112:115], v[80:95]
    ds_read_b64_tr_b16 a[224:225], v10 offset:49152
    ds_read_b64_tr_b16 a[226:227], v10 offset:51200
    ds_read_b64_tr_b16 a[228:229], v11 offset:49152
    ds_read_b64_tr_b16 a[230:231], v11 offset:51200
    buffer_load_dwordx4 v5, s[36:39], s52 offen offset:2048 sc1 lds
    s_waitcnt lgkmcnt(8)
    v_mfma_f32_32x32x16_bf16 v[80:95], a[208:211], v[112:115], v[80:95]
    ds_read_b64_tr_b16 a[232:233], v10 offset:53248
    ds_read_b64_tr_b16 a[234:235], v10 offset:55296
    ds_read_b64_tr_b16 a[236:237], v11 offset:53248
    ds_read_b64_tr_b16 a[238:239], v11 offset:55296
    buffer_load_dwordx4 v5, s[36:39], s52 offen offset:3072 sc1 lds
    s_waitcnt lgkmcnt(8)
    v_mfma_f32_32x32x16_bf16 v[80:95], a[216:219], v[112:115], v[80:95]
    ds_read_b64_tr_b16 a[240:241], v10 offset:57344
    ds_read_b64_tr_b16 a[242:243], v10 offset:59392
    ds_read_b64_tr_b16 a[244:245], v11 offset:57344
    ds_read_b64_tr_b16 a[246:247], v11 offset:59392
    s_waitcnt lgkmcnt(8)
    v_mfma_f32_32x32x16_bf16 v[80:95], a[224:227], v[112:115], v[80:95]
    ds_read_b64_tr_b16 a[248:249], v10 offset:61440
    ds_read_b64_tr_b16 a[250:251], v10 offset:63488
    ds_read_b64_tr_b16 a[252:253], v11 offset:61440
    ds_read_b64_tr_b16 a[254:255], v11 offset:63488
    s_waitcnt lgkmcnt(8)
    v_mfma_f32_32x32x16_bf16 v[80:95], a[232:235], v[112:115], v[80:95]
    s_waitcnt lgkmcnt(0)
    v_mfma_f32_32x32x16_bf16 v[80:95], a[240:243], v[112:115], v[80:95]
    v_mfma_f32_32x32x16_bf16 v[80:95], a[248:251], v[112:115], v[80:95]
    v_lshrrev_b32 v6, 5, v1
    v_lshlrev_b32 v6, 6, v6
    s_lshl_b32 s53, s48, 7
    s_add_u32 s53, s53, 159744
    v_add_u32 v6, s53, v6
    v_xor_b32 v7, 256, v6
    s_nop 3
    s_mov_b32 exec_lo, 1
    s_mov_b32 exec_hi, 1
    ds_write_b128 v6, v[80:83] offset:0
    ds_write_b128 v6, v[84:87] offset:16
    ds_write_b128 v6, v[88:91] offset:32
    ds_write_b128 v6, v[92:95] offset:48
    s_mov_b64 exec, -1
    v_and_b32 v8, 31, v1
    v_lshlrev_b32 v4, 3, v8
    s_lshl_b32 s53, s44, 11
    v_add_u32 v182, s53, v5
    v_xor_b32 v183, 2048, v182
    s_waitcnt vmcnt(4)
    s_waitcnt lgkmcnt(0)
    s_barrier
    ds_read_b128 v[96:99], v7 offset:0
    ds_read_b128 v[100:103], v7 offset:16
    ds_read_b128 v[104:107], v7 offset:32
    ds_read_b128 v[108:111], v7 offset:48
    ds_read_b64_tr_b16 v[128:129], v121 offset:0
    ds_read_b64_tr_b16 v[130:131], v121 offset:512
    ds_read_b64_tr_b16 v[132:133], v121 offset:1024
    ds_read_b64_tr_b16 v[134:135], v121 offset:1536
    ds_read_b64_tr_b16 v[136:137], v121 offset:2048
    ds_read_b64_tr_b16 v[138:139], v121 offset:2560
    ds_read_b64_tr_b16 v[140:141], v121 offset:3072
    ds_read_b64_tr_b16 v[142:143], v121 offset:3584
    ds_read_b64_tr_b16 v[144:145], v121 offset:4096
    ds_read_b64_tr_b16 v[146:147], v121 offset:4608
    s_waitcnt lgkmcnt(8)
    v_mfma_f32_32x32x16_bf16 v[16:31], a[0:3], v[128:131], 0
    ds_read_b64_tr_b16 v[148:149], v121 offset:5120
    v_mfma_f32_32x32x16_bf16 v[32:47], a[4:7], v[128:131], 0
    ds_read_b64_tr_b16 v[150:151], v121 offset:5632
    s_add_u32 m0, m0, 4096
    s_add_u32 s52, s52, 4096
    buffer_load_dwordx4 v5, s[36:39], s52 offen offset:0 sc1 lds
    s_waitcnt lgkmcnt(8)
    v_mfma_f32_32x32x16_bf16 v[16:31], a[8:11], v[132:135], v[16:31]
    ds_read_b64_tr_b16 v[152:153], v121 offset:6144
    v_mfma_f32_32x32x16_bf16 v[32:47], a[12:15], v[132:135], v[32:47]
    ds_read_b64_tr_b16 v[154:155], v121 offset:6656
    buffer_load_dwordx4 v5, s[36:39], s52 offen offset:1024 sc1 lds
    s_waitcnt lgkmcnt(8)
    v_mfma_f32_32x32x16_bf16 v[16:31], a[16:19], v[136:139], v[16:31]
    ds_read_b64_tr_b16 v[156:157], v121 offset:7168
    v_mfma_f32_32x32x16_bf16 v[32:47], a[20:23], v[136:139], v[32:47]
    ds_read_b64_tr_b16 v[158:159], v121 offset:7680
    buffer_load_dwordx4 v5, s[36:39], s52 offen offset:2048 sc1 lds
    s_waitcnt lgkmcnt(8)
    v_mfma_f32_32x32x16_bf16 v[16:31], a[24:27], v[140:143], v[16:31]
    ds_read_b64_tr_b16 v[128:129], v121 offset:8192
    v_mfma_f32_32x32x16_bf16 v[32:47], a[28:31], v[140:143], v[32:47]
    ds_read_b64_tr_b16 v[130:131], v121 offset:8704
    buffer_load_dwordx4 v5, s[36:39], s52 offen offset:3072 sc1 lds
    s_waitcnt lgkmcnt(8)
    v_mfma_f32_32x32x16_bf16 v[16:31], a[32:35], v[144:147], v[16:31]
    ds_read_b64_tr_b16 v[132:133], v121 offset:9216
    v_mfma_f32_32x32x16_bf16 v[32:47], a[36:39], v[144:147], v[32:47]
    ds_read_b64_tr_b16 v[134:135], v121 offset:9728
    s_add_u32 m0, m0, 45056
    s_add_u32 s52, s52, 45056
    buffer_load_dwordx4 v5, s[36:39], s52 offen offset:0 sc1 lds
    s_waitcnt lgkmcnt(8)
    v_mfma_f32_32x32x16_bf16 v[16:31], a[40:43], v[148:151], v[16:31]
    ds_read_b64_tr_b16 v[136:137], v121 offset:10240
    v_mfma_f32_32x32x16_bf16 v[32:47], a[44:47], v[148:151], v[32:47]
    ds_read_b64_tr_b16 v[138:139], v121 offset:10752
    buffer_load_dwordx4 v5, s[36:39], s52 offen offset:1024 sc1 lds
    s_waitcnt lgkmcnt(8)
    v_mfma_f32_32x32x16_bf16 v[16:31], a[48:51], v[152:155], v[16:31]
    ds_read_b64_tr_b16 v[140:141], v121 offset:11264
    v_mfma_f32_32x32x16_bf16 v[32:47], a[52:55], v[152:155], v[32:47]
    ds_read_b64_tr_b16 v[142:143], v121 offset:11776
    buffer_load_dwordx4 v5, s[36:39], s52 offen offset:2048 sc1 lds
    s_waitcnt lgkmcnt(8)
    v_mfma_f32_32x32x16_bf16 v[16:31], a[56:59], v[156:159], v[16:31]
    ds_read_b64_tr_b16 v[144:145], v121 offset:12288
    v_mfma_f32_32x32x16_bf16 v[32:47], a[60:63], v[156:159], v[32:47]
    ds_read_b64_tr_b16 v[146:147], v121 offset:12800
    buffer_load_dwordx4 v5, s[36:39], s52 offen offset:3072 sc1 lds
    s_waitcnt lgkmcnt(8)
    v_mfma_f32_32x32x16_bf16 v[16:31], a[64:67], v[128:131], v[16:31]
    ds_read_b64_tr_b16 v[148:149], v121 offset:13312
    v_mfma_f32_32x32x16_bf16 v[32:47], a[68:71], v[128:131], v[32:47]
    ds_read_b64_tr_b16 v[150:151], v121 offset:13824
    s_add_u32 m0, m0, 4096
    s_add_u32 s52, s52, 4096
    buffer_load_dwordx4 v5, s[36:39], s52 offen offset:0 sc1 lds
    s_waitcnt lgkmcnt(8)
    v_mfma_f32_32x32x16_bf16 v[16:31], a[72:75], v[132:135], v[16:31]
    ds_read_b64_tr_b16 v[152:153], v121 offset:14336
    v_mfma_f32_32x32x16_bf16 v[32:47], a[76:79], v[132:135], v[32:47]
    ds_read_b64_tr_b16 v[154:155], v121 offset:14848
    buffer_load_dwordx4 v5, s[36:39], s52 offen offset:1024 sc1 lds
    s_waitcnt vmcnt(6)
    s_barrier
    s_waitcnt lgkmcnt(8)
    v_mfma_f32_32x32x16_bf16 v[16:31], a[80:83], v[136:139], v[16:31]
    ds_read_b64_tr_b16 v[156:157], v121 offset:15360
    v_mfma_f32_32x32x16_bf16 v[32:47], a[84:87], v[136:139], v[32:47]
    ds_read_b64_tr_b16 v[158:159], v121 offset:15872
    buffer_load_dwordx4 v5, s[36:39], s52 offen offset:2048 sc1 lds
    s_waitcnt lgkmcnt(8)
    v_mfma_f32_32x32x16_bf16 v[16:31], a[88:91], v[140:143], v[16:31]
    ds_read_b64_tr_b16 v[128:129], v121 offset:16384
    v_mfma_f32_32x32x16_bf16 v[32:47], a[92:95], v[140:143], v[32:47]
    ds_read_b64_tr_b16 v[130:131], v121 offset:16896
    buffer_load_dwordx4 v5, s[36:39], s52 offen offset:3072 sc1 lds
    s_waitcnt lgkmcnt(8)
    v_mfma_f32_32x32x16_bf16 v[16:31], a[96:99], v[144:147], v[16:31]
    ds_read_b64_tr_b16 v[132:133], v121 offset:17408
    v_mfma_f32_32x32x16_bf16 v[32:47], a[100:103], v[144:147], v[32:47]
    ds_read_b64_tr_b16 v[134:135], v121 offset:17920
    s_add_u32 m0, m0, 12288
    s_add_u32 s52, s52, 12288
    buffer_load_dwordx4 v5, s[36:39], s52 offen offset:0 sc1 lds
    s_waitcnt lgkmcnt(8)
    v_mfma_f32_32x32x16_bf16 v[16:31], a[104:107], v[148:151], v[16:31]
    ds_read_b64_tr_b16 v[136:137], v121 offset:18432
    v_mfma_f32_32x32x16_bf16 v[32:47], a[108:111], v[148:151], v[32:47]
    ds_read_b64_tr_b16 v[138:139], v121 offset:18944
    buffer_load_dwordx4 v5, s[36:39], s52 offen offset:1024 sc1 lds
    s_waitcnt lgkmcnt(8)
    v_mfma_f32_32x32x16_bf16 v[16:31], a[112:115], v[152:155], v[16:31]
    ds_read_b64_tr_b16 v[140:141], v121 offset:19456
    v_mfma_f32_32x32x16_bf16 v[32:47], a[116:119], v[152:155], v[32:47]
    ds_read_b64_tr_b16 v[142:143], v121 offset:19968
    buffer_load_dwordx4 v5, s[36:39], s52 offen offset:2048 sc1 lds
    s_waitcnt lgkmcnt(8)
    v_mfma_f32_32x32x16_bf16 v[16:31], a[120:123], v[156:159], v[16:31]
    ds_read_b64_tr_b16 v[144:145], v121 offset:20480
    v_mfma_f32_32x32x16_bf16 v[32:47], a[124:127], v[156:159], v[32:47]
    ds_read_b64_tr_b16 v[146:147], v121 offset:20992
    buffer_load_dwordx4 v5, s[36:39], s52 offen offset:3072 sc1 lds
    s_waitcnt lgkmcnt(8)
    v_mfma_f32_32x32x16_bf16 v[16:31], a[128:131], v[128:131], v[16:31]
    ds_read_b64_tr_b16 v[148:149], v121 offset:21504
    v_mfma_f32_32x32x16_bf16 v[32:47], a[132:135], v[128:131], v[32:47]
    ds_read_b64_tr_b16 v[150:151], v121 offset:22016
    s_add_u32 m0, m0, 4096
    s_add_u32 s52, s52, 4096
    buffer_load_dwordx4 v5, s[36:39], s52 offen offset:0 sc1 lds
    s_waitcnt lgkmcnt(8)
    v_mfma_f32_32x32x16_bf16 v[16:31], a[136:139], v[132:135], v[16:31]
    ds_read_b64_tr_b16 v[152:153], v121 offset:22528
    v_mfma_f32_32x32x16_bf16 v[32:47], a[140:143], v[132:135], v[32:47]
    ds_read_b64_tr_b16 v[154:155], v121 offset:23040
    buffer_load_dwordx4 v5, s[36:39], s52 offen offset:1024 sc1 lds
    s_waitcnt lgkmcnt(8)
    v_mfma_f32_32x32x16_bf16 v[16:31], a[144:147], v[136:139], v[16:31]
    ds_read_b64_tr_b16 v[156:157], v121 offset:23552
    v_mfma_f32_32x32x16_bf16 v[32:47], a[148:151], v[136:139], v[32:47]
    ds_read_b64_tr_b16 v[158:159], v121 offset:24064
    buffer_load_dwordx4 v5, s[36:39], s52 offen offset:2048 sc1 lds
    s_waitcnt lgkmcnt(8)
    v_mfma_f32_32x32x16_bf16 v[16:31], a[152:155], v[140:143], v[16:31]
    ds_read_b64_tr_b16 v[128:129], v121 offset:24576
    v_mfma_f32_32x32x16_bf16 v[32:47], a[156:159], v[140:143], v[32:47]
    ds_read_b64_tr_b16 v[130:131], v121 offset:25088
    buffer_load_dwordx4 v5, s[36:39], s52 offen offset:3072 sc1 lds
    s_waitcnt lgkmcnt(8)
    v_mfma_f32_32x32x16_bf16 v[16:31], a[160:163], v[144:147], v[16:31]
    ds_read_b64_tr_b16 v[132:133], v121 offset:25600
    v_mfma_f32_32x32x16_bf16 v[32:47], a[164:167], v[144:147], v[32:47]
    ds_read_b64_tr_b16 v[134:135], v121 offset:26112
    s_waitcnt lgkmcnt(8)
    v_mfma_f32_32x32x16_bf16 v[16:31], a[168:171], v[148:151], v[16:31]
    ds_read_b64_tr_b16 v[136:137], v121 offset:26624
    v_mfma_f32_32x32x16_bf16 v[32:47], a[172:175], v[148:151], v[32:47]
    ds_read_b64_tr_b16 v[138:139], v121 offset:27136
    s_waitcnt lgkmcnt(8)
    v_mfma_f32_32x32x16_bf16 v[16:31], a[176:179], v[152:155], v[16:31]
    ds_read_b64_tr_b16 v[140:141], v121 offset:27648
    v_mfma_f32_32x32x16_bf16 v[32:47], a[180:183], v[152:155], v[32:47]
    ds_read_b64_tr_b16 v[142:143], v121 offset:28160
    s_waitcnt lgkmcnt(8)
    v_mfma_f32_32x32x16_bf16 v[16:31], a[184:187], v[156:159], v[16:31]
    ds_read_b64_tr_b16 v[144:145], v121 offset:28672
    v_mfma_f32_32x32x16_bf16 v[32:47], a[188:191], v[156:159], v[32:47]
    ds_read_b64_tr_b16 v[146:147], v121 offset:29184
    s_waitcnt lgkmcnt(8)
    v_mfma_f32_32x32x16_bf16 v[16:31], a[192:195], v[128:131], v[16:31]
    ds_read_b64_tr_b16 v[148:149], v121 offset:29696
    v_mfma_f32_32x32x16_bf16 v[32:47], a[196:199], v[128:131], v[32:47]
    ds_read_b64_tr_b16 v[150:151], v121 offset:30208
    s_waitcnt lgkmcnt(8)
    v_mfma_f32_32x32x16_bf16 v[16:31], a[200:203], v[132:135], v[16:31]
    ds_read_b64_tr_b16 v[152:153], v121 offset:30720
    v_mfma_f32_32x32x16_bf16 v[32:47], a[204:207], v[132:135], v[32:47]
    ds_read_b64_tr_b16 v[154:155], v121 offset:31232
    s_waitcnt vmcnt(8)
    s_barrier
    s_waitcnt lgkmcnt(8)
    v_mfma_f32_32x32x16_bf16 v[16:31], a[208:211], v[136:139], v[16:31]
    ds_read_b64_tr_b16 v[156:157], v121 offset:31744
    v_mfma_f32_32x32x16_bf16 v[32:47], a[212:215], v[136:139], v[32:47]
    ds_read_b64_tr_b16 v[158:159], v121 offset:32256
    s_waitcnt lgkmcnt(8)
    v_mfma_f32_32x32x16_bf16 v[16:31], a[216:219], v[140:143], v[16:31]
    ds_read_b64_tr_b16 v[128:129], v122 offset:0
    v_mfma_f32_32x32x16_bf16 v[32:47], a[220:223], v[140:143], v[32:47]
    ds_read_b64_tr_b16 v[130:131], v122 offset:512
    buffer_load_dwordx2 v[124:125], v4, s[36:39], s56 offen offset:0 sc1
    s_waitcnt lgkmcnt(8)
    v_mfma_f32_32x32x16_bf16 v[16:31], a[224:227], v[144:147], v[16:31]
    ds_read_b64_tr_b16 v[132:133], v122 offset:1024
    v_mfma_f32_32x32x16_bf16 v[32:47], a[228:231], v[144:147], v[32:47]
    ds_read_b64_tr_b16 v[134:135], v122 offset:1536
    s_waitcnt lgkmcnt(8)
    v_mfma_f32_32x32x16_bf16 v[16:31], a[232:235], v[148:151], v[16:31]
    ds_read_b64_tr_b16 v[136:137], v122 offset:2048
    v_mfma_f32_32x32x16_bf16 v[32:47], a[236:239], v[148:151], v[32:47]
    ds_read_b64_tr_b16 v[138:139], v122 offset:2560
    s_waitcnt lgkmcnt(8)
    v_mfma_f32_32x32x16_bf16 v[16:31], a[240:243], v[152:155], v[16:31]
    ds_read_b64_tr_b16 v[140:141], v122 offset:3072
    v_mfma_f32_32x32x16_bf16 v[32:47], a[244:247], v[152:155], v[32:47]
    ds_read_b64_tr_b16 v[142:143], v122 offset:3584
    s_waitcnt lgkmcnt(8)
    v_mfma_f32_32x32x16_bf16 v[16:31], a[248:251], v[156:159], v[16:31]
    ds_read_b64_tr_b16 v[144:145], v122 offset:4096
    v_mfma_f32_32x32x16_bf16 v[32:47], a[252:255], v[156:159], v[32:47]
    ds_read_b64_tr_b16 v[146:147], v122 offset:4608
    s_waitcnt lgkmcnt(8)
    v_mfma_f32_32x32x16_bf16 v[48:63], a[0:3], v[128:131], 0
    ds_read_b64_tr_b16 v[148:149], v122 offset:5120
    v_mfma_f32_32x32x16_bf16 v[64:79], a[4:7], v[128:131], 0
    ds_read_b64_tr_b16 v[150:151], v122 offset:5632
    s_waitcnt vmcnt(0)
    v_cmp_ne_u32 vcc, s49, v125
    s_cbranch_vccz Lm0bk
    s_mov_b32 s62, 0
    Lm0b:
    buffer_load_dwordx2 v[124:125], v4, s[36:39], s56 offen offset:0 sc1
    s_add_u32 s62, s62, 1
    s_cmp_gt_u32 s62, 1048576
    s_cbranch_scc1 Lm0bk
    s_waitcnt vmcnt(0)
    v_cmp_ne_u32 vcc, s49, v125
    s_cbranch_vccnz Lm0b
    Lm0bk:
    v_lshlrev_b32 v120, 16, v124
    v_xor_b32 v120, 0x80000000, v120
    s_waitcnt lgkmcnt(8)
    v_mfma_f32_32x32x16_bf16 v[48:63], a[8:11], v[132:135], v[48:63]
    ds_read_b64_tr_b16 v[152:153], v122 offset:6144
    v_mfma_f32_32x32x16_bf16 v[64:79], a[12:15], v[132:135], v[64:79]
    ds_read_b64_tr_b16 v[154:155], v122 offset:6656
    s_waitcnt lgkmcnt(8)
    v_mfma_f32_32x32x16_bf16 v[48:63], a[16:19], v[136:139], v[48:63]
    ds_read_b64_tr_b16 v[156:157], v122 offset:7168
    v_fmac_f32 v16, v120, v80
    v_fmac_f32 v17, v120, v81
    v_fmac_f32 v18, v120, v82
    v_mfma_f32_32x32x16_bf16 v[64:79], a[20:23], v[136:139], v[64:79]
    ds_read_b64_tr_b16 v[158:159], v122 offset:7680
    v_fmac_f32 v19, v120, v83
    v_fmac_f32 v20, v120, v84
    s_waitcnt lgkmcnt(8)
    v_mfma_f32_32x32x16_bf16 v[48:63], a[24:27], v[140:143], v[48:63]
    ds_read_b64_tr_b16 v[128:129], v122 offset:8192
    v_fmac_f32 v21, v120, v85
    v_fmac_f32 v22, v120, v86
    v_mfma_f32_32x32x16_bf16 v[64:79], a[28:31], v[140:143], v[64:79]
    ds_read_b64_tr_b16 v[130:131], v122 offset:8704
    v_fmac_f32 v23, v120, v87
    v_fmac_f32 v24, v120, v88
    s_waitcnt lgkmcnt(8)
    v_mfma_f32_32x32x16_bf16 v[48:63], a[32:35], v[144:147], v[48:63]
    ds_read_b64_tr_b16 v[132:133], v122 offset:9216
    v_fmac_f32 v25, v120, v89
    v_fmac_f32 v26, v120, v90
    v_mfma_f32_32x32x16_bf16 v[64:79], a[36:39], v[144:147], v[64:79]
    ds_read_b64_tr_b16 v[134:135], v122 offset:9728
    v_fmac_f32 v27, v120, v91
    v_fmac_f32 v28, v120, v92
    s_add_u32 m0, s74, 131072
    s_nop 0
    buffer_load_dwordx4 v127, s[28:31], 0 offen offset:0  lds
    s_waitcnt lgkmcnt(8)
    v_mfma_f32_32x32x16_bf16 v[48:63], a[40:43], v[148:151], v[48:63]
    ds_read_b64_tr_b16 v[136:137], v122 offset:10240
    v_fmac_f32 v29, v120, v93
    v_fmac_f32 v30, v120, v94
    v_mfma_f32_32x32x16_bf16 v[64:79], a[44:47], v[148:151], v[64:79]
    ds_read_b64_tr_b16 v[138:139], v122 offset:10752
    v_fmac_f32 v31, v120, v95
    v_cvt_pk_bf16_f32 v112, v16, v17
    buffer_load_dwordx4 v127, s[28:31], s58 offen offset:1024  lds
    s_waitcnt lgkmcnt(8)
    v_mfma_f32_32x32x16_bf16 v[48:63], a[48:51], v[152:155], v[48:63]
    ds_read_b64_tr_b16 v[140:141], v122 offset:11264
    v_cvt_pk_bf16_f32 v113, v18, v19
    v_cvt_pk_bf16_f32 v114, v20, v21
    v_cvt_pk_bf16_f32 v115, v22, v23
    v_mfma_f32_32x32x16_bf16 v[64:79], a[52:55], v[152:155], v[64:79]
    ds_read_b64_tr_b16 v[142:143], v122 offset:11776
    v_cvt_pk_bf16_f32 v116, v24, v25
    v_cvt_pk_bf16_f32 v117, v26, v27
    buffer_load_dwordx4 v127, s[28:31], s59 offen offset:2048  lds
    s_waitcnt lgkmcnt(8)
    v_mfma_f32_32x32x16_bf16 v[48:63], a[56:59], v[156:159], v[48:63]
    ds_read_b64_tr_b16 v[144:145], v122 offset:12288
    v_cvt_pk_bf16_f32 v118, v28, v29
    v_cvt_pk_bf16_f32 v119, v30, v31
    v_mfma_f32_32x32x16_bf16 v[64:79], a[60:63], v[156:159], v[64:79]
    ds_read_b64_tr_b16 v[146:147], v122 offset:12800
    v_pk_max_i16 v112, v112, 0
    v_pk_max_i16 v113, v113, 0
    buffer_load_dwordx4 v127, s[28:31], s60 offen offset:3072  lds
    s_waitcnt lgkmcnt(8)
    v_mfma_f32_32x32x16_bf16 v[48:63], a[64:67], v[128:131], v[48:63]
    ds_read_b64_tr_b16 v[148:149], v122 offset:13312
    v_pk_max_i16 v114, v114, 0
    v_pk_max_i16 v115, v115, 0
    v_mfma_f32_32x32x16_bf16 v[64:79], a[68:71], v[128:131], v[64:79]
    ds_read_b64_tr_b16 v[150:151], v122 offset:13824
    v_pk_max_i16 v116, v116, 0
    v_pk_max_i16 v117, v117, 0
    s_add_u32 m0, m0, 4096
    v_add_u32 v127, 32768, v127
    buffer_load_dwordx4 v127, s[28:31], 0 offen offset:0  lds
    s_waitcnt lgkmcnt(8)
    v_mfma_f32_32x32x16_bf16 v[48:63], a[72:75], v[132:135], v[48:63]
    ds_read_b64_tr_b16 v[152:153], v122 offset:14336
    v_pk_max_i16 v118, v118, 0
    v_pk_max_i16 v119, v119, 0
    v_mfma_f32_32x32x16_bf16 v[64:79], a[76:79], v[132:135], v[64:79]
    ds_read_b64_tr_b16 v[154:155], v122 offset:14848
    buffer_store_dwordx4 v[112:115], v182, s[36:39], s55 offen offset:0 sc1 nt
    buffer_store_dwordx4 v[116:119], v182, s[36:39], s55 offen offset:1024 sc1 nt
    buffer_load_dwordx4 v127, s[28:31], s58 offen offset:1024  lds
    s_waitcnt vmcnt(9)
    s_barrier
    s_waitcnt lgkmcnt(8)
    v_mfma_f32_32x32x16_bf16 v[48:63], a[80:83], v[136:139], v[48:63]
    ds_read_b64_tr_b16 v[156:157], v122 offset:15360
    v_fmac_f32 v32, v120, v96
    v_fmac_f32 v33, v120, v97
    v_fmac_f32 v34, v120, v98
    v_mfma_f32_32x32x16_bf16 v[64:79], a[84:87], v[136:139], v[64:79]
    ds_read_b64_tr_b16 v[158:159], v122 offset:15872
    v_fmac_f32 v35, v120, v99
    v_fmac_f32 v36, v120, v100
    buffer_load_dwordx4 v127, s[28:31], s59 offen offset:2048  lds
    s_waitcnt lgkmcnt(8)
    v_mfma_f32_32x32x16_bf16 v[48:63], a[88:91], v[140:143], v[48:63]
    ds_read_b64_tr_b16 v[128:129], v122 offset:16384
    v_fmac_f32 v37, v120, v101
    v_fmac_f32 v38, v120, v102
    v_mfma_f32_32x32x16_bf16 v[64:79], a[92:95], v[140:143], v[64:79]
    ds_read_b64_tr_b16 v[130:131], v122 offset:16896
    v_fmac_f32 v39, v120, v103
    v_fmac_f32 v40, v120, v104
    s_add_u32 m0, s74, 0
    v_add_u32 v127, 196608, v127
    buffer_load_dwordx4 v127, s[28:31], 0 offen offset:0  lds
    s_waitcnt lgkmcnt(8)
    v_mfma_f32_32x32x16_bf16 v[48:63], a[96:99], v[144:147], v[48:63]
    ds_read_b64_tr_b16 v[132:133], v122 offset:17408
    v_fmac_f32 v41, v120, v105
    v_fmac_f32 v42, v120, v106
    v_mfma_f32_32x32x16_bf16 v[64:79], a[100:103], v[144:147], v[64:79]
    ds_read_b64_tr_b16 v[134:135], v122 offset:17920
    v_fmac_f32 v43, v120, v107
    v_fmac_f32 v44, v120, v108
    buffer_load_dwordx4 v127, s[28:31], s58 offen offset:1024  lds
    s_waitcnt lgkmcnt(8)
    v_mfma_f32_32x32x16_bf16 v[48:63], a[104:107], v[148:151], v[48:63]
    ds_read_b64_tr_b16 v[136:137], v122 offset:18432
    v_fmac_f32 v45, v120, v109
    v_fmac_f32 v46, v120, v110
    v_mfma_f32_32x32x16_bf16 v[64:79], a[108:111], v[148:151], v[64:79]
    ds_read_b64_tr_b16 v[138:139], v122 offset:18944
    v_fmac_f32 v47, v120, v111
    v_cvt_pk_bf16_f32 v160, v32, v33
    buffer_load_dwordx4 v127, s[28:31], s59 offen offset:2048  lds
    s_waitcnt lgkmcnt(8)
    v_mfma_f32_32x32x16_bf16 v[48:63], a[112:115], v[152:155], v[48:63]
    ds_read_b64_tr_b16 v[140:141], v122 offset:19456
    v_cvt_pk_bf16_f32 v161, v34, v35
    v_cvt_pk_bf16_f32 v162, v36, v37
    v_cvt_pk_bf16_f32 v163, v38, v39
    v_mfma_f32_32x32x16_bf16 v[64:79], a[116:119], v[152:155], v[64:79]
    ds_read_b64_tr_b16 v[142:143], v122 offset:19968
    v_cvt_pk_bf16_f32 v164, v40, v41
    v_cvt_pk_bf16_f32 v165, v42, v43
    buffer_load_dwordx4 v127, s[28:31], s60 offen offset:3072  lds
    s_waitcnt lgkmcnt(8)
    v_mfma_f32_32x32x16_bf16 v[48:63], a[120:123], v[156:159], v[48:63]
    ds_read_b64_tr_b16 v[144:145], v122 offset:20480
    v_cvt_pk_bf16_f32 v166, v44, v45
    v_cvt_pk_bf16_f32 v167, v46, v47
    v_mfma_f32_32x32x16_bf16 v[64:79], a[124:127], v[156:159], v[64:79]
    ds_read_b64_tr_b16 v[146:147], v122 offset:20992
    v_pk_max_i16 v160, v160, 0
    v_pk_max_i16 v161, v161, 0
    s_add_u32 m0, m0, 4096
    v_add_u32 v127, 32768, v127
    buffer_load_dwordx4 v127, s[28:31], 0 offen offset:0  lds
    s_waitcnt lgkmcnt(8)
    v_mfma_f32_32x32x16_bf16 v[48:63], a[128:131], v[128:131], v[48:63]
    ds_read_b64_tr_b16 v[148:149], v122 offset:21504
    v_pk_max_i16 v162, v162, 0
    v_pk_max_i16 v163, v163, 0
    v_mfma_f32_32x32x16_bf16 v[64:79], a[132:135], v[128:131], v[64:79]
    ds_read_b64_tr_b16 v[150:151], v122 offset:22016
    v_pk_max_i16 v164, v164, 0
    v_pk_max_i16 v165, v165, 0
    buffer_load_dwordx4 v127, s[28:31], s58 offen offset:1024  lds
    buffer_load_dwordx2 v[168:169], v4, s[36:39], s56 offen offset:512 sc1
    s_waitcnt lgkmcnt(8)
    v_mfma_f32_32x32x16_bf16 v[48:63], a[136:139], v[132:135], v[48:63]
    ds_read_b64_tr_b16 v[152:153], v122 offset:22528
    v_pk_max_i16 v166, v166, 0
    v_pk_max_i16 v167, v167, 0
    v_mfma_f32_32x32x16_bf16 v[64:79], a[140:143], v[132:135], v[64:79]
    ds_read_b64_tr_b16 v[154:155], v122 offset:23040
    buffer_store_dwordx4 v[160:163], v183, s[36:39], s55 offen offset:0 sc1 nt
    buffer_store_dwordx4 v[164:167], v183, s[36:39], s55 offen offset:1024 sc1 nt
    buffer_load_dwordx4 v127, s[28:31], s59 offen offset:2048  lds
    s_waitcnt lgkmcnt(8)
    v_mfma_f32_32x32x16_bf16 v[48:63], a[144:147], v[136:139], v[48:63]
    ds_read_b64_tr_b16 v[156:157], v122 offset:23552
    v_mfma_f32_32x32x16_bf16 v[64:79], a[148:151], v[136:139], v[64:79]
    ds_read_b64_tr_b16 v[158:159], v122 offset:24064
    s_add_u32 m0, s74, 32768
    v_add_u32 v127, 196608, v127
    buffer_load_dwordx4 v127, s[28:31], 0 offen offset:0  lds
    s_waitcnt lgkmcnt(8)
    v_mfma_f32_32x32x16_bf16 v[48:63], a[152:155], v[140:143], v[48:63]
    ds_read_b64_tr_b16 v[128:129], v122 offset:24576
    v_mfma_f32_32x32x16_bf16 v[64:79], a[156:159], v[140:143], v[64:79]
    ds_read_b64_tr_b16 v[130:131], v122 offset:25088
    buffer_load_dwordx4 v127, s[28:31], s58 offen offset:1024  lds
    s_waitcnt lgkmcnt(8)
    v_mfma_f32_32x32x16_bf16 v[48:63], a[160:163], v[144:147], v[48:63]
    ds_read_b64_tr_b16 v[132:133], v122 offset:25600
    v_mfma_f32_32x32x16_bf16 v[64:79], a[164:167], v[144:147], v[64:79]
    ds_read_b64_tr_b16 v[134:135], v122 offset:26112
    buffer_load_dwordx4 v127, s[28:31], s59 offen offset:2048  lds
    s_waitcnt lgkmcnt(8)
    v_mfma_f32_32x32x16_bf16 v[48:63], a[168:171], v[148:151], v[48:63]
    ds_read_b64_tr_b16 v[136:137], v122 offset:26624
    v_mfma_f32_32x32x16_bf16 v[64:79], a[172:175], v[148:151], v[64:79]
    ds_read_b64_tr_b16 v[138:139], v122 offset:27136
    buffer_load_dwordx4 v127, s[28:31], s60 offen offset:3072  lds
    s_waitcnt lgkmcnt(8)
    v_mfma_f32_32x32x16_bf16 v[48:63], a[176:179], v[152:155], v[48:63]
    ds_read_b64_tr_b16 v[140:141], v122 offset:27648
    v_mfma_f32_32x32x16_bf16 v[64:79], a[180:183], v[152:155], v[64:79]
    ds_read_b64_tr_b16 v[142:143], v122 offset:28160
    s_add_u32 m0, m0, 4096
    v_add_u32 v127, 32768, v127
    buffer_load_dwordx4 v127, s[28:31], 0 offen offset:0  lds
    s_waitcnt lgkmcnt(8)
    v_mfma_f32_32x32x16_bf16 v[48:63], a[184:187], v[156:159], v[48:63]
    ds_read_b64_tr_b16 v[144:145], v122 offset:28672
    v_mfma_f32_32x32x16_bf16 v[64:79], a[188:191], v[156:159], v[64:79]
    ds_read_b64_tr_b16 v[146:147], v122 offset:29184
    buffer_load_dwordx4 v127, s[28:31], s58 offen offset:1024  lds
    s_waitcnt lgkmcnt(8)
    v_mfma_f32_32x32x16_bf16 v[48:63], a[192:195], v[128:131], v[48:63]
    ds_read_b64_tr_b16 v[148:149], v122 offset:29696
    v_mfma_f32_32x32x16_bf16 v[64:79], a[196:199], v[128:131], v[64:79]
    ds_read_b64_tr_b16 v[150:151], v122 offset:30208
    buffer_load_dwordx4 v127, s[28:31], s59 offen offset:2048  lds
    s_waitcnt lgkmcnt(8)
    v_mfma_f32_32x32x16_bf16 v[48:63], a[200:203], v[132:135], v[48:63]
    ds_read_b64_tr_b16 v[152:153], v122 offset:30720
    v_mfma_f32_32x32x16_bf16 v[64:79], a[204:207], v[132:135], v[64:79]
    ds_read_b64_tr_b16 v[154:155], v122 offset:31232
    s_waitcnt vmcnt(8)
    s_barrier
    s_add_u32 s54, s16, 12288
    s_cmp_lg_u32 s48, 0
    s_cbranch_scc1 Lf11
    v_mov_b32 v14, s49
    v_mov_b32 v15, 0
    s_mov_b64 exec, 1
    buffer_store_dword v14, v15, s[36:39], s54 offen sc1
    s_mov_b64 exec, -1
Lf11:
    s_waitcnt lgkmcnt(8)
    v_mfma_f32_32x32x16_bf16 v[48:63], a[208:211], v[136:139], v[48:63]
    ds_read_b64_tr_b16 v[156:157], v122 offset:31744
    s_add_u32 m0, s74, 65536
    v_add_u32 v127, 196608, v127
    s_lshr_b32 s68, s48, 1
    s_mul_i32 s68, s68, 18432
    s_add_u32 m0, m0, s68
    s_nop 0
    buffer_load_dwordx4 v127, s[28:31], 0 offen offset:0  lds
    v_mfma_f32_32x32x16_bf16 v[64:79], a[212:215], v[136:139], v[64:79]
    ds_read_b64_tr_b16 v[158:159], v122 offset:32256
    buffer_load_dwordx4 v127, s[28:31], s58 offen offset:1024  lds
    s_waitcnt lgkmcnt(8)
    v_mfma_f32_32x32x16_bf16 v[48:63], a[216:219], v[140:143], v[48:63]
    buffer_load_dwordx4 v127, s[28:31], s59 offen offset:2048  lds
    v_mfma_f32_32x32x16_bf16 v[64:79], a[220:223], v[140:143], v[64:79]
    buffer_load_dwordx4 v127, s[28:31], s60 offen offset:3072  lds
    s_waitcnt lgkmcnt(6)
    v_mfma_f32_32x32x16_bf16 v[48:63], a[224:227], v[144:147], v[48:63]
    s_add_u32 m0, m0, 4096
    v_add_u32 v127, 32768, v127
    buffer_load_dwordx4 v127, s[28:31], 0 offen offset:0  lds
    v_mfma_f32_32x32x16_bf16 v[64:79], a[228:231], v[144:147], v[64:79]
    buffer_load_dwordx4 v127, s[28:31], s58 offen offset:1024  lds
    s_waitcnt lgkmcnt(4)
    v_mfma_f32_32x32x16_bf16 v[48:63], a[232:235], v[148:151], v[48:63]
    buffer_load_dwordx4 v127, s[28:31], s59 offen offset:2048  lds
    v_mfma_f32_32x32x16_bf16 v[64:79], a[236:239], v[148:151], v[64:79]
    s_waitcnt lgkmcnt(2)
    v_mfma_f32_32x32x16_bf16 v[48:63], a[240:243], v[152:155], v[48:63]
    v_mfma_f32_32x32x16_bf16 v[64:79], a[244:247], v[152:155], v[64:79]
    s_waitcnt lgkmcnt(0)
    v_mfma_f32_32x32x16_bf16 v[48:63], a[248:251], v[156:159], v[48:63]
    v_mfma_f32_32x32x16_bf16 v[64:79], a[252:255], v[156:159], v[64:79]
    s_waitcnt vmcnt(17)
    v_mov_b32 v124, v168
    v_mov_b32 v125, v169
    s_add_u32 s55, s55, 114688
    v_cmp_ne_u32 vcc, s49, v125
    s_cbranch_vccz Lm1bk
    s_mov_b32 s62, 0
    Lm1b:
    buffer_load_dwordx2 v[124:125], v4, s[36:39], s56 offen offset:512 sc1
    s_add_u32 s62, s62, 1
    s_cmp_gt_u32 s62, 1048576
    s_cbranch_scc1 Lm1bk
    s_waitcnt vmcnt(0)
    v_cmp_ne_u32 vcc, s49, v125
    s_cbranch_vccnz Lm1b
    Lm1bk:
    v_lshlrev_b32 v120, 16, v124
    v_xor_b32 v120, 0x80000000, v120
    buffer_load_dword v9, v178, s[36:39], s14 offen sc1
    s_nop 1
    v_fmac_f32 v48, v120, v80
    v_fmac_f32 v49, v120, v81
    v_fmac_f32 v50, v120, v82
    v_fmac_f32 v51, v120, v83
    v_fmac_f32 v52, v120, v84
    v_fmac_f32 v53, v120, v85
    v_fmac_f32 v54, v120, v86
    v_fmac_f32 v55, v120, v87
    v_fmac_f32 v56, v120, v88
    v_fmac_f32 v57, v120, v89
    v_fmac_f32 v58, v120, v90
    v_fmac_f32 v59, v120, v91
    v_fmac_f32 v60, v120, v92
    v_fmac_f32 v61, v120, v93
    v_fmac_f32 v62, v120, v94
    v_fmac_f32 v63, v120, v95
    v_cvt_pk_bf16_f32 v112, v48, v49
    v_cvt_pk_bf16_f32 v113, v50, v51
    v_cvt_pk_bf16_f32 v114, v52, v53
    v_cvt_pk_bf16_f32 v115, v54, v55
    v_cvt_pk_bf16_f32 v116, v56, v57
    v_cvt_pk_bf16_f32 v117, v58, v59
    v_cvt_pk_bf16_f32 v118, v60, v61
    v_cvt_pk_bf16_f32 v119, v62, v63
    v_pk_max_i16 v112, v112, 0
    v_pk_max_i16 v113, v113, 0
    v_pk_max_i16 v114, v114, 0
    v_pk_max_i16 v115, v115, 0
    v_pk_max_i16 v116, v116, 0
    v_pk_max_i16 v117, v117, 0
    v_pk_max_i16 v118, v118, 0
    v_pk_max_i16 v119, v119, 0
    buffer_store_dwordx4 v[112:115], v182, s[36:39], s55 offen offset:0 sc1 nt
    buffer_store_dwordx4 v[116:119], v182, s[36:39], s55 offen offset:1024 sc1 nt
    v_fmac_f32 v64, v120, v96
    v_fmac_f32 v65, v120, v97
    v_fmac_f32 v66, v120, v98
    v_fmac_f32 v67, v120, v99
    v_fmac_f32 v68, v120, v100
    v_fmac_f32 v69, v120, v101
    v_fmac_f32 v70, v120, v102
    v_fmac_f32 v71, v120, v103
    v_fmac_f32 v72, v120, v104
    v_fmac_f32 v73, v120, v105
    v_fmac_f32 v74, v120, v106
    v_fmac_f32 v75, v120, v107
    v_fmac_f32 v76, v120, v108
    v_fmac_f32 v77, v120, v109
    v_fmac_f32 v78, v120, v110
    v_fmac_f32 v79, v120, v111
    v_cvt_pk_bf16_f32 v160, v64, v65
    v_cvt_pk_bf16_f32 v161, v66, v67
    v_cvt_pk_bf16_f32 v162, v68, v69
    v_cvt_pk_bf16_f32 v163, v70, v71
    v_cvt_pk_bf16_f32 v164, v72, v73
    v_cvt_pk_bf16_f32 v165, v74, v75
    v_cvt_pk_bf16_f32 v166, v76, v77
    v_cvt_pk_bf16_f32 v167, v78, v79
    v_pk_max_i16 v160, v160, 0
    v_pk_max_i16 v161, v161, 0
    v_pk_max_i16 v162, v162, 0
    v_pk_max_i16 v163, v163, 0
    v_pk_max_i16 v164, v164, 0
    v_pk_max_i16 v165, v165, 0
    v_pk_max_i16 v166, v166, 0
    v_pk_max_i16 v167, v167, 0
    buffer_store_dwordx4 v[160:163], v183, s[36:39], s55 offen offset:0 sc1 nt
    buffer_store_dwordx4 v[164:167], v183, s[36:39], s55 offen offset:1024 sc1 nt
    s_add_u32 s54, s16, 7168
    v_mov_b32 v14, s49
    v_mov_b32 v15, 0
    s_waitcnt vmcnt(0)
    s_barrier
    s_cmp_lg_u32 s48, 3
    s_cbranch_scc1 Lnfb
    s_mov_b64 exec, 1
    buffer_store_dword v14, v15, s[36:39], s54 offen sc1
    s_mov_b64 exec, -1
    Lnfb:
    v_cmp_eq_u32 vcc, s49, v9
    s_nop 0
    s_or_b32 s53, vcc_lo, vcc_hi
    s_and_b32 s53, s53, s73
    s_cmp_lg_u32 s53, s73
    s_cbranch_scc0 Lp3bd
    s_branch Lg2b
Lswb:
    s_lshl_b32 s52, s64, 17
    s_lshl_b32 s53, s48, 13
    s_add_u32 s52, s52, s53
    s_add_u32 s52, s52, 0x100000
    s_mov_b32 m0, s53
    s_nop 0
    buffer_load_dwordx4 v5, s[36:39], s52 offen offset:0 sc1 lds
    buffer_load_dwordx4 v5, s[36:39], s52 offen offset:1024 sc1 lds
    buffer_load_dwordx4 v5, s[36:39], s52 offen offset:2048 sc1 lds
    buffer_load_dwordx4 v5, s[36:39], s52 offen offset:3072 sc1 lds
    s_add_u32 m0, m0, 4096
    s_add_u32 s52, s52, 4096
    buffer_load_dwordx4 v5, s[36:39], s52 offen offset:0 sc1 lds
    buffer_load_dwordx4 v5, s[36:39], s52 offen offset:1024 sc1 lds
    buffer_load_dwordx4 v5, s[36:39], s52 offen offset:2048 sc1 lds
    buffer_load_dwordx4 v5, s[36:39], s52 offen offset:3072 sc1 lds
    s_add_u32 m0, m0, 28672
    s_add_u32 s52, s52, 28672
    buffer_load_dwordx4 v5, s[36:39], s52 offen offset:0 sc1 lds
    buffer_load_dwordx4 v5, s[36:39], s52 offen offset:1024 sc1 lds
    buffer_load_dwordx4 v5, s[36:39], s52 offen offset:2048 sc1 lds
    buffer_load_dwordx4 v5, s[36:39], s52 offen offset:3072 sc1 lds
    s_lshl_b32 s56, s97, 10
    s_add_u32 s56, s56, s75
    s_lshl_b32 s53, s72, 8
    s_add_u32 s56, s56, s53
    s_add_u32 s56, s56, 0xe0000
    v_and_b32 v8, 31, v1
    v_lshlrev_b32 v3, 3, v8
    v_lshlrev_b32 v7, 5, v8
    v_add_u32 v7, 159744, v7
    s_lshl_b32 s53, s48, 3
    v_add_u32 v6, s53, v7
    v_mov_b32 v4, 0x3f803f80
    s_lshl_b32 s53, s72, 10
    v_add_u32 v7, s53, v7
    v_mov_b32 v117, s49
    s_waitcnt vmcnt(4)
    ds_read_b64_tr_b16 v[48:49], v123 offset:0
    ds_read_b64_tr_b16 v[50:51], v123 offset:512
    ds_read_b64_tr_b16 v[52:53], v123 offset:1024
    ds_read_b64_tr_b16 v[54:55], v123 offset:1536
    ds_read_b64_tr_b16 v[56:57], v123 offset:2048
    ds_read_b64_tr_b16 v[58:59], v123 offset:2560
    ds_read_b64_tr_b16 v[60:61], v123 offset:3072
    ds_read_b64_tr_b16 v[62:63], v123 offset:3584
    ds_read_b64_tr_b16 v[64:65], v123 offset:4096
    ds_read_b64_tr_b16 v[66:67], v123 offset:4608
    ds_read_b64_tr_b16 v[68:69], v123 offset:5120
    ds_read_b64_tr_b16 v[70:71], v123 offset:5632
    s_waitcnt lgkmcnt(6)
    ds_read_b64_tr_b16 v[72:73], v123 offset:6144
    ds_read_b64_tr_b16 v[74:75], v123 offset:6656
    ds_read_b64_tr_b16 v[76:77], v123 offset:7168
    ds_read_b64_tr_b16 v[78:79], v123 offset:7680
    v_mov_b32 v106, 0
    v_mov_b32 v107, 0
    s_waitcnt lgkmcnt(8)
    v_dot2c_f32_bf16 v106, v48, v4
    v_dot2c_f32_bf16 v107, v48, v48
    v_dot2c_f32_bf16 v106, v49, v4
    v_dot2c_f32_bf16 v107, v49, v49
    v_dot2c_f32_bf16 v106, v50, v4
    v_dot2c_f32_bf16 v107, v50, v50
    s_add_u32 m0, m0, 4096
    s_add_u32 s52, s52, 4096
    buffer_load_dwordx4 v5, s[36:39], s52 offen offset:0 sc1 lds
    v_dot2c_f32_bf16 v106, v51, v4
    v_dot2c_f32_bf16 v107, v51, v51
    v_dot2c_f32_bf16 v106, v52, v4
    v_dot2c_f32_bf16 v107, v52, v52
    v_dot2c_f32_bf16 v106, v53, v4
    v_dot2c_f32_bf16 v107, v53, v53
    buffer_load_dwordx4 v5, s[36:39], s52 offen offset:1024 sc1 lds
    v_dot2c_f32_bf16 v106, v54, v4
    v_dot2c_f32_bf16 v107, v54, v54
    v_dot2c_f32_bf16 v106, v55, v4
    v_dot2c_f32_bf16 v107, v55, v55
    s_waitcnt lgkmcnt(4)
    v_dot2c_f32_bf16 v106, v56, v4
    v_dot2c_f32_bf16 v107, v56, v56
    buffer_load_dwordx4 v5, s[36:39], s52 offen offset:2048 sc1 lds
    v_dot2c_f32_bf16 v106, v57, v4
    v_dot2c_f32_bf16 v107, v57, v57
    v_dot2c_f32_bf16 v106, v58, v4
    v_dot2c_f32_bf16 v107, v58, v58
    v_dot2c_f32_bf16 v106, v59, v4
    v_dot2c_f32_bf16 v107, v59, v59
    buffer_load_dwordx4 v5, s[36:39], s52 offen offset:3072 sc1 lds
    v_dot2c_f32_bf16 v106, v60, v4
    v_dot2c_f32_bf16 v107, v60, v60
    v_dot2c_f32_bf16 v106, v61, v4
    v_dot2c_f32_bf16 v107, v61, v61
    v_dot2c_f32_bf16 v106, v62, v4
    v_dot2c_f32_bf16 v107, v62, v62
    s_add_u32 m0, m0, 28672
    s_add_u32 s52, s52, 28672
    buffer_load_dwordx4 v5, s[36:39], s52 offen offset:0 sc1 lds
    v_dot2c_f32_bf16 v106, v63, v4
    v_dot2c_f32_bf16 v107, v63, v63
    s_waitcnt lgkmcnt(0)
    v_dot2c_f32_bf16 v106, v64, v4
    v_dot2c_f32_bf16 v107, v64, v64
    v_dot2c_f32_bf16 v106, v65, v4
    v_dot2c_f32_bf16 v107, v65, v65
    buffer_load_dwordx4 v5, s[36:39], s52 offen offset:1024 sc1 lds
    v_dot2c_f32_bf16 v106, v66, v4
    v_dot2c_f32_bf16 v107, v66, v66
    v_dot2c_f32_bf16 v106, v67, v4
    v_dot2c_f32_bf16 v107, v67, v67
    v_dot2c_f32_bf16 v106, v68, v4
    v_dot2c_f32_bf16 v107, v68, v68
    buffer_load_dwordx4 v5, s[36:39], s52 offen offset:2048 sc1 lds
    v_dot2c_f32_bf16 v106, v69, v4
    v_dot2c_f32_bf16 v107, v69, v69
    v_dot2c_f32_bf16 v106, v70, v4
    v_dot2c_f32_bf16 v107, v70, v70
    v_dot2c_f32_bf16 v106, v71, v4
    v_dot2c_f32_bf16 v107, v71, v71
    buffer_load_dwordx4 v5, s[36:39], s52 offen offset:3072 sc1 lds
    s_waitcnt lgkmcnt(0)
    v_dot2c_f32_bf16 v106, v72, v4
    v_dot2c_f32_bf16 v107, v72, v72
    v_dot2c_f32_bf16 v106, v73, v4
    v_dot2c_f32_bf16 v107, v73, v73
    v_dot2c_f32_bf16 v106, v74, v4
    v_dot2c_f32_bf16 v107, v74, v74
    s_add_u32 m0, m0, 4096
    s_add_u32 s52, s52, 4096
    buffer_load_dwordx4 v5, s[36:39], s52 offen offset:0 sc1 lds
    v_dot2c_f32_bf16 v106, v75, v4
    v_dot2c_f32_bf16 v107, v75, v75
    v_dot2c_f32_bf16 v106, v76, v4
    v_dot2c_f32_bf16 v107, v76, v76
    v_dot2c_f32_bf16 v106, v77, v4
    v_dot2c_f32_bf16 v107, v77, v77
    buffer_load_dwordx4 v5, s[36:39], s52 offen offset:1024 sc1 lds
    v_dot2c_f32_bf16 v106, v78, v4
    v_dot2c_f32_bf16 v107, v78, v78
    v_dot2c_f32_bf16 v106, v79, v4
    v_dot2c_f32_bf16 v107, v79, v79
    s_nop 2
    v_mov_b32 v108, v106
    v_mov_b32 v109, v107
    s_nop 1
    v_permlane32_swap_b32 v106, v108
    v_permlane32_swap_b32 v107, v109
    s_nop 1
    v_add_f32 v106, v106, v108
    v_add_f32 v107, v107, v109
    ds_write_b64 v6, v[106:107] offset:0
    s_waitcnt vmcnt(6)
    ds_read_b64_tr_b16 v[48:49], v123 offset:32768
    ds_read_b64_tr_b16 v[50:51], v123 offset:33280
    ds_read_b64_tr_b16 v[52:53], v123 offset:33792
    ds_read_b64_tr_b16 v[54:55], v123 offset:34304
    ds_read_b64_tr_b16 v[56:57], v123 offset:34816
    ds_read_b64_tr_b16 v[58:59], v123 offset:35328
    ds_read_b64_tr_b16 v[60:61], v123 offset:35840
    ds_read_b64_tr_b16 v[62:63], v123 offset:36352
    ds_read_b64_tr_b16 v[64:65], v123 offset:36864
    ds_read_b64_tr_b16 v[66:67], v123 offset:37376
    ds_read_b64_tr_b16 v[68:69], v123 offset:37888
    ds_read_b64_tr_b16 v[70:71], v123 offset:38400
    s_waitcnt lgkmcnt(6)
    ds_read_b64_tr_b16 v[72:73], v123 offset:38912
    ds_read_b64_tr_b16 v[74:75], v123 offset:39424
    ds_read_b64_tr_b16 v[76:77], v123 offset:39936
    ds_read_b64_tr_b16 v[78:79], v123 offset:40448
    v_mov_b32 v106, 0
    v_mov_b32 v107, 0
    s_waitcnt lgkmcnt(8)
    v_dot2c_f32_bf16 v106, v48, v4
    v_dot2c_f32_bf16 v107, v48, v48
    v_dot2c_f32_bf16 v106, v49, v4
    v_dot2c_f32_bf16 v107, v49, v49
    v_dot2c_f32_bf16 v106, v50, v4
    v_dot2c_f32_bf16 v107, v50, v50
    buffer_load_dwordx4 v5, s[36:39], s52 offen offset:2048 sc1 lds
    v_dot2c_f32_bf16 v106, v51, v4
    v_dot2c_f32_bf16 v107, v51, v51
    v_dot2c_f32_bf16 v106, v52, v4
    v_dot2c_f32_bf16 v107, v52, v52
    v_dot2c_f32_bf16 v106, v53, v4
    v_dot2c_f32_bf16 v107, v53, v53
    buffer_load_dwordx4 v5, s[36:39], s52 offen offset:3072 sc1 lds
    v_dot2c_f32_bf16 v106, v54, v4
    v_dot2c_f32_bf16 v107, v54, v54
    v_dot2c_f32_bf16 v106, v55, v4
    v_dot2c_f32_bf16 v107, v55, v55
    s_waitcnt lgkmcnt(4)
    v_dot2c_f32_bf16 v106, v56, v4
    v_dot2c_f32_bf16 v107, v56, v56
    s_add_u32 m0, m0, 28672
    s_add_u32 s52, s52, 28672
    buffer_load_dwordx4 v5, s[36:39], s52 offen offset:0 sc1 lds
    v_dot2c_f32_bf16 v106, v57, v4
    v_dot2c_f32_bf16 v107, v57, v57
    v_dot2c_f32_bf16 v106, v58, v4
    v_dot2c_f32_bf16 v107, v58, v58
    v_dot2c_f32_bf16 v106, v59, v4
    v_dot2c_f32_bf16 v107, v59, v59
    buffer_load_dwordx4 v5, s[36:39], s52 offen offset:1024 sc1 lds
    v_dot2c_f32_bf16 v106, v60, v4
    v_dot2c_f32_bf16 v107, v60, v60
    v_dot2c_f32_bf16 v106, v61, v4
    v_dot2c_f32_bf16 v107, v61, v61
    v_dot2c_f32_bf16 v106, v62, v4
    v_dot2c_f32_bf16 v107, v62, v62
    buffer_load_dwordx4 v5, s[36:39], s52 offen offset:2048 sc1 lds
    v_dot2c_f32_bf16 v106, v63, v4
    v_dot2c_f32_bf16 v107, v63, v63
    s_waitcnt lgkmcnt(0)
    v_dot2c_f32_bf16 v106, v64, v4
    v_dot2c_f32_bf16 v107, v64, v64
    v_dot2c_f32_bf16 v106, v65, v4
    v_dot2c_f32_bf16 v107, v65, v65
    buffer_load_dwordx4 v5, s[36:39], s52 offen offset:3072 sc1 lds
    v_dot2c_f32_bf16 v106, v66, v4
    v_dot2c_f32_bf16 v107, v66, v66
    v_dot2c_f32_bf16 v106, v67, v4
    v_dot2c_f32_bf16 v107, v67, v67
    v_dot2c_f32_bf16 v106, v68, v4
    v_dot2c_f32_bf16 v107, v68, v68
    s_add_u32 m0, m0, 4096
    s_add_u32 s52, s52, 4096
    buffer_load_dwordx4 v5, s[36:39], s52 offen offset:0 sc1 lds
    v_dot2c_f32_bf16 v106, v69, v4
    v_dot2c_f32_bf16 v107, v69, v69
    v_dot2c_f32_bf16 v106, v70, v4
    v_dot2c_f32_bf16 v107, v70, v70
    v_dot2c_f32_bf16 v106, v71, v4
    v_dot2c_f32_bf16 v107, v71, v71
    buffer_load_dwordx4 v5, s[36:39], s52 offen offset:1024 sc1 lds
    s_waitcnt lgkmcnt(0)
    v_dot2c_f32_bf16 v106, v72, v4
    v_dot2c_f32_bf16 v107, v72, v72
    v_dot2c_f32_bf16 v106, v73, v4
    v_dot2c_f32_bf16 v107, v73, v73
    v_dot2c_f32_bf16 v106, v74, v4
    v_dot2c_f32_bf16 v107, v74, v74
    v_dot2c_f32_bf16 v106, v75, v4
    v_dot2c_f32_bf16 v107, v75, v75
    v_dot2c_f32_bf16 v106, v76, v4
    v_dot2c_f32_bf16 v107, v76, v76
    v_dot2c_f32_bf16 v106, v77, v4
    v_dot2c_f32_bf16 v107, v77, v77
    v_dot2c_f32_bf16 v106, v78, v4
    v_dot2c_f32_bf16 v107, v78, v78
    v_dot2c_f32_bf16 v106, v79, v4
    v_dot2c_f32_bf16 v107, v79, v79
    s_nop 2
    v_mov_b32 v108, v106
    v_mov_b32 v109, v107
    s_nop 1
    v_permlane32_swap_b32 v106, v108
    v_permlane32_swap_b32 v107, v109
    s_nop 1
    v_add_f32 v106, v106, v108
    v_add_f32 v107, v107, v109
    ds_write_b64 v6, v[106:107] offset:1024
    s_waitcnt lgkmcnt(0)
    s_barrier
    ds_read_b128 v[108:111], v7 offset:0
    ds_read_b128 v[112:115], v7 offset:16
    s_waitcnt lgkmcnt(0)
    v_pk_add_f32 v[108:109], v[108:109], v[110:111]
    v_pk_add_f32 v[112:113], v[112:113], v[114:115]
    v_pk_add_f32 v[108:109], v[108:109], v[112:113]
    v_mul_f32 v108, 0x3b000000, v108
    v_mul_f32 v109, 0x3b000000, v109
    v_fma_f32 v109, -v108, v108, v109
    v_max_f32 v109, 0, v109
    v_cvt_pk_bf16_f32 v109, v109, v109
    v_lshlrev_b32 v109, 16, v109
    v_add_f32 v109, 0x3727c5ac, v109
    v_cvt_pk_bf16_f32 v109, v109, v109
    v_lshlrev_b32 v109, 16, v109
    v_sqrt_f32 v109, v109
    s_nop 0
    v_cvt_pk_bf16_f32 v116, v108, v109
    buffer_store_dwordx2 v[116:117], v3, s[36:39], s56 offen offset:0 sc1
    s_waitcnt vmcnt(6)
    v_add_u32 v123, 0x10000, v123
    ds_read_b64_tr_b16 v[48:49], v123 offset:0
    ds_read_b64_tr_b16 v[50:51], v123 offset:512
    ds_read_b64_tr_b16 v[52:53], v123 offset:1024
    ds_read_b64_tr_b16 v[54:55], v123 offset:1536
    ds_read_b64_tr_b16 v[56:57], v123 offset:2048
    ds_read_b64_tr_b16 v[58:59], v123 offset:2560
    ds_read_b64_tr_b16 v[60:61], v123 offset:3072
    ds_read_b64_tr_b16 v[62:63], v123 offset:3584
    ds_read_b64_tr_b16 v[64:65], v123 offset:4096
    ds_read_b64_tr_b16 v[66:67], v123 offset:4608
    ds_read_b64_tr_b16 v[68:69], v123 offset:5120
    ds_read_b64_tr_b16 v[70:71], v123 offset:5632
    s_waitcnt lgkmcnt(6)
    ds_read_b64_tr_b16 v[72:73], v123 offset:6144
    ds_read_b64_tr_b16 v[74:75], v123 offset:6656
    ds_read_b64_tr_b16 v[76:77], v123 offset:7168
    ds_read_b64_tr_b16 v[78:79], v123 offset:7680
    v_mov_b32 v106, 0
    v_mov_b32 v107, 0
    s_waitcnt lgkmcnt(8)
    v_dot2c_f32_bf16 v106, v48, v4
    v_dot2c_f32_bf16 v107, v48, v48
    v_dot2c_f32_bf16 v106, v49, v4
    v_dot2c_f32_bf16 v107, v49, v49
    v_dot2c_f32_bf16 v106, v50, v4
    v_dot2c_f32_bf16 v107, v50, v50
    buffer_load_dwordx4 v5, s[36:39], s52 offen offset:2048 sc1 lds
    v_dot2c_f32_bf16 v106, v51, v4
    v_dot2c_f32_bf16 v107, v51, v51
    v_dot2c_f32_bf16 v106, v52, v4
    v_dot2c_f32_bf16 v107, v52, v52
    v_dot2c_f32_bf16 v106, v53, v4
    v_dot2c_f32_bf16 v107, v53, v53
    buffer_load_dwordx4 v5, s[36:39], s52 offen offset:3072 sc1 lds
    v_dot2c_f32_bf16 v106, v54, v4
    v_dot2c_f32_bf16 v107, v54, v54
    v_dot2c_f32_bf16 v106, v55, v4
    v_dot2c_f32_bf16 v107, v55, v55
    s_waitcnt lgkmcnt(4)
    v_dot2c_f32_bf16 v106, v56, v4
    v_dot2c_f32_bf16 v107, v56, v56
    v_dot2c_f32_bf16 v106, v57, v4
    v_dot2c_f32_bf16 v107, v57, v57
    v_dot2c_f32_bf16 v106, v58, v4
    v_dot2c_f32_bf16 v107, v58, v58
    v_dot2c_f32_bf16 v106, v59, v4
    v_dot2c_f32_bf16 v107, v59, v59
    v_dot2c_f32_bf16 v106, v60, v4
    v_dot2c_f32_bf16 v107, v60, v60
    v_dot2c_f32_bf16 v106, v61, v4
    v_dot2c_f32_bf16 v107, v61, v61
    v_dot2c_f32_bf16 v106, v62, v4
    v_dot2c_f32_bf16 v107, v62, v62
    v_dot2c_f32_bf16 v106, v63, v4
    v_dot2c_f32_bf16 v107, v63, v63
    s_waitcnt lgkmcnt(0)
    v_dot2c_f32_bf16 v106, v64, v4
    v_dot2c_f32_bf16 v107, v64, v64
    v_dot2c_f32_bf16 v106, v65, v4
    v_dot2c_f32_bf16 v107, v65, v65
    v_dot2c_f32_bf16 v106, v66, v4
    v_dot2c_f32_bf16 v107, v66, v66
    v_dot2c_f32_bf16 v106, v67, v4
    v_dot2c_f32_bf16 v107, v67, v67
    v_dot2c_f32_bf16 v106, v68, v4
    v_dot2c_f32_bf16 v107, v68, v68
    v_dot2c_f32_bf16 v106, v69, v4
    v_dot2c_f32_bf16 v107, v69, v69
    v_dot2c_f32_bf16 v106, v70, v4
    v_dot2c_f32_bf16 v107, v70, v70
    v_dot2c_f32_bf16 v106, v71, v4
    v_dot2c_f32_bf16 v107, v71, v71
    s_waitcnt lgkmcnt(0)
    v_dot2c_f32_bf16 v106, v72, v4
    v_dot2c_f32_bf16 v107, v72, v72
    v_dot2c_f32_bf16 v106, v73, v4
    v_dot2c_f32_bf16 v107, v73, v73
    v_dot2c_f32_bf16 v106, v74, v4
    v_dot2c_f32_bf16 v107, v74, v74
    v_dot2c_f32_bf16 v106, v75, v4
    v_dot2c_f32_bf16 v107, v75, v75
    v_dot2c_f32_bf16 v106, v76, v4
    v_dot2c_f32_bf16 v107, v76, v76
    v_dot2c_f32_bf16 v106, v77, v4
    v_dot2c_f32_bf16 v107, v77, v77
    v_dot2c_f32_bf16 v106, v78, v4
    v_dot2c_f32_bf16 v107, v78, v78
    v_dot2c_f32_bf16 v106, v79, v4
    v_dot2c_f32_bf16 v107, v79, v79
    s_nop 2
    v_mov_b32 v108, v106
    v_mov_b32 v109, v107
    s_nop 1
    v_permlane32_swap_b32 v106, v108
    v_permlane32_swap_b32 v107, v109
    s_nop 1
    v_add_f32 v106, v106, v108
    v_add_f32 v107, v107, v109
    ds_write_b64 v6, v[106:107] offset:2048
    s_waitcnt vmcnt(0)
    ds_read_b64_tr_b16 v[48:49], v123 offset:32768
    ds_read_b64_tr_b16 v[50:51], v123 offset:33280
    ds_read_b64_tr_b16 v[52:53], v123 offset:33792
    ds_read_b64_tr_b16 v[54:55], v123 offset:34304
    ds_read_b64_tr_b16 v[56:57], v123 offset:34816
    ds_read_b64_tr_b16 v[58:59], v123 offset:35328
    ds_read_b64_tr_b16 v[60:61], v123 offset:35840
    ds_read_b64_tr_b16 v[62:63], v123 offset:36352
    ds_read_b64_tr_b16 v[64:65], v123 offset:36864
    ds_read_b64_tr_b16 v[66:67], v123 offset:37376
    ds_read_b64_tr_b16 v[68:69], v123 offset:37888
    ds_read_b64_tr_b16 v[70:71], v123 offset:38400
    s_waitcnt lgkmcnt(6)
    ds_read_b64_tr_b16 v[72:73], v123 offset:38912
    ds_read_b64_tr_b16 v[74:75], v123 offset:39424
    ds_read_b64_tr_b16 v[76:77], v123 offset:39936
    ds_read_b64_tr_b16 v[78:79], v123 offset:40448
    v_mov_b32 v106, 0
    v_mov_b32 v107, 0
    s_waitcnt lgkmcnt(8)
    v_dot2c_f32_bf16 v106, v48, v4
    v_dot2c_f32_bf16 v107, v48, v48
    v_dot2c_f32_bf16 v106, v49, v4
    v_dot2c_f32_bf16 v107, v49, v49
    v_dot2c_f32_bf16 v106, v50, v4
    v_dot2c_f32_bf16 v107, v50, v50
    v_dot2c_f32_bf16 v106, v51, v4
    v_dot2c_f32_bf16 v107, v51, v51
    v_dot2c_f32_bf16 v106, v52, v4
    v_dot2c_f32_bf16 v107, v52, v52
    v_dot2c_f32_bf16 v106, v53, v4
    v_dot2c_f32_bf16 v107, v53, v53
    v_dot2c_f32_bf16 v106, v54, v4
    v_dot2c_f32_bf16 v107, v54, v54
    v_dot2c_f32_bf16 v106, v55, v4
    v_dot2c_f32_bf16 v107, v55, v55
    s_waitcnt lgkmcnt(4)
    v_dot2c_f32_bf16 v106, v56, v4
    v_dot2c_f32_bf16 v107, v56, v56
    v_dot2c_f32_bf16 v106, v57, v4
    v_dot2c_f32_bf16 v107, v57, v57
    v_dot2c_f32_bf16 v106, v58, v4
    v_dot2c_f32_bf16 v107, v58, v58
    v_dot2c_f32_bf16 v106, v59, v4
    v_dot2c_f32_bf16 v107, v59, v59
    v_dot2c_f32_bf16 v106, v60, v4
    v_dot2c_f32_bf16 v107, v60, v60
    v_dot2c_f32_bf16 v106, v61, v4
    v_dot2c_f32_bf16 v107, v61, v61
    v_dot2c_f32_bf16 v106, v62, v4
    v_dot2c_f32_bf16 v107, v62, v62
    v_dot2c_f32_bf16 v106, v63, v4
    v_dot2c_f32_bf16 v107, v63, v63
    s_waitcnt lgkmcnt(0)
    v_dot2c_f32_bf16 v106, v64, v4
    v_dot2c_f32_bf16 v107, v64, v64
    v_dot2c_f32_bf16 v106, v65, v4
    v_dot2c_f32_bf16 v107, v65, v65
    v_dot2c_f32_bf16 v106, v66, v4
    v_dot2c_f32_bf16 v107, v66, v66
    v_dot2c_f32_bf16 v106, v67, v4
    v_dot2c_f32_bf16 v107, v67, v67
    v_dot2c_f32_bf16 v106, v68, v4
    v_dot2c_f32_bf16 v107, v68, v68
    v_dot2c_f32_bf16 v106, v69, v4
    v_dot2c_f32_bf16 v107, v69, v69
    v_dot2c_f32_bf16 v106, v70, v4
    v_dot2c_f32_bf16 v107, v70, v70
    v_dot2c_f32_bf16 v106, v71, v4
    v_dot2c_f32_bf16 v107, v71, v71
    s_waitcnt lgkmcnt(0)
    v_dot2c_f32_bf16 v106, v72, v4
    v_dot2c_f32_bf16 v107, v72, v72
    v_dot2c_f32_bf16 v106, v73, v4
    v_dot2c_f32_bf16 v107, v73, v73
    v_dot2c_f32_bf16 v106, v74, v4
    v_dot2c_f32_bf16 v107, v74, v74
    v_dot2c_f32_bf16 v106, v75, v4
    v_dot2c_f32_bf16 v107, v75, v75
    v_dot2c_f32_bf16 v106, v76, v4
    v_dot2c_f32_bf16 v107, v76, v76
    v_dot2c_f32_bf16 v106, v77, v4
    v_dot2c_f32_bf16 v107, v77, v77
    v_dot2c_f32_bf16 v106, v78, v4
    v_dot2c_f32_bf16 v107, v78, v78
    v_dot2c_f32_bf16 v106, v79, v4
    v_dot2c_f32_bf16 v107, v79, v79
    s_nop 2
    v_mov_b32 v108, v106
    v_mov_b32 v109, v107
    s_nop 1
    v_permlane32_swap_b32 v106, v108
    v_permlane32_swap_b32 v107, v109
    s_nop 1
    v_add_f32 v106, v106, v108
    v_add_f32 v107, v107, v109
    ds_write_b64 v6, v[106:107] offset:3072
    s_waitcnt lgkmcnt(0)
    s_barrier
    ds_read_b128 v[108:111], v7 offset:2048
    ds_read_b128 v[112:115], v7 offset:2064
    s_waitcnt lgkmcnt(0)
    v_pk_add_f32 v[108:109], v[108:109], v[110:111]
    v_pk_add_f32 v[112:113], v[112:113], v[114:115]
    v_pk_add_f32 v[108:109], v[108:109], v[112:113]
    v_mul_f32 v108, 0x3b000000, v108
    v_mul_f32 v109, 0x3b000000, v109
    v_fma_f32 v109, -v108, v108, v109
    v_max_f32 v109, 0, v109
    v_cvt_pk_bf16_f32 v109, v109, v109
    v_lshlrev_b32 v109, 16, v109
    v_add_f32 v109, 0x3727c5ac, v109
    v_cvt_pk_bf16_f32 v109, v109, v109
    v_lshlrev_b32 v109, 16, v109
    v_sqrt_f32 v109, v109
    s_nop 0
    v_cvt_pk_bf16_f32 v116, v108, v109
    buffer_store_dwordx2 v[116:117], v3, s[36:39], s56 offen offset:512 sc1
    s_barrier
    s_add_u32 m0, s74, 131072
    s_nop 0
    buffer_load_dwordx4 v127, s[28:31], 0 offen offset:0  lds
    buffer_load_dwordx4 v127, s[28:31], s58 offen offset:1024  lds
    buffer_load_dwordx4 v127, s[28:31], s59 offen offset:2048  lds
    buffer_load_dwordx4 v127, s[28:31], s60 offen offset:3072  lds
    s_add_u32 m0, m0, 4096
    v_add_u32 v127, 32768, v127
    buffer_load_dwordx4 v127, s[28:31], 0 offen offset:0  lds
    buffer_load_dwordx4 v127, s[28:31], s58 offen offset:1024  lds
    buffer_load_dwordx4 v127, s[28:31], s59 offen offset:2048  lds
    s_add_u32 m0, s74, 0
    v_add_u32 v127, 196608, v127
    buffer_load_dwordx4 v127, s[28:31], 0 offen offset:0  lds
    buffer_load_dwordx4 v127, s[28:31], s58 offen offset:1024  lds
    buffer_load_dwordx4 v127, s[28:31], s59 offen offset:2048  lds
    buffer_load_dwordx4 v127, s[28:31], s60 offen offset:3072  lds
    s_add_u32 m0, m0, 4096
    v_add_u32 v127, 32768, v127
    buffer_load_dwordx4 v127, s[28:31], 0 offen offset:0  lds
    buffer_load_dwordx4 v127, s[28:31], s58 offen offset:1024  lds
    buffer_load_dwordx4 v127, s[28:31], s59 offen offset:2048  lds
    s_add_u32 m0, s74, 32768
    v_add_u32 v127, 196608, v127
    buffer_load_dwordx4 v127, s[28:31], 0 offen offset:0  lds
    buffer_load_dwordx4 v127, s[28:31], s58 offen offset:1024  lds
    buffer_load_dwordx4 v127, s[28:31], s59 offen offset:2048  lds
    buffer_load_dwordx4 v127, s[28:31], s60 offen offset:3072  lds
    s_add_u32 m0, m0, 4096
    v_add_u32 v127, 32768, v127
    buffer_load_dwordx4 v127, s[28:31], 0 offen offset:0  lds
    buffer_load_dwordx4 v127, s[28:31], s58 offen offset:1024  lds
    buffer_load_dwordx4 v127, s[28:31], s59 offen offset:2048  lds
    s_add_u32 m0, s74, 65536
    v_add_u32 v127, 196608, v127
    s_lshr_b32 s68, s48, 1
    s_mul_i32 s68, s68, 18432
    s_add_u32 m0, m0, s68
    s_nop 0
    buffer_load_dwordx4 v127, s[28:31], 0 offen offset:0  lds
    buffer_load_dwordx4 v127, s[28:31], s58 offen offset:1024  lds
    buffer_load_dwordx4 v127, s[28:31], s59 offen offset:2048  lds
    buffer_load_dwordx4 v127, s[28:31], s60 offen offset:3072  lds
    s_add_u32 m0, m0, 4096
    v_add_u32 v127, 32768, v127
    buffer_load_dwordx4 v127, s[28:31], 0 offen offset:0  lds
    buffer_load_dwordx4 v127, s[28:31], s58 offen offset:1024  lds
    buffer_load_dwordx4 v127, s[28:31], s59 offen offset:2048  lds
    s_waitcnt vmcnt(0)
    s_barrier
Lg2b:
    s_mov_b32 s62, 0
Lp3b:
    s_add_u32 s62, s62, 1
    buffer_load_dword v9, v178, s[36:39], s14 offen sc1
    s_cmp_gt_u32 s62, 1048576
    s_cbranch_scc1 Lp3bd
    s_waitcnt vmcnt(0)
    v_cmp_eq_u32 vcc, s49, v9
    s_nop 0
    s_or_b32 s53, vcc_lo, vcc_hi
    s_and_b32 s53, s53, s73
    s_cmp_lg_u32 s53, s73
    s_cbranch_scc1 Lp3b
Lp3bd:
    buffer_load_dwordx4 a[0:3], v5, s[36:39], s13 offen offset:0 sc1
    buffer_load_dwordx4 a[4:7], v5, s[36:39], s13 offen offset:1024 sc1
    buffer_load_dwordx4 a[8:11], v5, s[36:39], s13 offen offset:2048 sc1
    buffer_load_dwordx4 a[12:15], v5, s[36:39], s13 offen offset:3072 sc1
    s_add_u32 s13, s13, 4096
    buffer_load_dwordx4 a[16:19], v5, s[36:39], s13 offen offset:0 sc1
    buffer_load_dwordx4 a[20:23], v5, s[36:39], s13 offen offset:1024 sc1
    buffer_load_dwordx4 a[24:27], v5, s[36:39], s13 offen offset:2048 sc1
    buffer_load_dwordx4 a[28:31], v5, s[36:39], s13 offen offset:3072 sc1
    s_add_u32 s13, s13, 4096
    buffer_load_dwordx4 a[32:35], v5, s[36:39], s13 offen offset:0 sc1
    buffer_load_dwordx4 a[36:39], v5, s[36:39], s13 offen offset:1024 sc1
    buffer_load_dwordx4 a[40:43], v5, s[36:39], s13 offen offset:2048 sc1
    buffer_load_dwordx4 a[44:47], v5, s[36:39], s13 offen offset:3072 sc1
    ds_read_b64_tr_b16 v[128:129], v172 offset:0
    ds_read_b64_tr_b16 v[130:131], v172 offset:1024
    ds_read_b64_tr_b16 v[132:133], v172 offset:2048
    ds_read_b64_tr_b16 v[134:135], v172 offset:3072
    ds_read_b64_tr_b16 v[136:137], v172 offset:4096
    ds_read_b64_tr_b16 v[138:139], v172 offset:5120
    ds_read_b64_tr_b16 v[140:141], v172 offset:6144
    ds_read_b64_tr_b16 v[142:143], v172 offset:7168
    ds_read_b64_tr_b16 v[144:145], v172 offset:8192
    ds_read_b64_tr_b16 v[146:147], v172 offset:9216
    s_waitcnt vmcnt(11)
    s_waitcnt lgkmcnt(8)
    v_mfma_f32_32x32x16_bf16 v[16:31], v[128:131], a[0:3], 0
    ds_read_b64_tr_b16 v[148:149], v172 offset:10240
    ds_read_b64_tr_b16 v[150:151], v172 offset:11264
    s_add_u32 s13, s13, 4096
    buffer_load_dwordx4 a[48:51], v5, s[36:39], s13 offen offset:0 sc1
    s_mov_b32 m0, s57
    s_nop 0
    buffer_load_dwordx4 v5, s[36:39], s11 offen sc1 lds
    s_waitcnt vmcnt(12)
    s_waitcnt lgkmcnt(8)
    v_mfma_f32_32x32x16_bf16 v[16:31], v[132:135], a[4:7], v[16:31]
    ds_read_b64_tr_b16 v[152:153], v172 offset:12288
    ds_read_b64_tr_b16 v[154:155], v172 offset:13312
    buffer_load_dwordx4 a[52:55], v5, s[36:39], s13 offen offset:1024 sc1
    buffer_load_dwordx4 v5, s[36:39], s11 offen offset:1024 sc1 lds
    s_waitcnt vmcnt(13)
    s_waitcnt lgkmcnt(8)
    v_mfma_f32_32x32x16_bf16 v[16:31], v[136:139], a[8:11], v[16:31]
    ds_read_b64_tr_b16 v[156:157], v172 offset:14336
    ds_read_b64_tr_b16 v[158:159], v172 offset:15360
    buffer_load_dwordx4 a[56:59], v5, s[36:39], s13 offen offset:2048 sc1
    buffer_load_dwordx2 v[96:97], v171, s[36:39], s12 offen sc1
    s_waitcnt vmcnt(14)
    s_waitcnt lgkmcnt(8)
    v_mfma_f32_32x32x16_bf16 v[16:31], v[140:143], a[12:15], v[16:31]
    ds_read_b64_tr_b16 v[128:129], v172 offset:16384
    ds_read_b64_tr_b16 v[130:131], v172 offset:17408
    buffer_load_dwordx4 a[60:63], v5, s[36:39], s13 offen offset:3072 sc1
    s_waitcnt vmcnt(14)
    s_waitcnt lgkmcnt(8)
    v_mfma_f32_32x32x16_bf16 v[16:31], v[144:147], a[16:19], v[16:31]
    ds_read_b64_tr_b16 v[132:133], v172 offset:18432
    ds_read_b64_tr_b16 v[134:135], v172 offset:19456
    s_add_u32 s13, s13, 4096
    buffer_load_dwordx4 a[64:67], v5, s[36:39], s13 offen offset:0 sc1
    s_waitcnt vmcnt(14)
    s_waitcnt lgkmcnt(8)
    v_mfma_f32_32x32x16_bf16 v[16:31], v[148:151], a[20:23], v[16:31]
    ds_read_b64_tr_b16 v[136:137], v172 offset:20480
    ds_read_b64_tr_b16 v[138:139], v172 offset:21504
    buffer_load_dwordx4 a[68:71], v5, s[36:39], s13 offen offset:1024 sc1
    s_waitcnt vmcnt(14)
    s_waitcnt lgkmcnt(8)
    v_mfma_f32_32x32x16_bf16 v[16:31], v[152:155], a[24:27], v[16:31]
    ds_read_b64_tr_b16 v[140:141], v172 offset:22528
    ds_read_b64_tr_b16 v[142:143], v172 offset:23552
    buffer_load_dwordx4 a[72:75], v5, s[36:39], s13 offen offset:2048 sc1
    s_waitcnt vmcnt(14)
    s_waitcnt lgkmcnt(8)
    v_mfma_f32_32x32x16_bf16 v[16:31], v[156:159], a[28:31], v[16:31]
    ds_read_b64_tr_b16 v[144:145], v172 offset:24576
    ds_read_b64_tr_b16 v[146:147], v172 offset:25600
    buffer_load_dwordx4 a[76:79], v5, s[36:39], s13 offen offset:3072 sc1
    s_waitcnt vmcnt(14)
    s_waitcnt lgkmcnt(8)
    v_mfma_f32_32x32x16_bf16 v[16:31], v[128:131], a[32:35], v[16:31]
    ds_read_b64_tr_b16 v[148:149], v172 offset:26624
    ds_read_b64_tr_b16 v[150:151], v172 offset:27648
    s_add_u32 s13, s13, 4096
    buffer_load_dwordx4 a[80:83], v5, s[36:39], s13 offen offset:0 sc1
    s_waitcnt vmcnt(14)
    s_waitcnt lgkmcnt(8)
    v_mfma_f32_32x32x16_bf16 v[16:31], v[132:135], a[36:39], v[16:31]
    ds_read_b64_tr_b16 v[152:153], v173 offset:0
    ds_read_b64_tr_b16 v[154:155], v173 offset:1024
    buffer_load_dwordx4 a[84:87], v5, s[36:39], s13 offen offset:1024 sc1
    s_waitcnt vmcnt(14)
    s_waitcnt lgkmcnt(8)
    v_mfma_f32_32x32x16_bf16 v[16:31], v[136:139], a[40:43], v[16:31]
    ds_read_b64_tr_b16 v[156:157], v173 offset:2048
    ds_read_b64_tr_b16 v[158:159], v173 offset:3072
    buffer_load_dwordx4 a[88:91], v5, s[36:39], s13 offen offset:2048 sc1
    s_waitcnt vmcnt(14)
    s_waitcnt lgkmcnt(8)
    v_mfma_f32_32x32x16_bf16 v[16:31], v[140:143], a[44:47], v[16:31]
    ds_read_b64_tr_b16 v[128:129], v173 offset:4096
    ds_read_b64_tr_b16 v[130:131], v173 offset:5120
    buffer_load_dwordx4 a[92:95], v5, s[36:39], s13 offen offset:3072 sc1
    s_waitcnt vmcnt(14)
    s_waitcnt lgkmcnt(8)
    v_mfma_f32_32x32x16_bf16 v[16:31], v[144:147], a[48:51], v[16:31]
    ds_read_b64_tr_b16 v[132:133], v173 offset:6144
    ds_read_b64_tr_b16 v[134:135], v173 offset:7168
    s_add_u32 s13, s13, 4096
    buffer_load_dwordx4 a[96:99], v5, s[36:39], s13 offen offset:0 sc1
    s_waitcnt vmcnt(13)
    s_waitcnt lgkmcnt(8)
    v_mfma_f32_32x32x16_bf16 v[16:31], v[148:151], a[52:55], v[16:31]
    ds_read_b64_tr_b16 v[136:137], v173 offset:8192
    ds_read_b64_tr_b16 v[138:139], v173 offset:9216
    buffer_load_dwordx4 a[100:103], v5, s[36:39], s13 offen offset:1024 sc1
    s_waitcnt vmcnt(12)
    s_waitcnt lgkmcnt(8)
    v_mfma_f32_32x32x16_bf16 v[16:31], v[152:155], a[56:59], v[16:31]
    ds_read_b64_tr_b16 v[140:141], v173 offset:10240
    ds_read_b64_tr_b16 v[142:143], v173 offset:11264
    buffer_load_dwordx4 a[104:107], v5, s[36:39], s13 offen offset:2048 sc1
    s_waitcnt vmcnt(11)
    s_waitcnt lgkmcnt(8)
    v_mfma_f32_32x32x16_bf16 v[16:31], v[156:159], a[60:63], v[16:31]
    ds_read_b64_tr_b16 v[144:145], v173 offset:12288
    ds_read_b64_tr_b16 v[146:147], v173 offset:13312
    buffer_load_dwordx4 a[108:111], v5, s[36:39], s13 offen offset:3072 sc1
    s_waitcnt vmcnt(11)
    s_waitcnt lgkmcnt(8)
    v_mfma_f32_32x32x16_bf16 v[16:31], v[128:131], a[64:67], v[16:31]
    ds_read_b64_tr_b16 v[148:149], v173 offset:14336
    ds_read_b64_tr_b16 v[150:151], v173 offset:15360
    s_add_u32 s13, s13, 4096
    buffer_load_dwordx4 a[112:115], v5, s[36:39], s13 offen offset:0 sc1
    s_waitcnt vmcnt(11)
    s_waitcnt lgkmcnt(8)
    v_mfma_f32_32x32x16_bf16 v[16:31], v[132:135], a[68:71], v[16:31]
    ds_read_b64_tr_b16 v[152:153], v173 offset:16384
    ds_read_b64_tr_b16 v[154:155], v173 offset:17408
    buffer_load_dwordx4 a[116:119], v5, s[36:39], s13 offen offset:1024 sc1
    s_waitcnt vmcnt(11)
    s_waitcnt lgkmcnt(8)
    v_mfma_f32_32x32x16_bf16 v[16:31], v[136:139], a[72:75], v[16:31]
    ds_read_b64_tr_b16 v[156:157], v173 offset:18432
    ds_read_b64_tr_b16 v[158:159], v173 offset:19456
    buffer_load_dwordx4 a[120:123], v5, s[36:39], s13 offen offset:2048 sc1
    s_waitcnt vmcnt(11)
    s_waitcnt lgkmcnt(8)
    v_mfma_f32_32x32x16_bf16 v[16:31], v[140:143], a[76:79], v[16:31]
    ds_read_b64_tr_b16 v[128:129], v173 offset:20480
    ds_read_b64_tr_b16 v[130:131], v173 offset:21504
    buffer_load_dwordx4 a[124:127], v5, s[36:39], s13 offen offset:3072 sc1
    s_waitcnt vmcnt(11)
    s_waitcnt lgkmcnt(8)
    v_mfma_f32_32x32x16_bf16 v[16:31], v[144:147], a[80:83], v[16:31]
    ds_read_b64_tr_b16 v[132:133], v173 offset:22528
    ds_read_b64_tr_b16 v[134:135], v173 offset:23552
    s_add_u32 s13, s13, 4096
    buffer_load_dwordx4 a[128:131], v5, s[36:39], s13 offen offset:0 sc1
    s_waitcnt vmcnt(11)
    s_waitcnt lgkmcnt(8)
    v_mfma_f32_32x32x16_bf16 v[16:31], v[148:151], a[84:87], v[16:31]
    ds_read_b64_tr_b16 v[136:137], v173 offset:24576
    ds_read_b64_tr_b16 v[138:139], v173 offset:25600
    buffer_load_dwordx4 a[132:135], v5, s[36:39], s13 offen offset:1024 sc1
    s_waitcnt vmcnt(11)
    s_waitcnt lgkmcnt(8)
    v_mfma_f32_32x32x16_bf16 v[16:31], v[152:155], a[88:91], v[16:31]
    ds_read_b64_tr_b16 v[140:141], v173 offset:26624
    ds_read_b64_tr_b16 v[142:143], v173 offset:27648
    buffer_load_dwordx4 a[136:139], v5, s[36:39], s13 offen offset:2048 sc1
    s_waitcnt vmcnt(11)
    s_waitcnt lgkmcnt(8)
    v_mfma_f32_32x32x16_bf16 v[16:31], v[156:159], a[92:95], v[16:31]
    ds_read_b64_tr_b16 v[144:145], v173 offset:32768
    ds_read_b64_tr_b16 v[146:147], v173 offset:33792
    buffer_load_dwordx4 a[140:143], v5, s[36:39], s13 offen offset:3072 sc1
    s_waitcnt vmcnt(11)
    s_waitcnt lgkmcnt(8)
    v_mfma_f32_32x32x16_bf16 v[16:31], v[128:131], a[96:99], v[16:31]
    ds_read_b64_tr_b16 v[148:149], v173 offset:34816
    ds_read_b64_tr_b16 v[150:151], v173 offset:35840
    s_add_u32 s13, s13, 4096
    buffer_load_dwordx4 a[144:147], v5, s[36:39], s13 offen offset:0 sc1
    s_waitcnt vmcnt(11)
    s_waitcnt lgkmcnt(8)
    v_mfma_f32_32x32x16_bf16 v[16:31], v[132:135], a[100:103], v[16:31]
    ds_read_b64_tr_b16 v[152:153], v173 offset:36864
    ds_read_b64_tr_b16 v[154:155], v173 offset:37888
    buffer_load_dwordx4 a[148:151], v5, s[36:39], s13 offen offset:1024 sc1
    s_waitcnt vmcnt(11)
    s_waitcnt lgkmcnt(8)
    v_mfma_f32_32x32x16_bf16 v[16:31], v[136:139], a[104:107], v[16:31]
    ds_read_b64_tr_b16 v[156:157], v173 offset:38912
    ds_read_b64_tr_b16 v[158:159], v173 offset:39936
    buffer_load_dwordx4 a[152:155], v5, s[36:39], s13 offen offset:2048 sc1
    s_waitcnt vmcnt(11)
    s_waitcnt lgkmcnt(8)
    v_mfma_f32_32x32x16_bf16 v[16:31], v[140:143], a[108:111], v[16:31]
    ds_read_b64_tr_b16 v[128:129], v173 offset:40960
    ds_read_b64_tr_b16 v[130:131], v173 offset:41984
    buffer_load_dwordx4 a[156:159], v5, s[36:39], s13 offen offset:3072 sc1
    s_waitcnt vmcnt(11)
    s_waitcnt lgkmcnt(8)
    v_mfma_f32_32x32x16_bf16 v[16:31], v[144:147], a[112:115], v[16:31]
    ds_read_b64_tr_b16 v[132:133], v173 offset:43008
    ds_read_b64_tr_b16 v[134:135], v173 offset:44032
    s_add_u32 s13, s13, 4096
    buffer_load_dwordx4 a[160:163], v5, s[36:39], s13 offen offset:0 sc1
    s_waitcnt vmcnt(11)
    s_waitcnt lgkmcnt(8)
    v_mfma_f32_32x32x16_bf16 v[16:31], v[148:151], a[116:119], v[16:31]
    ds_read_b64_tr_b16 v[136:137], v173 offset:45056
    ds_read_b64_tr_b16 v[138:139], v173 offset:46080
    buffer_load_dwordx4 a[164:167], v5, s[36:39], s13 offen offset:1024 sc1
    s_waitcnt vmcnt(11)
    s_waitcnt lgkmcnt(8)
    v_mfma_f32_32x32x16_bf16 v[16:31], v[152:155], a[120:123], v[16:31]
    ds_read_b64_tr_b16 v[140:141], v173 offset:47104
    ds_read_b64_tr_b16 v[142:143], v173 offset:48128
    buffer_load_dwordx4 a[168:171], v5, s[36:39], s13 offen offset:2048 sc1
    s_xor_b32 s52, s2, 1
    s_waitcnt vmcnt(11)
    s_waitcnt lgkmcnt(8)
    v_mfma_f32_32x32x16_bf16 v[16:31], v[156:159], a[124:127], v[16:31]
    ds_read_b64_tr_b16 v[144:145], v173 offset:49152
    ds_read_b64_tr_b16 v[146:147], v173 offset:50176
    buffer_load_dwordx4 a[172:175], v5, s[36:39], s13 offen offset:3072 sc1
    s_and_b32 s53, s52, 7
    s_lshl_b32 s53, s53, 5
    s_waitcnt vmcnt(11)
    s_waitcnt lgkmcnt(8)
    v_mfma_f32_32x32x16_bf16 v[16:31], v[128:131], a[128:131], v[16:31]
    ds_read_b64_tr_b16 v[148:149], v173 offset:51200
    ds_read_b64_tr_b16 v[150:151], v173 offset:52224
    s_add_u32 s13, s13, 4096
    buffer_load_dwordx4 a[176:179], v5, s[36:39], s13 offen offset:0 sc1
    s_add_u32 s53, s53, s47
    s_lshl_b32 s53, s53, 2
    s_waitcnt vmcnt(11)
    s_waitcnt lgkmcnt(8)
    v_mfma_f32_32x32x16_bf16 v[16:31], v[132:135], a[132:135], v[16:31]
    ds_read_b64_tr_b16 v[152:153], v173 offset:53248
    ds_read_b64_tr_b16 v[154:155], v173 offset:54272
    buffer_load_dwordx4 a[180:183], v5, s[36:39], s13 offen offset:1024 sc1
    s_add_u32 s53, s53, s48
    s_lshl_b32 s58, s53, 12
    s_waitcnt vmcnt(11)
    s_waitcnt lgkmcnt(8)
    v_mfma_f32_32x32x16_bf16 v[16:31], v[136:139], a[136:139], v[16:31]
    ds_read_b64_tr_b16 v[156:157], v173 offset:55296
    ds_read_b64_tr_b16 v[158:159], v173 offset:56320
    buffer_load_dwordx4 a[184:187], v5, s[36:39], s13 offen offset:2048 sc1
    s_add_u32 s58, s58, 0x400000
    s_xor_b32 s59, s58, 0x80000
    s_waitcnt vmcnt(11)
    s_waitcnt lgkmcnt(8)
    v_mfma_f32_32x32x16_bf16 v[16:31], v[140:143], a[140:143], v[16:31]
    ds_read_b64_tr_b16 v[128:129], v173 offset:57344
    ds_read_b64_tr_b16 v[130:131], v173 offset:58368
    buffer_load_dwordx4 a[188:191], v5, s[36:39], s13 offen offset:3072 sc1
    s_lshl_b32 s52, s10, 15
    s_lshl_b32 s53, s9, 7
    s_waitcnt vmcnt(11)
    s_waitcnt lgkmcnt(8)
    v_mfma_f32_32x32x16_bf16 v[16:31], v[144:147], a[144:147], v[16:31]
    ds_read_b64_tr_b16 v[132:133], v173 offset:59392
    ds_read_b64_tr_b16 v[134:135], v173 offset:60416
    s_add_u32 s13, s13, 4096
    buffer_load_dwordx4 a[192:195], v5, s[36:39], s13 offen offset:0 sc1
    s_add_u32 s52, s52, s53
    s_lshl_b32 s53, s99, 6
    s_waitcnt vmcnt(11)
    s_waitcnt lgkmcnt(8)
    v_mfma_f32_32x32x16_bf16 v[16:31], v[148:151], a[148:151], v[16:31]
    ds_read_b64_tr_b16 v[136:137], v174 offset:0
    ds_read_b64_tr_b16 v[138:139], v174 offset:1024
    buffer_load_dwordx4 a[196:199], v5, s[36:39], s13 offen offset:1024 sc1
    s_add_u32 s52, s52, s53
    s_add_u32 s53, s52, 0x4000
    s_waitcnt vmcnt(11)
    s_waitcnt lgkmcnt(8)
    v_mfma_f32_32x32x16_bf16 v[16:31], v[152:155], a[152:155], v[16:31]
    ds_read_b64_tr_b16 v[140:141], v174 offset:2048
    ds_read_b64_tr_b16 v[142:143], v174 offset:3072
    buffer_load_dwordx4 a[200:203], v5, s[36:39], s13 offen offset:2048 sc1
    v_cmp_ne_u32 vcc, s49, v97
    s_cbranch_vccz Lrbk
    s_mov_b32 s62, 0
    Lrb:
    buffer_load_dwordx2 v[96:97], v171, s[36:39], s12 offen sc1
    s_add_u32 s62, s62, 1
    s_cmp_gt_u32 s62, 1048576
    s_cbranch_scc1 Lrbk
    s_waitcnt vmcnt(0)
    v_cmp_ne_u32 vcc, s49, v97
    s_cbranch_vccnz Lrb
    Lrbk:
    v_and_b32 v96, 0xffff0000, v96
    s_waitcnt vmcnt(11)
    s_waitcnt lgkmcnt(8)
    v_mfma_f32_32x32x16_bf16 v[16:31], v[156:159], a[156:159], v[16:31]
    ds_read_b64_tr_b16 v[144:145], v174 offset:4096
    ds_read_b64_tr_b16 v[146:147], v174 offset:5120
    buffer_load_dwordx4 a[204:207], v5, s[36:39], s13 offen offset:3072 sc1
    v_rcp_f32 v96, v96
    s_waitcnt vmcnt(11)
    s_waitcnt lgkmcnt(8)
    v_mfma_f32_32x32x16_bf16 v[16:31], v[128:131], a[160:163], v[16:31]
    ds_read_b64_tr_b16 v[148:149], v174 offset:6144
    ds_read_b64_tr_b16 v[150:151], v174 offset:7168
    s_add_u32 s13, s13, 4096
    buffer_load_dwordx4 a[208:211], v5, s[36:39], s13 offen offset:0 sc1
    v_mov_b32 v11, s49
    v_mov_b32 v12, 0xff
    s_waitcnt vmcnt(11)
    s_waitcnt lgkmcnt(8)
    v_mfma_f32_32x32x16_bf16 v[16:31], v[132:135], a[164:167], v[16:31]
    ds_read_b64_tr_b16 v[152:153], v174 offset:8192
    ds_read_b64_tr_b16 v[154:155], v174 offset:9216
    buffer_load_dwordx4 a[212:215], v5, s[36:39], s13 offen offset:1024 sc1
    v_and_b32 v8, 0xff, v11
    v_bfe_u32 v9, v11, 8, 8
    s_waitcnt vmcnt(11)
    s_waitcnt lgkmcnt(8)
    v_mfma_f32_32x32x16_bf16 v[16:31], v[136:139], a[168:171], v[16:31]
    ds_read_b64_tr_b16 v[156:157], v174 offset:10240
    ds_read_b64_tr_b16 v[158:159], v174 offset:11264
    buffer_load_dwordx4 a[216:219], v5, s[36:39], s13 offen offset:2048 sc1
    v_bfe_u32 v10, v11, 16, 8
    v_lshrrev_b32 v11, 24, v11
    s_waitcnt vmcnt(11)
    s_waitcnt lgkmcnt(8)
    v_mfma_f32_32x32x16_bf16 v[16:31], v[140:143], a[172:175], v[16:31]
    ds_read_b64_tr_b16 v[128:129], v174 offset:12288
    ds_read_b64_tr_b16 v[130:131], v174 offset:13312
    buffer_load_dwordx4 a[220:223], v5, s[36:39], s13 offen offset:3072 sc1
    s_waitcnt vmcnt(11)
    s_waitcnt lgkmcnt(8)
    v_mfma_f32_32x32x16_bf16 v[16:31], v[144:147], a[176:179], v[16:31]
    ds_read_b64_tr_b16 v[132:133], v174 offset:32768
    ds_read_b64_tr_b16 v[134:135], v174 offset:33792
    s_waitcnt vmcnt(10)
    s_waitcnt lgkmcnt(8)
    v_mfma_f32_32x32x16_bf16 v[16:31], v[148:151], a[180:183], v[16:31]
    ds_read_b64_tr_b16 v[136:137], v174 offset:34816
    ds_read_b64_tr_b16 v[138:139], v174 offset:35840
    s_waitcnt vmcnt(9)
    s_waitcnt lgkmcnt(8)
    v_mfma_f32_32x32x16_bf16 v[16:31], v[152:155], a[184:187], v[16:31]
    ds_read_b64_tr_b16 v[140:141], v174 offset:36864
    ds_read_b64_tr_b16 v[142:143], v174 offset:37888
    s_waitcnt vmcnt(8)
    s_waitcnt lgkmcnt(8)
    v_mfma_f32_32x32x16_bf16 v[16:31], v[156:159], a[188:191], v[16:31]
    ds_read_b64_tr_b16 v[144:145], v174 offset:38912
    ds_read_b64_tr_b16 v[146:147], v174 offset:39936
    s_waitcnt vmcnt(7)
    s_waitcnt lgkmcnt(8)
    v_mfma_f32_32x32x16_bf16 v[16:31], v[128:131], a[192:195], v[16:31]
    ds_read_b64_tr_b16 v[148:149], v174 offset:40960
    ds_read_b64_tr_b16 v[150:151], v174 offset:41984
    s_waitcnt vmcnt(6)
    s_waitcnt lgkmcnt(8)
    v_mfma_f32_32x32x16_bf16 v[16:31], v[132:135], a[196:199], v[16:31]
    ds_read_b64_tr_b16 v[152:153], v174 offset:43008
    ds_read_b64_tr_b16 v[154:155], v174 offset:44032
    s_waitcnt vmcnt(5)
    s_waitcnt lgkmcnt(8)
    v_mfma_f32_32x32x16_bf16 v[16:31], v[136:139], a[200:203], v[16:31]
    ds_read_b64_tr_b16 v[156:157], v174 offset:45056
    ds_read_b64_tr_b16 v[158:159], v174 offset:46080
    s_waitcnt vmcnt(4)
    s_waitcnt lgkmcnt(8)
    v_mfma_f32_32x32x16_bf16 v[16:31], v[140:143], a[204:207], v[16:31]
    ds_read_b64_tr_b16 v[128:129], v175 offset:0
    ds_read_b64_tr_b16 v[130:131], v175 offset:1024
    s_waitcnt vmcnt(3)
    s_waitcnt lgkmcnt(8)
    v_mfma_f32_32x32x16_bf16 v[16:31], v[144:147], a[208:211], v[16:31]
    ds_read_b64_tr_b16 v[132:133], v175 offset:2048
    ds_read_b64_tr_b16 v[134:135], v175 offset:3072
    s_waitcnt vmcnt(2)
    s_waitcnt lgkmcnt(8)
    v_mfma_f32_32x32x16_bf16 v[16:31], v[148:151], a[212:215], v[16:31]
    ds_read_b64_tr_b16 v[136:137], v175 offset:4096
    ds_read_b64_tr_b16 v[138:139], v175 offset:5120
    s_waitcnt vmcnt(1)
    s_waitcnt lgkmcnt(8)
    v_mfma_f32_32x32x16_bf16 v[16:31], v[152:155], a[216:219], v[16:31]
    ds_read_b64_tr_b16 v[140:141], v175 offset:6144
    ds_read_b64_tr_b16 v[142:143], v175 offset:7168
    s_waitcnt vmcnt(0)
    s_waitcnt lgkmcnt(8)
    v_mfma_f32_32x32x16_bf16 v[16:31], v[156:159], a[220:223], v[16:31]
    ds_read_b64_tr_b16 v[144:145], v175 offset:8192
    ds_read_b64_tr_b16 v[146:147], v175 offset:9216
    s_waitcnt lgkmcnt(8)
    v_mfma_f32_32x32x16_bf16 v[32:47], v[128:131], a[0:3], 0
    ds_read_b64_tr_b16 v[148:149], v175 offset:10240
    ds_read_b64_tr_b16 v[150:151], v175 offset:11264
    s_waitcnt lgkmcnt(8)
    v_mfma_f32_32x32x16_bf16 v[32:47], v[132:135], a[4:7], v[32:47]
    ds_read_b64_tr_b16 v[152:153], v175 offset:12288
    ds_read_b64_tr_b16 v[154:155], v175 offset:13312
    s_waitcnt lgkmcnt(8)
    v_mfma_f32_32x32x16_bf16 v[32:47], v[136:139], a[8:11], v[32:47]
    ds_read_b64_tr_b16 v[156:157], v175 offset:14336
    ds_read_b64_tr_b16 v[158:159], v175 offset:15360
    s_waitcnt lgkmcnt(8)
    v_mfma_f32_32x32x16_bf16 v[32:47], v[140:143], a[12:15], v[32:47]
    ds_read_b64_tr_b16 v[128:129], v175 offset:16384
    ds_read_b64_tr_b16 v[130:131], v175 offset:17408
    v_bfi_b32 v16, v12, v8, v16
    v_bfi_b32 v17, v12, v9, v17
    v_bfi_b32 v18, v12, v10, v18
    v_bfi_b32 v19, v12, v11, v19
    buffer_store_dwordx4 v[16:19], v5, s[36:39], s58 offen offset:0 sc1
    s_waitcnt lgkmcnt(8)
    v_mfma_f32_32x32x16_bf16 v[32:47], v[144:147], a[16:19], v[32:47]
    ds_read_b64_tr_b16 v[132:133], v175 offset:18432
    ds_read_b64_tr_b16 v[134:135], v175 offset:19456
    v_bfi_b32 v20, v12, v8, v20
    v_bfi_b32 v21, v12, v9, v21
    v_bfi_b32 v22, v12, v10, v22
    v_bfi_b32 v23, v12, v11, v23
    buffer_store_dwordx4 v[20:23], v5, s[36:39], s58 offen offset:1024 sc1
    s_waitcnt lgkmcnt(8)
    v_mfma_f32_32x32x16_bf16 v[32:47], v[148:151], a[20:23], v[32:47]
    ds_read_b64_tr_b16 v[136:137], v175 offset:20480
    ds_read_b64_tr_b16 v[138:139], v175 offset:21504
    v_bfi_b32 v24, v12, v8, v24
    v_bfi_b32 v25, v12, v9, v25
    v_bfi_b32 v26, v12, v10, v26
    v_bfi_b32 v27, v12, v11, v27
    buffer_store_dwordx4 v[24:27], v5, s[36:39], s58 offen offset:2048 sc1
    s_waitcnt lgkmcnt(8)
    v_mfma_f32_32x32x16_bf16 v[32:47], v[152:155], a[24:27], v[32:47]
    ds_read_b64_tr_b16 v[140:141], v175 offset:22528
    ds_read_b64_tr_b16 v[142:143], v175 offset:23552
    v_bfi_b32 v28, v12, v8, v28
    v_bfi_b32 v29, v12, v9, v29
    v_bfi_b32 v30, v12, v10, v30
    v_bfi_b32 v31, v12, v11, v31
    buffer_store_dwordx4 v[28:31], v5, s[36:39], s58 offen offset:3072 sc1
    s_waitcnt lgkmcnt(8)
    v_mfma_f32_32x32x16_bf16 v[32:47], v[156:159], a[28:31], v[32:47]
    ds_read_b64_tr_b16 v[144:145], v175 offset:24576
    ds_read_b64_tr_b16 v[146:147], v175 offset:25600
    s_waitcnt lgkmcnt(8)
    v_mfma_f32_32x32x16_bf16 v[32:47], v[128:131], a[32:35], v[32:47]
    ds_read_b64_tr_b16 v[148:149], v175 offset:26624
    ds_read_b64_tr_b16 v[150:151], v175 offset:27648
    ds_read_b64_tr_b16 v[98:99], v170 offset:0
    ds_read_b64_tr_b16 v[100:101], v170 offset:512
    ds_read_b64_tr_b16 v[102:103], v170 offset:1024
    ds_read_b64_tr_b16 v[104:105], v170 offset:1536
    s_waitcnt lgkmcnt(8)
    v_mfma_f32_32x32x16_bf16 v[32:47], v[132:135], a[36:39], v[32:47]
    ds_read_b64_tr_b16 v[152:153], v176 offset:0
    ds_read_b64_tr_b16 v[154:155], v176 offset:1024
    s_waitcnt lgkmcnt(8)
    v_mfma_f32_32x32x16_bf16 v[32:47], v[136:139], a[40:43], v[32:47]
    ds_read_b64_tr_b16 v[156:157], v176 offset:2048
    ds_read_b64_tr_b16 v[158:159], v176 offset:3072
    s_waitcnt lgkmcnt(8)
    v_mfma_f32_32x32x16_bf16 v[32:47], v[140:143], a[44:47], v[32:47]
    ds_read_b64_tr_b16 v[128:129], v176 offset:4096
    ds_read_b64_tr_b16 v[130:131], v176 offset:5120
    s_waitcnt lgkmcnt(8)
    v_mfma_f32_32x32x16_bf16 v[32:47], v[144:147], a[48:51], v[32:47]
    ds_read_b64_tr_b16 v[132:133], v176 offset:6144
    ds_read_b64_tr_b16 v[134:135], v176 offset:7168
    s_waitcnt lgkmcnt(8)
    v_mfma_f32_32x32x16_bf16 v[32:47], v[148:151], a[52:55], v[32:47]
    ds_read_b64_tr_b16 v[136:137], v176 offset:8192
    ds_read_b64_tr_b16 v[138:139], v176 offset:9216
    s_waitcnt lgkmcnt(8)
    v_mfma_f32_32x32x16_bf16 v[32:47], v[152:155], a[56:59], v[32:47]
    ds_read_b64_tr_b16 v[140:141], v176 offset:10240
    ds_read_b64_tr_b16 v[142:143], v176 offset:11264
    s_waitcnt lgkmcnt(8)
    v_mfma_f32_32x32x16_bf16 v[32:47], v[156:159], a[60:63], v[32:47]
    ds_read_b64_tr_b16 v[144:145], v176 offset:12288
    ds_read_b64_tr_b16 v[146:147], v176 offset:13312
    s_waitcnt lgkmcnt(8)
    v_mfma_f32_32x32x16_bf16 v[32:47], v[128:131], a[64:67], v[32:47]
    ds_read_b64_tr_b16 v[148:149], v176 offset:14336
    ds_read_b64_tr_b16 v[150:151], v176 offset:15360
    v_lshlrev_b32 v80, 16, v98
    s_waitcnt lgkmcnt(8)
    v_mfma_f32_32x32x16_bf16 v[32:47], v[132:135], a[68:71], v[32:47]
    ds_read_b64_tr_b16 v[152:153], v176 offset:16384
    ds_read_b64_tr_b16 v[154:155], v176 offset:17408
    v_and_b32 v81, 0xffff0000, v98
    s_waitcnt lgkmcnt(8)
    v_mfma_f32_32x32x16_bf16 v[32:47], v[136:139], a[72:75], v[32:47]
    ds_read_b64_tr_b16 v[156:157], v176 offset:18432
    ds_read_b64_tr_b16 v[158:159], v176 offset:19456
    v_lshlrev_b32 v82, 16, v99
    s_waitcnt lgkmcnt(8)
    v_mfma_f32_32x32x16_bf16 v[32:47], v[140:143], a[76:79], v[32:47]
    ds_read_b64_tr_b16 v[128:129], v176 offset:20480
    ds_read_b64_tr_b16 v[130:131], v176 offset:21504
    v_and_b32 v83, 0xffff0000, v99
    s_waitcnt lgkmcnt(8)
    v_mfma_f32_32x32x16_bf16 v[32:47], v[144:147], a[80:83], v[32:47]
    ds_read_b64_tr_b16 v[132:133], v176 offset:22528
    ds_read_b64_tr_b16 v[134:135], v176 offset:23552
    v_lshlrev_b32 v84, 16, v100
    s_waitcnt lgkmcnt(8)
    v_mfma_f32_32x32x16_bf16 v[32:47], v[148:151], a[84:87], v[32:47]
    ds_read_b64_tr_b16 v[136:137], v176 offset:24576
    ds_read_b64_tr_b16 v[138:139], v176 offset:25600
    v_and_b32 v85, 0xffff0000, v100
    s_waitcnt lgkmcnt(8)
    v_mfma_f32_32x32x16_bf16 v[32:47], v[152:155], a[88:91], v[32:47]
    ds_read_b64_tr_b16 v[140:141], v176 offset:26624
    ds_read_b64_tr_b16 v[142:143], v176 offset:27648
    v_lshlrev_b32 v86, 16, v101
    s_waitcnt lgkmcnt(8)
    v_mfma_f32_32x32x16_bf16 v[32:47], v[156:159], a[92:95], v[32:47]
    ds_read_b64_tr_b16 v[144:145], v176 offset:32768
    ds_read_b64_tr_b16 v[146:147], v176 offset:33792
    v_and_b32 v87, 0xffff0000, v101
    s_waitcnt lgkmcnt(8)
    v_mfma_f32_32x32x16_bf16 v[32:47], v[128:131], a[96:99], v[32:47]
    ds_read_b64_tr_b16 v[148:149], v176 offset:34816
    ds_read_b64_tr_b16 v[150:151], v176 offset:35840
    v_lshlrev_b32 v88, 16, v102
    s_waitcnt lgkmcnt(8)
    v_mfma_f32_32x32x16_bf16 v[32:47], v[132:135], a[100:103], v[32:47]
    ds_read_b64_tr_b16 v[152:153], v176 offset:36864
    ds_read_b64_tr_b16 v[154:155], v176 offset:37888
    v_and_b32 v89, 0xffff0000, v102
    s_waitcnt lgkmcnt(8)
    v_mfma_f32_32x32x16_bf16 v[32:47], v[136:139], a[104:107], v[32:47]
    ds_read_b64_tr_b16 v[156:157], v176 offset:38912
    ds_read_b64_tr_b16 v[158:159], v176 offset:39936
    v_lshlrev_b32 v90, 16, v103
    s_waitcnt lgkmcnt(8)
    v_mfma_f32_32x32x16_bf16 v[32:47], v[140:143], a[108:111], v[32:47]
    ds_read_b64_tr_b16 v[128:129], v176 offset:40960
    ds_read_b64_tr_b16 v[130:131], v176 offset:41984
    v_and_b32 v91, 0xffff0000, v103
    s_waitcnt lgkmcnt(8)
    v_mfma_f32_32x32x16_bf16 v[32:47], v[144:147], a[112:115], v[32:47]
    ds_read_b64_tr_b16 v[132:133], v176 offset:43008
    ds_read_b64_tr_b16 v[134:135], v176 offset:44032
    v_lshlrev_b32 v92, 16, v104
    s_waitcnt lgkmcnt(8)
    v_mfma_f32_32x32x16_bf16 v[32:47], v[148:151], a[116:119], v[32:47]
    ds_read_b64_tr_b16 v[136:137], v176 offset:45056
    ds_read_b64_tr_b16 v[138:139], v176 offset:46080
    v_and_b32 v93, 0xffff0000, v104
    s_waitcnt lgkmcnt(8)
    v_mfma_f32_32x32x16_bf16 v[32:47], v[152:155], a[120:123], v[32:47]
    ds_read_b64_tr_b16 v[140:141], v176 offset:47104
    ds_read_b64_tr_b16 v[142:143], v176 offset:48128
    v_lshlrev_b32 v94, 16, v105
    s_waitcnt lgkmcnt(8)
    v_mfma_f32_32x32x16_bf16 v[32:47], v[156:159], a[124:127], v[32:47]
    ds_read_b64_tr_b16 v[144:145], v176 offset:49152
    ds_read_b64_tr_b16 v[146:147], v176 offset:50176
    v_and_b32 v95, 0xffff0000, v105
    s_waitcnt lgkmcnt(8)
    v_mfma_f32_32x32x16_bf16 v[32:47], v[128:131], a[128:131], v[32:47]
    ds_read_b64_tr_b16 v[148:149], v176 offset:51200
    ds_read_b64_tr_b16 v[150:151], v176 offset:52224
    s_waitcnt lgkmcnt(8)
    v_mfma_f32_32x32x16_bf16 v[32:47], v[132:135], a[132:135], v[32:47]
    ds_read_b64_tr_b16 v[152:153], v176 offset:53248
    ds_read_b64_tr_b16 v[154:155], v176 offset:54272
    s_waitcnt lgkmcnt(8)
    v_mfma_f32_32x32x16_bf16 v[32:47], v[136:139], a[136:139], v[32:47]
    ds_read_b64_tr_b16 v[156:157], v176 offset:55296
    ds_read_b64_tr_b16 v[158:159], v176 offset:56320
    s_waitcnt lgkmcnt(8)
    v_mfma_f32_32x32x16_bf16 v[32:47], v[140:143], a[140:143], v[32:47]
    ds_read_b64_tr_b16 v[128:129], v176 offset:57344
    ds_read_b64_tr_b16 v[130:131], v176 offset:58368
    s_waitcnt lgkmcnt(8)
    v_mfma_f32_32x32x16_bf16 v[32:47], v[144:147], a[144:147], v[32:47]
    ds_read_b64_tr_b16 v[132:133], v176 offset:59392
    ds_read_b64_tr_b16 v[134:135], v176 offset:60416
    s_waitcnt lgkmcnt(8)
    v_mfma_f32_32x32x16_bf16 v[32:47], v[148:151], a[148:151], v[32:47]
    ds_read_b64_tr_b16 v[136:137], v177 offset:0
    ds_read_b64_tr_b16 v[138:139], v177 offset:1024
    s_waitcnt lgkmcnt(8)
    v_mfma_f32_32x32x16_bf16 v[32:47], v[152:155], a[152:155], v[32:47]
    ds_read_b64_tr_b16 v[140:141], v177 offset:2048
    ds_read_b64_tr_b16 v[142:143], v177 offset:3072
    s_waitcnt lgkmcnt(8)
    v_mfma_f32_32x32x16_bf16 v[32:47], v[156:159], a[156:159], v[32:47]
    ds_read_b64_tr_b16 v[144:145], v177 offset:4096
    ds_read_b64_tr_b16 v[146:147], v177 offset:5120
    s_waitcnt lgkmcnt(8)
    v_mfma_f32_32x32x16_bf16 v[32:47], v[128:131], a[160:163], v[32:47]
    ds_read_b64_tr_b16 v[148:149], v177 offset:6144
    ds_read_b64_tr_b16 v[150:151], v177 offset:7168
    s_waitcnt lgkmcnt(8)
    v_mfma_f32_32x32x16_bf16 v[32:47], v[132:135], a[164:167], v[32:47]
    ds_read_b64_tr_b16 v[152:153], v177 offset:8192
    ds_read_b64_tr_b16 v[154:155], v177 offset:9216
    s_waitcnt lgkmcnt(8)
    v_mfma_f32_32x32x16_bf16 v[32:47], v[136:139], a[168:171], v[32:47]
    ds_read_b64_tr_b16 v[156:157], v177 offset:10240
    ds_read_b64_tr_b16 v[158:159], v177 offset:11264
    s_waitcnt lgkmcnt(8)
    v_mfma_f32_32x32x16_bf16 v[32:47], v[140:143], a[172:175], v[32:47]
    ds_read_b64_tr_b16 v[128:129], v177 offset:12288
    ds_read_b64_tr_b16 v[130:131], v177 offset:13312
    s_waitcnt lgkmcnt(8)
    v_mfma_f32_32x32x16_bf16 v[32:47], v[144:147], a[176:179], v[32:47]
    ds_read_b64_tr_b16 v[132:133], v177 offset:32768
    ds_read_b64_tr_b16 v[134:135], v177 offset:33792
    buffer_load_dwordx4 v[48:51], v5, s[36:39], s59 offen offset:0 sc1
    s_waitcnt lgkmcnt(8)
    v_mfma_f32_32x32x16_bf16 v[32:47], v[148:151], a[180:183], v[32:47]
    ds_read_b64_tr_b16 v[136:137], v177 offset:34816
    ds_read_b64_tr_b16 v[138:139], v177 offset:35840
    buffer_load_dwordx4 v[52:55], v5, s[36:39], s59 offen offset:1024 sc1
    s_waitcnt lgkmcnt(8)
    v_mfma_f32_32x32x16_bf16 v[32:47], v[152:155], a[184:187], v[32:47]
    ds_read_b64_tr_b16 v[140:141], v177 offset:36864
    ds_read_b64_tr_b16 v[142:143], v177 offset:37888
    buffer_load_dwordx4 v[56:59], v5, s[36:39], s59 offen offset:2048 sc1
    s_waitcnt lgkmcnt(8)
    v_mfma_f32_32x32x16_bf16 v[32:47], v[156:159], a[188:191], v[32:47]
    ds_read_b64_tr_b16 v[144:145], v177 offset:38912
    ds_read_b64_tr_b16 v[146:147], v177 offset:39936
    buffer_load_dwordx4 v[60:63], v5, s[36:39], s59 offen offset:3072 sc1
    s_waitcnt lgkmcnt(8)
    v_mfma_f32_32x32x16_bf16 v[32:47], v[128:131], a[192:195], v[32:47]
    ds_read_b64_tr_b16 v[148:149], v177 offset:40960
    ds_read_b64_tr_b16 v[150:151], v177 offset:41984
    s_waitcnt lgkmcnt(8)
    v_mfma_f32_32x32x16_bf16 v[32:47], v[132:135], a[196:199], v[32:47]
    ds_read_b64_tr_b16 v[152:153], v177 offset:43008
    ds_read_b64_tr_b16 v[154:155], v177 offset:44032
    s_waitcnt lgkmcnt(8)
    v_mfma_f32_32x32x16_bf16 v[32:47], v[136:139], a[200:203], v[32:47]
    ds_read_b64_tr_b16 v[156:157], v177 offset:45056
    ds_read_b64_tr_b16 v[158:159], v177 offset:46080
    s_waitcnt lgkmcnt(8)
    v_mfma_f32_32x32x16_bf16 v[32:47], v[140:143], a[204:207], v[32:47]
    s_waitcnt lgkmcnt(6)
    v_mfma_f32_32x32x16_bf16 v[32:47], v[144:147], a[208:211], v[32:47]
    s_waitcnt lgkmcnt(4)
    v_mfma_f32_32x32x16_bf16 v[32:47], v[148:151], a[212:215], v[32:47]
    s_waitcnt lgkmcnt(2)
    v_mfma_f32_32x32x16_bf16 v[32:47], v[152:155], a[216:219], v[32:47]
    s_waitcnt lgkmcnt(0)
    v_mfma_f32_32x32x16_bf16 v[32:47], v[156:159], a[220:223], v[32:47]
    s_mov_b32 s62, 0
    s_branch Lxbc
Lxb:
    buffer_load_dwordx4 v[48:51], v5, s[36:39], s59 offen offset:0 sc1
    buffer_load_dwordx4 v[52:55], v5, s[36:39], s59 offen offset:1024 sc1
    buffer_load_dwordx4 v[56:59], v5, s[36:39], s59 offen offset:2048 sc1
    buffer_load_dwordx4 v[60:63], v5, s[36:39], s59 offen offset:3072 sc1
    s_add_u32 s62, s62, 1
    s_cmp_gt_u32 s62, 1048576
    s_cbranch_scc1 Lxdb
Lxbc:
    s_waitcnt vmcnt(3)
    v_xor_b32 v48, v8, v48
    v_xor_b32 v49, v9, v49
    v_xor_b32 v50, v10, v50
    v_xor_b32 v51, v11, v51
    v_or3_b32 v13, v48, v49, 0
    v_or3_b32 v13, v50, v51, v13
    s_waitcnt vmcnt(2)
    v_xor_b32 v52, v8, v52
    v_xor_b32 v53, v9, v53
    v_xor_b32 v54, v10, v54
    v_xor_b32 v55, v11, v55
    v_or3_b32 v13, v52, v53, v13
    v_or3_b32 v13, v54, v55, v13
    s_waitcnt vmcnt(1)
    v_xor_b32 v56, v8, v56
    v_xor_b32 v57, v9, v57
    v_xor_b32 v58, v10, v58
    v_xor_b32 v59, v11, v59
    v_or3_b32 v13, v56, v57, v13
    v_or3_b32 v13, v58, v59, v13
    s_waitcnt vmcnt(0)
    v_xor_b32 v60, v8, v60
    v_xor_b32 v61, v9, v61
    v_xor_b32 v62, v10, v62
    v_xor_b32 v63, v11, v63
    v_or3_b32 v13, v60, v61, v13
    v_or3_b32 v13, v62, v63, v13
    v_and_b32 v13, 0xff, v13
    v_cmp_ne_u32 vcc, 0, v13
    s_cbranch_vccnz Lxb
Lxdb:
    s_waitcnt vmcnt(0)
    s_nop 4
    v_pk_add_f32 v[48:49], v[48:49], v[32:33]
    v_pk_add_f32 v[50:51], v[50:51], v[34:35]
    v_fmac_f32 v80, v96, v48
    v_fmac_f32 v81, v96, v49
    v_fmac_f32 v82, v96, v50
    v_fmac_f32 v83, v96, v51
    v_cvt_pk_bf16_f32 v64, v80, v81
    v_cvt_pk_bf16_f32 v65, v82, v83
    ds_write_b64 v179, v[64:65] offset:0
    v_pk_add_f32 v[52:53], v[52:53], v[36:37]
    v_pk_add_f32 v[54:55], v[54:55], v[38:39]
    v_fmac_f32 v84, v96, v52
    v_fmac_f32 v85, v96, v53
    v_fmac_f32 v86, v96, v54
    v_fmac_f32 v87, v96, v55
    v_cvt_pk_bf16_f32 v66, v84, v85
    v_cvt_pk_bf16_f32 v67, v86, v87
    ds_write_b64 v179, v[66:67] offset:16
    v_pk_add_f32 v[56:57], v[56:57], v[40:41]
    v_pk_add_f32 v[58:59], v[58:59], v[42:43]
    v_fmac_f32 v88, v96, v56
    v_fmac_f32 v89, v96, v57
    v_fmac_f32 v90, v96, v58
    v_fmac_f32 v91, v96, v59
    v_cvt_pk_bf16_f32 v68, v88, v89
    v_cvt_pk_bf16_f32 v69, v90, v91
    ds_write_b64 v179, v[68:69] offset:32
    v_pk_add_f32 v[60:61], v[60:61], v[44:45]
    v_pk_add_f32 v[62:63], v[62:63], v[46:47]
    v_fmac_f32 v92, v96, v60
    v_fmac_f32 v93, v96, v61
    v_fmac_f32 v94, v96, v62
    v_fmac_f32 v95, v96, v63
    v_cvt_pk_bf16_f32 v70, v92, v93
    v_cvt_pk_bf16_f32 v71, v94, v95
    ds_write_b64 v179, v[70:71] offset:48
    s_waitcnt lgkmcnt(0)
    ds_read_b128 v[72:75], v180
    ds_read_b128 v[76:79], v180 offset:1280
    s_waitcnt lgkmcnt(1)
    buffer_store_dwordx4 v[72:75], v181, s[32:35], s52 offen nt
    s_waitcnt lgkmcnt(0)
    buffer_store_dwordx4 v[76:79], v181, s[32:35], s53 offen nt
    s_branch L_fin
.section .rodata,"a"
.p2align 6
.amdhsa_kernel sequential_preLN__ssm_conv_h3__dense_activation_relu__prompt_kernel
  .amdhsa_next_free_vgpr 512
  .amdhsa_next_free_sgpr 102
  .amdhsa_accum_offset 256
  .amdhsa_group_segment_fixed_size 0
  .amdhsa_kernarg_size 96
  .amdhsa_user_sgpr_count 2
  .amdhsa_user_sgpr_kernarg_segment_ptr 1
  .amdhsa_system_sgpr_workgroup_id_x 1
.end_amdhsa_kernel
```
